```python
import torch

def _softmax(x, axis=-1):
    return torch.softmax(x, dim=axis)

def _gelu(x):
    return torch.nn.functional.gelu(x, approximate='tanh')

def _silu(x):
    return torch.nn.functional.silu(x)

def _sigmoid(x):
    return torch.sigmoid(x)

def _layernorm(x, axis=-1, eps=1e-05):
    m = x.mean(dim=axis, keepdim=True)
    v = x.var(dim=axis, keepdim=True, unbiased=False)
    return (x - m) / torch.sqrt(v + eps)

def _scatter_add(tgt, idx, src, axis=0):
    return tgt.clone().index_add_(axis, idx, src)

def _segment_sum(src, seg, n):
    out = torch.zeros((n,) + src.shape[1:], dtype=src.dtype)
    return out.index_add_(0, seg, src)

def _pad(x, pw):
    flat = tuple((v for pair in reversed(pw) for v in pair))
    return torch.nn.functional.pad(x, flat)
kernel_name = 'adaLN_cond__sliding_local_dilated__mixer_s_mlp__prompt'

def setup_inputs():

    _w = lambda a: (lambda t: t.to(torch.bfloat16) if t.is_floating_point() else t)(torch.as_tensor(a))

    def _A_setup():
        B, S, D = (1, 2048, 512)
        return {'x': _w((lambda *s: torch.randn(*s, dtype=torch.bfloat16) * 0.05)(B, S, D)), 'wqkv': _w((lambda *s: torch.randn(*s, dtype=torch.bfloat16) * 0.05)(D, 3 * D)), 'wo': _w((lambda *s: torch.randn(*s, dtype=torch.bfloat16) * 0.05)(D, D))}
    _A_in = _A_setup()

    def _B_setup():
        B, S, D, F = (1, 2048, 512, 1792)
        return {'x': _w((lambda *s: torch.randn(*s, dtype=torch.bfloat16) * 0.05)(B, S, D)), 'w1': _w((lambda *s: torch.randn(*s, dtype=torch.bfloat16) * 3.2)(D, D) * D ** (-0.5)), 'w2': _w((lambda *s: torch.randn(*s, dtype=torch.bfloat16) * 3.2)(D, D) * D ** (-0.5)), 'w3': _w((lambda *s: torch.randn(*s, dtype=torch.bfloat16) * 3.2)(D, F) * D ** (-0.5)), 'w4': _w((lambda *s: torch.randn(*s, dtype=torch.bfloat16) * 3.2)(F, D) * F ** (-0.5))}
    _B_in = _B_setup()
    return {'A_x': _A_in['x'], 'A_wqkv': _A_in['wqkv'], 'A_wo': _A_in['wo'], 'B_x': _B_in['x'], 'B_w1': _B_in['w1'], 'B_w2': _B_in['w2'], 'B_w3': _B_in['w3'], 'B_w4': _B_in['w4'], 'c': _w((lambda *s: torch.randn(*s, dtype=torch.bfloat16) * 0.1)(1, 512) * 8.0), 'w_mod': _w((lambda *s: torch.randn(*s, dtype=torch.bfloat16) * 0.1)(512, 6 * 512) * 512 ** (-0.5) * 8.0)}

def reference(A_x, A_wqkv, A_wo, B_x, B_w1, B_w2, B_w3, B_w4, c, w_mod):

    def _A_ref(x, wqkv, wo):
        B, S, D = x.shape
        H = 32
        Dh = D // H
        W, dil = (8, 2)
        qkv = (lambda x, *d: x.permute(*d))((x @ wqkv).reshape(B, S, 3, H, Dh), 2, 0, 3, 1, 4)
        q, k, v = (qkv[0], qkv[1], qkv[2])
        scale = Dh ** (-0.5)
        pos = torch.arange(S)
        off = torch.arange(W) * dil
        idx = pos[:, None] - off[None, :]
        mask = idx >= 0
        idx_c = torch.where(mask, idx, 0).reshape(-1)
        kg = k[:, :, idx_c, :].reshape(B, H, S, W, Dh)
        vg = v[:, :, idx_c, :].reshape(B, H, S, W, Dh)
        logits = torch.einsum('bhsd,bhswd->bhsw', q, kg) * scale
        logits = torch.where(mask[None, None, :, :], logits, -1000000000.0)
        attn = _softmax(logits, axis=-1)
        o = torch.einsum('bhsw,bhswd->bhsd', attn, vg)
        return (lambda x, *d: x.permute(*d))(o, 0, 2, 1, 3).reshape(B, S, D) @ wo

    def _B_ref(x, w1, w2, w3, w4):
        B, S, D = x.shape
        h = _gelu(_layernorm(x, axis=-1) @ w1)
        c = D // 4
        g0 = _pad(h[:, :, 0 * c:1 * c], ((0, 0), (1, 0), (0, 0)))[:, :S, :]
        g1 = _pad(h[:, :, 1 * c:2 * c], ((0, 0), (0, 1), (0, 0)))[:, 1:, :]
        g2 = _pad(h[:, :, 2 * c:3 * c], ((0, 0), (2, 0), (0, 0)))[:, :S, :]
        g3 = _pad(h[:, :, 3 * c:], ((0, 0), (0, 2), (0, 0)))[:, 2:, :]
        hs = torch.concatenate([g0, g1, g2, g3], axis=-1) @ w2
        x1 = x + hs
        h2 = _gelu(_layernorm(x1, axis=-1) @ w3) @ w4
        return x1 + h2
    x = A_x
    mod = (_silu(c) @ w_mod).reshape(c.shape[0], 6, 1, -1)
    sa, ca, ga, sb, cb, gb = (mod[:, 0].clone(), mod[:, 1].clone(), mod[:, 2].clone(), mod[:, 3].clone(), mod[:, 4].clone(), mod[:, 5].clone())
    h = _layernorm(x, axis=-1) * (1 + ca) + sa
    x = x + ga * _A_ref(h, A_wqkv, A_wo)
    h = _layernorm(x, axis=-1) * (1 + cb) + sb
    x = x + gb * _B_ref(h, B_w1, B_w2, B_w3, B_w4)
    return x
```

```asm
; @launch kernel=adaLN_cond__sliding_local_dilated__mixer_s_mlp__prompt_kernel grid=(256,1,1) block=(512,1,1) lds=163840
.amdgcn_target "amdgcn-amd-amdhsa--gfx950"
.text
.globl adaLN_cond__sliding_local_dilated__mixer_s_mlp__prompt_kernel
.p2align 8
.type adaLN_cond__sliding_local_dilated__mixer_s_mlp__prompt_kernel,@function
adaLN_cond__sliding_local_dilated__mixer_s_mlp__prompt_kernel:
    s_cmp_ge_u32 s2, 256
    s_cbranch_scc1 kp_end
    v_lshrrev_b32 v1, 6, v0
    v_and_b32 v2, 63, v0
    v_mov_b32 v6, 0
    v_readfirstlane_b32 s3, v1
    s_nop 0
    s_cmp_lg_u32 s3, 7
    s_cbranch_scc1 kp_nclr
    v_lshlrev_b32 v9, 3, v2
    v_add_u32 v9, 161792, v9
    v_mov_b32 v7, 0
    ds_write_b64 v9, v[6:7] offset:0
    ds_write_b64 v9, v[6:7] offset:512
    ds_write_b64 v9, v[6:7] offset:1024
    s_waitcnt lgkmcnt(0)
kp_nclr:
    s_load_dwordx2 s[40:41], s[0:1], 96
    s_load_dwordx16 s[16:31], s[0:1], 0
    s_load_dwordx4 s[64:67], s[0:1], 64
    s_load_dwordx2 s[32:33], s[0:1], 80
    s_load_dwordx2 s[42:43], s[0:1], 88
    s_and_b32 s4, s2, 7
    s_lshr_b32 s5, s2, 3
    v_lshrrev_b32 v3, 4, v2
    v_and_b32 v4, 15, v2
    v_lshlrev_b32 v5, 4, v2
    v_mov_b32 v1, 1
    v_mov_b32 v10, 161792
    v_mov_b32 v11, 161792
    s_lshr_b32 s6, s5, 3
    s_and_b32 s7, s5, 7
    s_lshr_b32 s12, s5, 4
    s_add_u32 s13, s5, 0
    s_and_b32 s13, s13, 15
    s_mov_b32 s37, 0
    s_getreg_b32 s9, hwreg(HW_REG_XCC_ID)
    s_and_b32 s9, s9, 15
    s_or_b32 s9, s9, 0x80
    s_mul_i32 s38, s9, 0x01010101
    s_barrier
    s_cmp_lt_u32 s3, 4
    s_cbranch_scc1 kp_compute
    s_setprio 3
    s_cmp_eq_u32 s3, 4
    s_cbranch_scc1 kp_loader
    s_cmp_eq_u32 s3, 6
    s_cbranch_scc1 kp_aux
    s_cmp_eq_u32 s3, 7
    s_cbranch_scc1 kp_aux2
    v_lshlrev_b32 v12, 7, v2
    v_lshlrev_b32 v15, 10, v2
    v_and_b32 v16, 3, v2
    v_lshlrev_b32 v16, 2, v16
    v_add_u32 v16, 161792, v16
    s_sub_u32 s52, s5, 17
    v_mov_b32 v14, s38
    v_mov_b32 v17, s5
    s_waitcnt lgkmcnt(0)
    s_load_dword s36, s[40:41], 0x0
    s_add_u32 s9, s4, 1
    s_lshl_b32 s9, s9, 21
    s_add_u32 s44, s40, s9
    s_addc_u32 s45, s41, 0
    s_mov_b32 s46, 0x200000
    s_mov_b32 s47, 0x20000
    s_mov_b32 s72, s40
    s_mov_b32 s73, s41
    s_mov_b32 s74, 0x2000000
    s_mov_b32 s75, 0x20000
    s_lshl_b32 s9, s4, 5
    s_add_u32 s42, s42, s9
    s_addc_u32 s43, s43, 0
    s_mov_b64 exec, 1
    global_store_byte v17, v14, s[42:43]
    global_load_dword v13, v6, s[42:43]
    s_mov_b64 exec, -1
    s_cmp_lt_u32 s5, 17
    s_cbranch_scc1 kp_t_a
    s_add_u32 s68, s44, 0x0
    s_addc_u32 s69, s45, 0
    s_mov_b32 s70, 16384
    s_mov_b32 s71, 0x20000
    s_lshl_b32 s10, s52, 13
    buffer_load_dword v13, v12, s[68:71], s10 offen
    s_mul_i32 s53, s4, 15
    s_mov_b32 s9, s52
    s_add_u32 s53, s53, s9
    s_mov_b32 s68, s18
    s_mov_b32 s69, s19
    s_mov_b32 s70, 0x180000
    s_mov_b32 s71, 0x20000
    s_lshl_b32 s10, s53, 13
    buffer_load_dword v13, v12, s[68:71], s10 offen
    s_add_u32 s10, s10, 983040
    buffer_load_dword v13, v12, s[68:71], s10 offen
    s_mov_b32 s68, s18
    s_mov_b32 s69, s19
    s_mov_b32 s70, 0x180000
    s_mov_b32 s71, 0x20000
    s_sub_u32 s9, 384, s18
    s_and_b32 s9, s9, 0x380
    s_lshl_b32 s10, s52, 16
    s_add_u32 s10, s10, s9
    s_add_u32 s10, s10, 0
    buffer_load_dword v13, v15, s[68:71], s10 offen
    s_add_u32 s10, s10, 983040
    buffer_load_dword v13, v15, s[68:71], s10 offen
    s_add_u32 s68, s44, 0x20000
    s_addc_u32 s69, s45, 0
    s_mov_b32 s70, 933888
    s_mov_b32 s71, 0x20000
    s_add_u32 s10, s52, 0
    s_and_b32 s9, s10, 1
    s_lshl_b32 s9, s9, 13
    s_lshr_b32 s10, s10, 1
    s_mul_i32 s10, s10, 57344
    s_add_u32 s10, s10, s9
    buffer_load_dword v13, v12, s[68:71], s10 offen
    s_add_u32 s10, s52, 15
    s_and_b32 s9, s10, 1
    s_lshl_b32 s9, s9, 13
    s_lshr_b32 s10, s10, 1
    s_mul_i32 s10, s10, 57344
    s_add_u32 s10, s10, s9
    buffer_load_dword v13, v12, s[68:71], s10 offen
    s_add_u32 s10, s52, 30
    s_and_b32 s9, s10, 1
    s_lshl_b32 s9, s9, 13
    s_lshr_b32 s10, s10, 1
    s_mul_i32 s10, s10, 57344
    s_add_u32 s10, s10, s9
    buffer_load_dword v13, v12, s[68:71], s10 offen
    ds_write_b32 v11, v1 offset:720
    s_waitcnt lgkmcnt(0)
    s_mul_i32 s36, s36, 1664525
    s_add_u32 s36, s36, 1013904221
    s_or_b32 s36, s36, 1
    v_mov_b32 v8, s36
    s_sub_u32 s9, s5, 18
    s_and_b32 s10, s9, 0xfffffff9
    s_cmp_lg_u32 s10, 0
    s_cbranch_scc1 kp_t_mid
    s_branch kp_t_a2
kp_t_a:
    s_waitcnt lgkmcnt(0)
    s_mul_i32 s36, s36, 1664525
    s_add_u32 s36, s36, 1013904221
    s_or_b32 s36, s36, 1
    v_mov_b32 v8, s36
kp_t_a2:
    s_mov_b32 s54, 0
lm_1:
    s_sleep 4
    s_cmp_eq_u32 s37, 1
    s_cbranch_scc1 cm_2
    v_and_b32 v9, 7, v2
    v_lshlrev_b32 v9, 2, v9
    global_load_dword v9, v9, s[42:43] sc1
    s_waitcnt vmcnt(0)
    v_cmp_ne_u32 vcc, s38, v9
    s_nop 0
    s_cmp_eq_u64 vcc, 0
    s_cselect_b32 s37, 1, 0
cm_2:
    s_add_u32 s54, s54, 1
    s_cmp_gt_u32 s54, 40
    s_cbranch_scc1 lm_1_x
    s_cmp_eq_u32 s37, 0
    s_cbranch_scc1 lm_1
lm_1_x:
    s_or_b32 s9, s13, 1
    s_lshl_b32 s9, s9, 2
    v_mov_b32 v17, s9
    s_cmp_eq_u32 s37, 0
    s_cbranch_scc1 td_3
    s_mov_b32 s53, 0x1e00
    s_mov_b32 s15, 0
sp_4:
    s_sleep 2
    buffer_load_dword v9, v17, s[44:47], s53 offen sc1
    s_add_u32 s15, s15, 1
    s_cmp_gt_u32 s15, 100000
    s_cbranch_scc1 sp_4_x
    s_waitcnt vmcnt(0)
    v_cmp_ne_u32 vcc, s36, v9
    s_cbranch_vccnz sp_4
sp_4_x:
    s_waitcnt vmcnt(0)
td_3:
    ds_write_b32 v11, v1 offset:736
    s_cmp_eq_u32 s37, 0
    s_cbranch_scc1 td_5
    s_mov_b32 s53, 0x1e40
    s_mov_b32 s15, 0
sp_6:
    s_sleep 2
    buffer_load_dword v9, v17, s[44:47], s53 offen sc1
    s_add_u32 s15, s15, 1
    s_cmp_gt_u32 s15, 100000
    s_cbranch_scc1 sp_6_x
    s_waitcnt vmcnt(0)
    v_cmp_ne_u32 vcc, s36, v9
    s_cbranch_vccnz sp_6
sp_6_x:
    s_waitcnt vmcnt(0)
td_5:
    ds_write_b32 v11, v1 offset:752
    s_cmp_eq_u32 s37, 0
    s_cbranch_scc1 td_7
    s_mov_b32 s53, 0x1e80
    s_mov_b32 s15, 0
sp_8:
    s_sleep 2
    buffer_load_dword v9, v17, s[44:47], s53 offen sc1
    s_add_u32 s15, s15, 1
    s_cmp_gt_u32 s15, 100000
    s_cbranch_scc1 sp_8_x
    s_waitcnt vmcnt(0)
    v_cmp_ne_u32 vcc, s36, v9
    s_cbranch_vccnz sp_8
sp_8_x:
    s_waitcnt vmcnt(0)
td_7:
    ds_write_b32 v11, v1 offset:768
    s_cmp_eq_u32 s37, 0
    s_cbranch_scc1 td_9
    s_mov_b32 s53, 0x1ec0
    s_mov_b32 s15, 0
sp_10:
    s_sleep 2
    buffer_load_dword v9, v17, s[44:47], s53 offen sc1
    s_add_u32 s15, s15, 1
    s_cmp_gt_u32 s15, 100000
    s_cbranch_scc1 sp_10_x
    s_waitcnt vmcnt(0)
    v_cmp_ne_u32 vcc, s36, v9
    s_cbranch_vccnz sp_10
sp_10_x:
    s_waitcnt vmcnt(0)
td_9:
    ds_write_b32 v11, v1 offset:784
kp_t_mid:
    s_mov_b32 s15, 0
sp_11:
    s_sleep 1
    ds_read_b32 v9, v10 offset:384
    s_add_u32 s15, s15, 1
    s_cmp_gt_u32 s15, 4000000
    s_cbranch_scc1 sp_11_x
    s_waitcnt lgkmcnt(0)
    v_cmp_ne_u32 vcc, 1, v9
    s_cbranch_vccnz sp_11
sp_11_x:
    s_waitcnt lgkmcnt(0)
    s_cmp_lt_u32 s5, 17
    s_cbranch_scc1 tq_12
    s_bitcmp0_b32 s5, 0
    s_cbranch_scc1 tq_12
    s_lshl_b32 s54, s52, 2
    s_add_u32 s54, s54, s4
    s_mov_b32 s68, s20
    s_mov_b32 s69, s21
    s_mov_b32 s70, 0x80000
    s_mov_b32 s71, 0x20000
    s_lshl_b32 s10, s54, 13
    buffer_load_dword v13, v12, s[68:71], s10 offen
tq_12:
    s_cmp_lt_u32 s5, 17
    s_cbranch_scc1 tq_13
    s_bitcmp0_b32 s5, 0
    s_cbranch_scc1 tq_13
    s_lshl_b32 s54, s52, 2
    s_add_u32 s54, s54, s4
    s_mov_b32 s68, s24
    s_mov_b32 s69, s25
    s_mov_b32 s70, 0x80000
    s_mov_b32 s71, 0x20000
    s_lshl_b32 s10, s54, 13
    buffer_load_dword v13, v12, s[68:71], s10 offen
tq_13:
    s_cmp_lt_u32 s5, 17
    s_cbranch_scc1 tq_14
    s_bitcmp0_b32 s5, 0
    s_cbranch_scc1 tq_14
    s_lshl_b32 s54, s52, 2
    s_add_u32 s54, s54, s4
    s_mov_b32 s68, s26
    s_mov_b32 s69, s27
    s_mov_b32 s70, 0x80000
    s_mov_b32 s71, 0x20000
    s_lshl_b32 s10, s54, 13
    buffer_load_dword v13, v12, s[68:71], s10 offen
tq_14:
    s_cmp_lt_u32 s5, 17
    s_cbranch_scc1 tq_15
    s_bitcmp0_b32 s5, 0
    s_cbranch_scc1 tq_15
    s_lshl_b32 s54, s52, 2
    s_add_u32 s54, s54, s4
    s_mov_b32 s68, s28
    s_mov_b32 s69, s29
    s_mov_b32 s70, 0x1c0000
    s_mov_b32 s71, 0x20000
    s_lshl_b32 s10, s54, 13
    buffer_load_dword v13, v12, s[68:71], s10 offen
    s_add_u32 s10, s10, 524288
    buffer_load_dword v13, v12, s[68:71], s10 offen
    s_add_u32 s10, s10, 524288
    buffer_load_dword v13, v12, s[68:71], s10 offen
    s_add_u32 s10, s10, 524288
    buffer_load_dword v13, v12, s[68:71], s10 offen
tq_15:
    s_mov_b32 s15, 0
sp_16:
    s_sleep 1
    ds_read_b32 v9, v10 offset:400
    s_add_u32 s15, s15, 1
    s_cmp_gt_u32 s15, 4000000
    s_cbranch_scc1 sp_16_x
    s_waitcnt lgkmcnt(0)
    v_cmp_ne_u32 vcc, 1, v9
    s_cbranch_vccnz sp_16
sp_16_x:
    s_waitcnt lgkmcnt(0)
    s_mov_b32 s15, 0
sp_17:
    s_sleep 1
    ds_read_b32 v9, v16 offset:0
    s_add_u32 s15, s15, 1
    s_cmp_gt_u32 s15, 4000000
    s_cbranch_scc1 sp_17_x
    s_waitcnt lgkmcnt(0)
    v_cmp_ne_u32 vcc, 1, v9
    s_cbranch_vccnz sp_17
sp_17_x:
    s_waitcnt lgkmcnt(0)
    s_mov_b32 s68, s20
    s_mov_b32 s69, s21
    s_mov_b32 s70, 0x80000
    s_mov_b32 s71, 0x20000
    s_lshl_b32 s10, s5, 13
    buffer_load_dword v13, v12, s[68:71], s10 offen
    s_add_u32 s10, s10, 262144
    s_waitcnt vmcnt(3)
    buffer_load_dword v13, v12, s[68:71], s10 offen
    s_waitcnt vmcnt(3)
    s_add_u32 s68, s44, 0x24000
    s_addc_u32 s69, s45, 0
    s_mov_b32 s70, 991232
    s_mov_b32 s71, 0x20000
    s_add_u32 s10, s5, 0
    s_and_b32 s9, s10, 1
    s_lshl_b32 s9, s9, 13
    s_lshr_b32 s10, s10, 1
    s_mul_i32 s10, s10, 57344
    s_add_u32 s10, s10, s9
    buffer_load_dword v13, v12, s[68:71], s10 offen
    s_waitcnt vmcnt(3)
    s_add_u32 s10, s5, 32
    s_and_b32 s9, s10, 1
    s_lshl_b32 s9, s9, 13
    s_lshr_b32 s10, s10, 1
    s_mul_i32 s10, s10, 57344
    s_add_u32 s10, s10, s9
    buffer_load_dword v13, v12, s[68:71], s10 offen
    s_waitcnt vmcnt(3)
    s_mov_b32 s68, s24
    s_mov_b32 s69, s25
    s_mov_b32 s70, 0x80000
    s_mov_b32 s71, 0x20000
    s_lshl_b32 s10, s5, 13
    buffer_load_dword v13, v12, s[68:71], s10 offen
    s_add_u32 s10, s10, 262144
    s_waitcnt vmcnt(3)
    buffer_load_dword v13, v12, s[68:71], s10 offen
    s_waitcnt vmcnt(3)
    s_waitcnt vmcnt(3)
    ds_write_b32 v11, v1 offset:800
    s_add_u32 s68, s44, 0x4000
    s_addc_u32 s69, s45, 0
    s_mov_b32 s70, 114688
    s_mov_b32 s71, 0x20000
    s_lshl_b32 s10, s5, 13
    buffer_load_dword v13, v12, s[68:71], s10 offen
    s_waitcnt vmcnt(3)
    s_add_u32 s68, s44, 0x11c000
    s_addc_u32 s69, s45, 0
    s_mov_b32 s70, 262144
    s_mov_b32 s71, 0x20000
    s_lshl_b32 s10, s5, 13
    buffer_load_dword v13, v12, s[68:71], s10 offen
    s_waitcnt vmcnt(3)
    s_mov_b32 s68, s26
    s_mov_b32 s69, s27
    s_mov_b32 s70, 0x80000
    s_mov_b32 s71, 0x20000
    s_lshl_b32 s10, s5, 13
    buffer_load_dword v13, v12, s[68:71], s10 offen
    s_add_u32 s10, s10, 262144
    s_waitcnt vmcnt(3)
    buffer_load_dword v13, v12, s[68:71], s10 offen
    s_waitcnt vmcnt(3)
    s_mov_b32 s68, s30
    s_mov_b32 s69, s31
    s_mov_b32 s70, 0x1c0000
    s_mov_b32 s71, 0x20000
    s_lshl_b32 s10, s2, 13
    buffer_load_dword v13, v12, s[68:71], s10 offen
    s_mov_b32 s15, 0
sp_18:
    s_sleep 1
    ds_read_b32 v9, v16 offset:16
    s_add_u32 s15, s15, 1
    s_cmp_gt_u32 s15, 4000000
    s_cbranch_scc1 sp_18_x
    s_waitcnt lgkmcnt(0)
    v_cmp_ne_u32 vcc, 1, v9
    s_cbranch_vccnz sp_18
sp_18_x:
    s_waitcnt lgkmcnt(0)
    s_mov_b32 s68, s28
    s_mov_b32 s69, s29
    s_mov_b32 s70, 0x1c0000
    s_mov_b32 s71, 0x20000
    s_lshl_b32 s10, s5, 13
    buffer_load_dword v13, v12, s[68:71], s10 offen
    s_mov_b32 s15, 0
sp_19:
    s_sleep 1
    ds_read_b32 v9, v16 offset:32
    s_add_u32 s15, s15, 1
    s_cmp_gt_u32 s15, 4000000
    s_cbranch_scc1 sp_19_x
    s_waitcnt lgkmcnt(0)
    v_cmp_ne_u32 vcc, 1, v9
    s_cbranch_vccnz sp_19
sp_19_x:
    s_waitcnt lgkmcnt(0)
    s_cmp_lg_u32 s13, 0
    s_cbranch_scc1 gf_20
    s_lshl_b32 s10, s4, 3
    s_lshl_b32 s9, s12, 2
    s_add_u32 s10, s10, s9
    s_mov_b64 exec, 1
    buffer_store_dword v8, v6, s[72:75], s10 offen offset:256 sc1
    s_mov_b64 exec, -1
gf_20:
    s_mov_b32 s68, s28
    s_mov_b32 s69, s29
    s_mov_b32 s70, 0x1c0000
    s_mov_b32 s71, 0x20000
    s_lshl_b32 s10, s5, 13
    s_add_u32 s10, s10, 0x40000
    buffer_load_dword v13, v12, s[68:71], s10 offen
    s_add_u32 s10, s10, 262144
    buffer_load_dword v13, v12, s[68:71], s10 offen
    s_mov_b32 s15, 0
sp_21:
    s_sleep 1
    ds_read_b32 v9, v16 offset:48
    s_add_u32 s15, s15, 1
    s_cmp_gt_u32 s15, 4000000
    s_cbranch_scc1 sp_21_x
    s_waitcnt lgkmcnt(0)
    v_cmp_ne_u32 vcc, 1, v9
    s_cbranch_vccnz sp_21
sp_21_x:
    s_waitcnt lgkmcnt(0)
    s_mov_b32 s68, s30
    s_mov_b32 s69, s31
    s_mov_b32 s70, 0x1c0000
    s_mov_b32 s71, 0x20000
    s_lshl_b32 s10, s5, 13
    buffer_load_dword v13, v12, s[68:71], s10 offen
    s_add_u32 s10, s10, 262144
    buffer_load_dword v13, v12, s[68:71], s10 offen
    s_mov_b32 s15, 0
sp_22:
    s_sleep 1
    ds_read_b32 v9, v16 offset:64
    s_add_u32 s15, s15, 1
    s_cmp_gt_u32 s15, 4000000
    s_cbranch_scc1 sp_22_x
    s_waitcnt lgkmcnt(0)
    v_cmp_ne_u32 vcc, 1, v9
    s_cbranch_vccnz sp_22
sp_22_x:
    s_waitcnt lgkmcnt(0)
    s_cmp_lg_u32 s2, 0
    s_cbranch_scc1 ge_23
    v_lshlrev_b32 v14, 2, v4
    s_mov_b32 s53, 256
    s_mov_b32 s15, 0
sp_24:
    buffer_load_dword v9, v14, s[72:75], s53 offen sc1
    s_add_u32 s15, s15, 1
    s_cmp_gt_u32 s15, 100000
    s_cbranch_scc1 sp_24_x
    s_waitcnt vmcnt(0)
    v_cmp_ne_u32 vcc, s36, v9
    s_cbranch_vccnz sp_24
sp_24_x:
    s_waitcnt vmcnt(0)
    s_mov_b64 exec, 1
    buffer_store_dword v8, v6, s[72:75], 0 offen offset:0
    s_mov_b64 exec, -1
ge_23:
    s_add_u32 s68, s44, 0x36000
    s_addc_u32 s69, s45, 0
    s_mov_b32 s70, 876544
    s_mov_b32 s71, 0x20000
    s_add_u32 s10, s5, 0
    s_and_b32 s9, s10, 1
    s_lshl_b32 s9, s9, 13
    s_lshr_b32 s10, s10, 1
    s_mul_i32 s10, s10, 57344
    s_add_u32 s10, s10, s9
    buffer_load_dword v13, v12, s[68:71], s10 offen
    s_add_u32 s68, s44, 0x3a000
    s_addc_u32 s69, s45, 0
    s_mov_b32 s70, 868352
    s_mov_b32 s71, 0x20000
    s_add_u32 s10, s5, 0
    s_mul_i32 s10, s10, 57344
    buffer_load_dword v13, v12, s[68:71], s10 offen
    s_mov_b32 s68, s30
    s_mov_b32 s69, s31
    s_mov_b32 s70, 0x1c0000
    s_mov_b32 s71, 0x20000
    s_lshl_b32 s10, s5, 13
    s_add_u32 s10, s10, 0x80000
    buffer_load_dword v13, v12, s[68:71], s10 offen
    s_add_u32 s10, s10, 262144
    buffer_load_dword v13, v12, s[68:71], s10 offen
    s_endpgm
kp_loader:
    v_lshlrev_b32 v15, 1, v3
    v_and_b32 v16, 7, v2
    v_xor_b32 v15, v15, v16
    v_lshlrev_b32 v15, 4, v15
    v_lshrrev_b32 v16, 3, v2
    v_mul_u32_u24 v36, 6144, v16
    v_add_u32 v36, v36, v15
    v_bfe_u32 v17, v15, 6, 1
    v_mul_u32_u24 v17, 960, v17
    v_add_u32 v36, v36, v17
    v_lshl_add_u32 v32, v16, 10, v15
    v_add_u32 v37, 48128, v36
    v_add_u32 v38, 96256, v36
    v_add_u32 v39, 144384, v36
    v_lshrrev_b32 v28, 2, v2
    v_mul_u32_u24 v28, 3072, v28
    v_lshrrev_b32 v15, 5, v2
    v_lshlrev_b32 v15, 1, v15
    v_and_b32 v16, 3, v2
    v_xor_b32 v15, v15, v16
    v_lshl_add_u32 v28, v15, 4, v28
    v_add_u32 v29, 48128, v28
    v_add_u32 v30, 96256, v28
    v_add_u32 v31, 144384, v28
    v_add_u32 v33, 7168, v32
    v_add_u32 v34, 14336, v32
    v_add_u32 v35, 21504, v32
    v_and_b32 v18, 3, v2
    v_lshlrev_b32 v18, 2, v18
    v_add_u32 v18, 161792, v18
    s_lshl_b32 s52, s5, 6
    s_mul_i32 s9, s4, 393216
    s_add_u32 s52, s52, s9
    s_waitcnt lgkmcnt(0)
    s_load_dword s36, s[40:41], 0x0
    s_add_u32 s9, s4, 1
    s_lshl_b32 s9, s9, 21
    s_add_u32 s44, s40, s9
    s_addc_u32 s45, s41, 0
    s_mov_b32 s46, 0x200000
    s_mov_b32 s47, 0x20000
    s_mov_b32 s72, s40
    s_mov_b32 s73, s41
    s_mov_b32 s74, 0x2000000
    s_mov_b32 s75, 0x20000
    s_lshl_b32 s9, s4, 5
    s_add_u32 s42, s42, s9
    s_addc_u32 s43, s43, 0
    s_cmp_gt_u32 s5, 15
    s_cbranch_scc1 kp_l_nm
    s_mov_b32 s48, s66
    s_mov_b32 s49, s67
    s_mov_b32 s50, 0x300000
    s_mov_b32 s51, 0x20000
    s_mov_b32 m0, 98304
    s_add_u32 s10, s52, 0
    s_mov_b32 s14, 2
dl_25:
    s_waitcnt vmcnt(16)
    buffer_load_dwordx4 v36, s[48:51], s10 offen offset:0 lds
    buffer_load_dwordx4 v37, s[48:51], s10 offen offset:1024 lds
    buffer_load_dwordx4 v38, s[48:51], s10 offen offset:2048 lds
    buffer_load_dwordx4 v39, s[48:51], s10 offen offset:3072 lds
    s_add_u32 m0, m0, 4096
    s_add_u32 s10, s10, 196608
    s_sub_u32 s14, s14, 1
    s_cmp_lg_u32 s14, 0
    s_cbranch_scc1 dl_25
kp_l_nm:
    s_mov_b32 s48, s18
    s_mov_b32 s49, s19
    s_mov_b32 s50, 0x180000
    s_mov_b32 s51, 0x20000
    s_lshl_b32 s52, s13, 6
    s_waitcnt vmcnt(0)
    ds_write_b32 v11, v1 offset:688
    s_waitcnt lgkmcnt(0)
    s_mul_i32 s36, s36, 1664525
    s_add_u32 s36, s36, 1013904221
    s_or_b32 s36, s36, 1
    v_mov_b32 v8, s36
    s_cmp_lt_u32 s5, 17
    s_cbranch_scc1 kp_l_a
    s_sub_u32 s9, s5, 18
    s_and_b32 s10, s9, 0xfffffff9
    s_cmp_lg_u32 s10, 0
    s_cbranch_scc1 kp_l_b
kp_l_a:
    s_mov_b32 s15, 0
sp_26:
    s_sleep 1
    ds_read_b32 v9, v10 offset:736
    s_add_u32 s15, s15, 1
    s_cmp_gt_u32 s15, 4000000
    s_cbranch_scc1 sp_26_x
    s_waitcnt lgkmcnt(0)
    v_cmp_ne_u32 vcc, 1, v9
    s_cbranch_vccnz sp_26
sp_26_x:
    s_waitcnt lgkmcnt(0)
    s_mov_b32 m0, 0
    s_add_u32 s10, s52, 0
    s_mov_b32 s14, 2
dl_27:
    buffer_load_dwordx4 v28, s[48:51], s10 offen offset:0 lds
    buffer_load_dwordx4 v29, s[48:51], s10 offen offset:1024 lds
    buffer_load_dwordx4 v30, s[48:51], s10 offen offset:2048 lds
    buffer_load_dwordx4 v31, s[48:51], s10 offen offset:3072 lds
    s_add_u32 m0, m0, 4096
    s_add_u32 s10, s10, 196608
    s_sub_u32 s14, s14, 1
    s_cmp_lg_u32 s14, 0
    s_cbranch_scc1 dl_27
    s_mov_b32 m0, 32768
    s_add_u32 s10, s52, 1024
    s_mov_b32 s14, 2
dl_28:
    buffer_load_dwordx4 v28, s[48:51], s10 offen offset:0 lds
    buffer_load_dwordx4 v29, s[48:51], s10 offen offset:1024 lds
    buffer_load_dwordx4 v30, s[48:51], s10 offen offset:2048 lds
    buffer_load_dwordx4 v31, s[48:51], s10 offen offset:3072 lds
    s_add_u32 m0, m0, 4096
    s_add_u32 s10, s10, 196608
    s_sub_u32 s14, s14, 1
    s_cmp_lg_u32 s14, 0
    s_cbranch_scc1 dl_28
    s_mov_b32 m0, 65536
    s_add_u32 s10, s52, 2048
    s_mov_b32 s14, 2
dl_29:
    buffer_load_dwordx4 v28, s[48:51], s10 offen offset:0 lds
    buffer_load_dwordx4 v29, s[48:51], s10 offen offset:1024 lds
    buffer_load_dwordx4 v30, s[48:51], s10 offen offset:2048 lds
    buffer_load_dwordx4 v31, s[48:51], s10 offen offset:3072 lds
    s_add_u32 m0, m0, 4096
    s_add_u32 s10, s10, 196608
    s_sub_u32 s14, s14, 1
    s_cmp_lg_u32 s14, 0
    s_cbranch_scc1 dl_29
    ds_read_b32 v9, v10 offset:752
    s_waitcnt lgkmcnt(0)
    v_cmp_ne_u32 vcc, 1, v9
    s_cbranch_vccz tq_30
    s_waitcnt vmcnt(0)
    ds_write_b32 v11, v1 offset:352
tq_30:
    s_mov_b32 s15, 0
sp_31:
    s_sleep 1
    ds_read_b32 v9, v10 offset:752
    s_add_u32 s15, s15, 1
    s_cmp_gt_u32 s15, 4000000
    s_cbranch_scc1 sp_31_x
    s_waitcnt lgkmcnt(0)
    v_cmp_ne_u32 vcc, 1, v9
    s_cbranch_vccnz sp_31
sp_31_x:
    s_waitcnt lgkmcnt(0)
    s_mov_b32 m0, 8192
    s_add_u32 s10, s52, 393216
    s_mov_b32 s14, 2
dl_32:
    buffer_load_dwordx4 v28, s[48:51], s10 offen offset:0 lds
    buffer_load_dwordx4 v29, s[48:51], s10 offen offset:1024 lds
    buffer_load_dwordx4 v30, s[48:51], s10 offen offset:2048 lds
    buffer_load_dwordx4 v31, s[48:51], s10 offen offset:3072 lds
    s_add_u32 m0, m0, 4096
    s_add_u32 s10, s10, 196608
    s_sub_u32 s14, s14, 1
    s_cmp_lg_u32 s14, 0
    s_cbranch_scc1 dl_32
    s_mov_b32 m0, 40960
    s_add_u32 s10, s52, 394240
    s_mov_b32 s14, 2
dl_33:
    buffer_load_dwordx4 v28, s[48:51], s10 offen offset:0 lds
    buffer_load_dwordx4 v29, s[48:51], s10 offen offset:1024 lds
    buffer_load_dwordx4 v30, s[48:51], s10 offen offset:2048 lds
    buffer_load_dwordx4 v31, s[48:51], s10 offen offset:3072 lds
    s_add_u32 m0, m0, 4096
    s_add_u32 s10, s10, 196608
    s_sub_u32 s14, s14, 1
    s_cmp_lg_u32 s14, 0
    s_cbranch_scc1 dl_33
    s_mov_b32 m0, 73728
    s_add_u32 s10, s52, 395264
    s_mov_b32 s14, 2
dl_34:
    buffer_load_dwordx4 v28, s[48:51], s10 offen offset:0 lds
    buffer_load_dwordx4 v29, s[48:51], s10 offen offset:1024 lds
    buffer_load_dwordx4 v30, s[48:51], s10 offen offset:2048 lds
    buffer_load_dwordx4 v31, s[48:51], s10 offen offset:3072 lds
    s_add_u32 m0, m0, 4096
    s_add_u32 s10, s10, 196608
    s_sub_u32 s14, s14, 1
    s_cmp_lg_u32 s14, 0
    s_cbranch_scc1 dl_34
    s_waitcnt vmcnt(24)
    ds_write_b32 v11, v1 offset:352
    ds_read_b32 v9, v10 offset:768
    s_waitcnt lgkmcnt(0)
    v_cmp_ne_u32 vcc, 1, v9
    s_cbranch_vccz tq_35
    s_waitcnt vmcnt(0)
    ds_write_b32 v11, v1 offset:368
tq_35:
    s_mov_b32 s15, 0
sp_36:
    s_sleep 1
    ds_read_b32 v9, v10 offset:768
    s_add_u32 s15, s15, 1
    s_cmp_gt_u32 s15, 4000000
    s_cbranch_scc1 sp_36_x
    s_waitcnt lgkmcnt(0)
    v_cmp_ne_u32 vcc, 1, v9
    s_cbranch_vccnz sp_36
sp_36_x:
    s_waitcnt lgkmcnt(0)
    s_mov_b32 m0, 16384
    s_add_u32 s10, s52, 786432
    s_mov_b32 s14, 2
dl_37:
    buffer_load_dwordx4 v28, s[48:51], s10 offen offset:0 lds
    buffer_load_dwordx4 v29, s[48:51], s10 offen offset:1024 lds
    buffer_load_dwordx4 v30, s[48:51], s10 offen offset:2048 lds
    buffer_load_dwordx4 v31, s[48:51], s10 offen offset:3072 lds
    s_add_u32 m0, m0, 4096
    s_add_u32 s10, s10, 196608
    s_sub_u32 s14, s14, 1
    s_cmp_lg_u32 s14, 0
    s_cbranch_scc1 dl_37
    s_mov_b32 m0, 49152
    s_add_u32 s10, s52, 787456
    s_mov_b32 s14, 2
dl_38:
    buffer_load_dwordx4 v28, s[48:51], s10 offen offset:0 lds
    buffer_load_dwordx4 v29, s[48:51], s10 offen offset:1024 lds
    buffer_load_dwordx4 v30, s[48:51], s10 offen offset:2048 lds
    buffer_load_dwordx4 v31, s[48:51], s10 offen offset:3072 lds
    s_add_u32 m0, m0, 4096
    s_add_u32 s10, s10, 196608
    s_sub_u32 s14, s14, 1
    s_cmp_lg_u32 s14, 0
    s_cbranch_scc1 dl_38
    s_mov_b32 m0, 81920
    s_add_u32 s10, s52, 788480
    s_mov_b32 s14, 2
dl_39:
    buffer_load_dwordx4 v28, s[48:51], s10 offen offset:0 lds
    buffer_load_dwordx4 v29, s[48:51], s10 offen offset:1024 lds
    buffer_load_dwordx4 v30, s[48:51], s10 offen offset:2048 lds
    buffer_load_dwordx4 v31, s[48:51], s10 offen offset:3072 lds
    s_add_u32 m0, m0, 4096
    s_add_u32 s10, s10, 196608
    s_sub_u32 s14, s14, 1
    s_cmp_lg_u32 s14, 0
    s_cbranch_scc1 dl_39
    s_waitcnt vmcnt(24)
    ds_write_b32 v11, v1 offset:368
    ds_read_b32 v9, v10 offset:784
    s_waitcnt lgkmcnt(0)
    v_cmp_ne_u32 vcc, 1, v9
    s_cbranch_vccz tq_40
    s_waitcnt vmcnt(0)
    ds_write_b32 v11, v1 offset:384
tq_40:
    s_mov_b32 s15, 0
sp_41:
    s_sleep 1
    ds_read_b32 v9, v10 offset:784
    s_add_u32 s15, s15, 1
    s_cmp_gt_u32 s15, 4000000
    s_cbranch_scc1 sp_41_x
    s_waitcnt lgkmcnt(0)
    v_cmp_ne_u32 vcc, 1, v9
    s_cbranch_vccnz sp_41
sp_41_x:
    s_waitcnt lgkmcnt(0)
    s_mov_b32 m0, 24576
    s_add_u32 s10, s52, 1179648
    s_mov_b32 s14, 2
dl_42:
    buffer_load_dwordx4 v28, s[48:51], s10 offen offset:0 lds
    buffer_load_dwordx4 v29, s[48:51], s10 offen offset:1024 lds
    buffer_load_dwordx4 v30, s[48:51], s10 offen offset:2048 lds
    buffer_load_dwordx4 v31, s[48:51], s10 offen offset:3072 lds
    s_add_u32 m0, m0, 4096
    s_add_u32 s10, s10, 196608
    s_sub_u32 s14, s14, 1
    s_cmp_lg_u32 s14, 0
    s_cbranch_scc1 dl_42
    s_mov_b32 m0, 57344
    s_add_u32 s10, s52, 1180672
    s_mov_b32 s14, 2
dl_43:
    buffer_load_dwordx4 v28, s[48:51], s10 offen offset:0 lds
    buffer_load_dwordx4 v29, s[48:51], s10 offen offset:1024 lds
    buffer_load_dwordx4 v30, s[48:51], s10 offen offset:2048 lds
    buffer_load_dwordx4 v31, s[48:51], s10 offen offset:3072 lds
    s_add_u32 m0, m0, 4096
    s_add_u32 s10, s10, 196608
    s_sub_u32 s14, s14, 1
    s_cmp_lg_u32 s14, 0
    s_cbranch_scc1 dl_43
    s_mov_b32 m0, 90112
    s_add_u32 s10, s52, 1181696
    s_mov_b32 s14, 2
dl_44:
    buffer_load_dwordx4 v28, s[48:51], s10 offen offset:0 lds
    buffer_load_dwordx4 v29, s[48:51], s10 offen offset:1024 lds
    buffer_load_dwordx4 v30, s[48:51], s10 offen offset:2048 lds
    buffer_load_dwordx4 v31, s[48:51], s10 offen offset:3072 lds
    s_add_u32 m0, m0, 4096
    s_add_u32 s10, s10, 196608
    s_sub_u32 s14, s14, 1
    s_cmp_lg_u32 s14, 0
    s_cbranch_scc1 dl_44
    s_waitcnt vmcnt(24)
    ds_write_b32 v11, v1 offset:384
    s_waitcnt vmcnt(0)
    ds_write_b32 v11, v1 offset:400
    s_branch kp_l_j
kp_l_b:
    s_lshl_b32 s53, s13, 2
    s_add_u32 s53, s53, 0x1e00
    s_mov_b32 s15, 0
sp_45:
    s_sleep 1
    ds_read_b32 v9, v10 offset:720
    s_add_u32 s15, s15, 1
    s_cmp_gt_u32 s15, 4000000
    s_cbranch_scc1 sp_45_x
    s_waitcnt lgkmcnt(0)
    v_cmp_ne_u32 vcc, 1, v9
    s_cbranch_vccnz sp_45
sp_45_x:
    s_waitcnt lgkmcnt(0)
    s_mov_b32 m0, 0
    s_add_u32 s10, s52, 0
    s_mov_b32 s14, 2
dl_46:
    buffer_load_dwordx4 v28, s[48:51], s10 offen offset:0 lds
    buffer_load_dwordx4 v29, s[48:51], s10 offen offset:1024 lds
    buffer_load_dwordx4 v30, s[48:51], s10 offen offset:2048 lds
    buffer_load_dwordx4 v31, s[48:51], s10 offen offset:3072 lds
    s_add_u32 m0, m0, 4096
    s_add_u32 s10, s10, 196608
    s_sub_u32 s14, s14, 1
    s_cmp_lg_u32 s14, 0
    s_cbranch_scc1 dl_46
    s_mov_b32 m0, 32768
    s_add_u32 s10, s52, 1024
    s_mov_b32 s14, 2
dl_47:
    buffer_load_dwordx4 v28, s[48:51], s10 offen offset:0 lds
    buffer_load_dwordx4 v29, s[48:51], s10 offen offset:1024 lds
    buffer_load_dwordx4 v30, s[48:51], s10 offen offset:2048 lds
    buffer_load_dwordx4 v31, s[48:51], s10 offen offset:3072 lds
    s_add_u32 m0, m0, 4096
    s_add_u32 s10, s10, 196608
    s_sub_u32 s14, s14, 1
    s_cmp_lg_u32 s14, 0
    s_cbranch_scc1 dl_47
    s_mov_b32 m0, 65536
    s_add_u32 s10, s52, 2048
    s_mov_b32 s14, 2
dl_48:
    buffer_load_dwordx4 v28, s[48:51], s10 offen offset:0 lds
    buffer_load_dwordx4 v29, s[48:51], s10 offen offset:1024 lds
    buffer_load_dwordx4 v30, s[48:51], s10 offen offset:2048 lds
    buffer_load_dwordx4 v31, s[48:51], s10 offen offset:3072 lds
    s_add_u32 m0, m0, 4096
    s_add_u32 s10, s10, 196608
    s_sub_u32 s14, s14, 1
    s_cmp_lg_u32 s14, 0
    s_cbranch_scc1 dl_48
    s_mov_b32 m0, 8192
    s_add_u32 s10, s52, 393216
    s_mov_b32 s14, 2
dl_49:
    buffer_load_dwordx4 v28, s[48:51], s10 offen offset:0 lds
    buffer_load_dwordx4 v29, s[48:51], s10 offen offset:1024 lds
    buffer_load_dwordx4 v30, s[48:51], s10 offen offset:2048 lds
    buffer_load_dwordx4 v31, s[48:51], s10 offen offset:3072 lds
    s_add_u32 m0, m0, 4096
    s_add_u32 s10, s10, 196608
    s_sub_u32 s14, s14, 1
    s_cmp_lg_u32 s14, 0
    s_cbranch_scc1 dl_49
    s_mov_b32 m0, 40960
    s_add_u32 s10, s52, 394240
    s_mov_b32 s14, 2
dl_50:
    buffer_load_dwordx4 v28, s[48:51], s10 offen offset:0 lds
    buffer_load_dwordx4 v29, s[48:51], s10 offen offset:1024 lds
    buffer_load_dwordx4 v30, s[48:51], s10 offen offset:2048 lds
    buffer_load_dwordx4 v31, s[48:51], s10 offen offset:3072 lds
    s_add_u32 m0, m0, 4096
    s_add_u32 s10, s10, 196608
    s_sub_u32 s14, s14, 1
    s_cmp_lg_u32 s14, 0
    s_cbranch_scc1 dl_50
    s_mov_b32 m0, 73728
    s_add_u32 s10, s52, 395264
    s_mov_b32 s14, 2
dl_51:
    buffer_load_dwordx4 v28, s[48:51], s10 offen offset:0 lds
    buffer_load_dwordx4 v29, s[48:51], s10 offen offset:1024 lds
    buffer_load_dwordx4 v30, s[48:51], s10 offen offset:2048 lds
    buffer_load_dwordx4 v31, s[48:51], s10 offen offset:3072 lds
    s_add_u32 m0, m0, 4096
    s_add_u32 s10, s10, 196608
    s_sub_u32 s14, s14, 1
    s_cmp_lg_u32 s14, 0
    s_cbranch_scc1 dl_51
    s_waitcnt vmcnt(24)
    s_mov_b64 exec, 1
    buffer_store_dword v8, v6, s[44:47], s53 offen offset:0
    s_mov_b64 exec, -1
    ds_write_b32 v11, v1 offset:352
    s_mov_b32 m0, 16384
    s_add_u32 s10, s52, 786432
    s_mov_b32 s14, 2
dl_52:
    buffer_load_dwordx4 v28, s[48:51], s10 offen offset:0 lds
    buffer_load_dwordx4 v29, s[48:51], s10 offen offset:1024 lds
    buffer_load_dwordx4 v30, s[48:51], s10 offen offset:2048 lds
    buffer_load_dwordx4 v31, s[48:51], s10 offen offset:3072 lds
    s_add_u32 m0, m0, 4096
    s_add_u32 s10, s10, 196608
    s_sub_u32 s14, s14, 1
    s_cmp_lg_u32 s14, 0
    s_cbranch_scc1 dl_52
    s_mov_b32 m0, 49152
    s_add_u32 s10, s52, 787456
    s_mov_b32 s14, 2
dl_53:
    buffer_load_dwordx4 v28, s[48:51], s10 offen offset:0 lds
    buffer_load_dwordx4 v29, s[48:51], s10 offen offset:1024 lds
    buffer_load_dwordx4 v30, s[48:51], s10 offen offset:2048 lds
    buffer_load_dwordx4 v31, s[48:51], s10 offen offset:3072 lds
    s_add_u32 m0, m0, 4096
    s_add_u32 s10, s10, 196608
    s_sub_u32 s14, s14, 1
    s_cmp_lg_u32 s14, 0
    s_cbranch_scc1 dl_53
    s_mov_b32 m0, 81920
    s_add_u32 s10, s52, 788480
    s_mov_b32 s14, 2
dl_54:
    buffer_load_dwordx4 v28, s[48:51], s10 offen offset:0 lds
    buffer_load_dwordx4 v29, s[48:51], s10 offen offset:1024 lds
    buffer_load_dwordx4 v30, s[48:51], s10 offen offset:2048 lds
    buffer_load_dwordx4 v31, s[48:51], s10 offen offset:3072 lds
    s_add_u32 m0, m0, 4096
    s_add_u32 s10, s10, 196608
    s_sub_u32 s14, s14, 1
    s_cmp_lg_u32 s14, 0
    s_cbranch_scc1 dl_54
    s_waitcnt vmcnt(25)
    s_mov_b64 exec, 1
    buffer_store_dword v8, v6, s[44:47], s53 offen offset:64
    s_mov_b64 exec, -1
    ds_write_b32 v11, v1 offset:368
    s_mov_b32 m0, 24576
    s_add_u32 s10, s52, 1179648
    s_mov_b32 s14, 2
dl_55:
    buffer_load_dwordx4 v28, s[48:51], s10 offen offset:0 lds
    buffer_load_dwordx4 v29, s[48:51], s10 offen offset:1024 lds
    buffer_load_dwordx4 v30, s[48:51], s10 offen offset:2048 lds
    buffer_load_dwordx4 v31, s[48:51], s10 offen offset:3072 lds
    s_add_u32 m0, m0, 4096
    s_add_u32 s10, s10, 196608
    s_sub_u32 s14, s14, 1
    s_cmp_lg_u32 s14, 0
    s_cbranch_scc1 dl_55
    s_mov_b32 m0, 57344
    s_add_u32 s10, s52, 1180672
    s_mov_b32 s14, 2
dl_56:
    buffer_load_dwordx4 v28, s[48:51], s10 offen offset:0 lds
    buffer_load_dwordx4 v29, s[48:51], s10 offen offset:1024 lds
    buffer_load_dwordx4 v30, s[48:51], s10 offen offset:2048 lds
    buffer_load_dwordx4 v31, s[48:51], s10 offen offset:3072 lds
    s_add_u32 m0, m0, 4096
    s_add_u32 s10, s10, 196608
    s_sub_u32 s14, s14, 1
    s_cmp_lg_u32 s14, 0
    s_cbranch_scc1 dl_56
    s_mov_b32 m0, 90112
    s_add_u32 s10, s52, 1181696
    s_mov_b32 s14, 2
dl_57:
    buffer_load_dwordx4 v28, s[48:51], s10 offen offset:0 lds
    buffer_load_dwordx4 v29, s[48:51], s10 offen offset:1024 lds
    buffer_load_dwordx4 v30, s[48:51], s10 offen offset:2048 lds
    buffer_load_dwordx4 v31, s[48:51], s10 offen offset:3072 lds
    s_add_u32 m0, m0, 4096
    s_add_u32 s10, s10, 196608
    s_sub_u32 s14, s14, 1
    s_cmp_lg_u32 s14, 0
    s_cbranch_scc1 dl_57
    s_waitcnt vmcnt(25)
    s_mov_b64 exec, 1
    buffer_store_dword v8, v6, s[44:47], s53 offen offset:128
    s_mov_b64 exec, -1
    ds_write_b32 v11, v1 offset:384
    s_waitcnt vmcnt(1)
    s_mov_b64 exec, 1
    buffer_store_dword v8, v6, s[44:47], s53 offen offset:192
    s_mov_b64 exec, -1
    ds_write_b32 v11, v1 offset:400
kp_l_j:
    v_add_u32 v15, 0, v2
    v_mul_u32_u24 v16, 4682, v15
    v_lshrrev_b32 v16, 16, v16
    v_mul_u32_u24 v17, 14, v16
    v_sub_u32 v17, v15, v17
    v_mul_u32_u24 v16, 3584, v16
    v_lshl_add_u32 v20, v17, 4, v16
    v_add_u32 v15, 64, v2
    v_mul_u32_u24 v16, 4682, v15
    v_lshrrev_b32 v16, 16, v16
    v_mul_u32_u24 v17, 14, v16
    v_sub_u32 v17, v15, v17
    v_mul_u32_u24 v16, 3584, v16
    v_lshl_add_u32 v21, v17, 4, v16
    v_subrev_u32 v21, 1024, v21
    v_add_u32 v15, 128, v2
    v_mul_u32_u24 v16, 4682, v15
    v_lshrrev_b32 v16, 16, v16
    v_mul_u32_u24 v17, 14, v16
    v_sub_u32 v17, v15, v17
    v_mul_u32_u24 v16, 3584, v16
    v_lshl_add_u32 v22, v17, 4, v16
    v_subrev_u32 v22, 2048, v22
    v_add_u32 v15, 192, v2
    v_mul_u32_u24 v16, 4682, v15
    v_lshrrev_b32 v16, 16, v16
    v_mul_u32_u24 v17, 14, v16
    v_sub_u32 v17, v15, v17
    v_mul_u32_u24 v16, 3584, v16
    v_lshl_add_u32 v23, v17, 4, v16
    v_subrev_u32 v23, 3072, v23
    v_add_u32 v15, 256, v2
    v_mul_u32_u24 v16, 4682, v15
    v_lshrrev_b32 v16, 16, v16
    v_mul_u32_u24 v17, 14, v16
    v_sub_u32 v17, v15, v17
    v_mul_u32_u24 v16, 3584, v16
    v_lshl_add_u32 v24, v17, 4, v16
    v_add_u32 v15, 320, v2
    v_mul_u32_u24 v16, 4682, v15
    v_lshrrev_b32 v16, 16, v16
    v_mul_u32_u24 v17, 14, v16
    v_sub_u32 v17, v15, v17
    v_mul_u32_u24 v16, 3584, v16
    v_lshl_add_u32 v25, v17, 4, v16
    v_subrev_u32 v25, 1024, v25
    v_add_u32 v15, 384, v2
    v_mul_u32_u24 v16, 4682, v15
    v_lshrrev_b32 v16, 16, v16
    v_mul_u32_u24 v17, 14, v16
    v_sub_u32 v17, v15, v17
    v_mul_u32_u24 v16, 3584, v16
    v_lshl_add_u32 v26, v17, 4, v16
    v_subrev_u32 v26, 2048, v26
    s_lshl_b32 s52, s7, 7
    s_mov_b32 s48, s20
    s_mov_b32 s49, s21
    s_mov_b32 s50, 0x80000
    s_mov_b32 s51, 0x20000
    s_mov_b32 s15, 0
sp_58:
    s_sleep 1
    ds_read_b32 v9, v10 offset:800
    s_add_u32 s15, s15, 1
    s_cmp_gt_u32 s15, 4000000
    s_cbranch_scc1 sp_58_x
    s_waitcnt lgkmcnt(0)
    v_cmp_ne_u32 vcc, 1, v9
    s_cbranch_vccnz sp_58
sp_58_x:
    s_waitcnt lgkmcnt(0)
    s_mov_b32 m0, 98304
    s_add_u32 s10, s52, 0
    s_mov_b32 s14, 8
dl_59:
    buffer_load_dwordx4 v32, s[48:51], s10 offen offset:0 lds
    buffer_load_dwordx4 v33, s[48:51], s10 offen offset:1024 lds
    buffer_load_dwordx4 v34, s[48:51], s10 offen offset:2048 lds
    buffer_load_dwordx4 v35, s[48:51], s10 offen offset:3072 lds
    s_add_u32 m0, m0, 4096
    s_add_u32 s10, s10, 32768
    s_sub_u32 s14, s14, 1
    s_cmp_lg_u32 s14, 0
    s_cbranch_scc1 dl_59
    s_waitcnt vmcnt(0)
    ds_write_b32 v11, v1 offset:448
    s_mov_b32 s15, 0
sp_60:
    s_sleep 1
    ds_read_b32 v9, v18 offset:80
    s_add_u32 s15, s15, 1
    s_cmp_gt_u32 s15, 4000000
    s_cbranch_scc1 sp_60_x
    s_waitcnt lgkmcnt(0)
    v_cmp_ne_u32 vcc, 1, v9
    s_cbranch_vccnz sp_60
sp_60_x:
    s_waitcnt lgkmcnt(0)
    s_mov_b32 s15, 0
sp_61:
    s_sleep 1
    ds_read_b32 v9, v10 offset:416
    s_add_u32 s15, s15, 1
    s_cmp_gt_u32 s15, 4000000
    s_cbranch_scc1 sp_61_x
    s_waitcnt lgkmcnt(0)
    v_cmp_ne_u32 vcc, 1, v9
    s_cbranch_vccnz sp_61
sp_61_x:
    s_waitcnt lgkmcnt(0)
    s_mov_b32 s15, 0
sp_62:
    s_sleep 1
    ds_read_b32 v9, v10 offset:432
    s_add_u32 s15, s15, 1
    s_cmp_gt_u32 s15, 4000000
    s_cbranch_scc1 sp_62_x
    s_waitcnt lgkmcnt(0)
    v_cmp_ne_u32 vcc, 1, v9
    s_cbranch_vccnz sp_62
sp_62_x:
    s_waitcnt lgkmcnt(0)
    s_mov_b32 m0, 0
    s_add_u32 s10, s52, 262144
    s_mov_b32 s14, 8
dl_63:
    buffer_load_dwordx4 v32, s[48:51], s10 offen offset:0 lds
    buffer_load_dwordx4 v33, s[48:51], s10 offen offset:1024 lds
    buffer_load_dwordx4 v34, s[48:51], s10 offen offset:2048 lds
    buffer_load_dwordx4 v35, s[48:51], s10 offen offset:3072 lds
    s_add_u32 m0, m0, 4096
    s_add_u32 s10, s10, 32768
    s_sub_u32 s14, s14, 1
    s_cmp_lg_u32 s14, 0
    s_cbranch_scc1 dl_63
    s_waitcnt vmcnt(0)
    ds_write_b32 v11, v1 offset:464
    s_mov_b32 s48, s24
    s_mov_b32 s49, s25
    s_mov_b32 s50, 0x80000
    s_mov_b32 s51, 0x20000
    s_mov_b32 s15, 0
sp_64:
    s_sleep 1
    ds_read_b32 v9, v18 offset:80
    s_add_u32 s15, s15, 1
    s_cmp_gt_u32 s15, 4000000
    s_cbranch_scc1 sp_64_x
    s_waitcnt lgkmcnt(0)
    v_cmp_ne_u32 vcc, 1, v9
    s_cbranch_vccnz sp_64
sp_64_x:
    s_waitcnt lgkmcnt(0)
    s_mov_b32 m0, 32768
    s_add_u32 s10, s52, 0
    s_mov_b32 s14, 8
dl_65:
    s_waitcnt vmcnt(16)
    buffer_load_dwordx4 v32, s[48:51], s10 offen offset:0 lds
    buffer_load_dwordx4 v33, s[48:51], s10 offen offset:1024 lds
    buffer_load_dwordx4 v34, s[48:51], s10 offen offset:2048 lds
    buffer_load_dwordx4 v35, s[48:51], s10 offen offset:3072 lds
    s_add_u32 m0, m0, 4096
    s_add_u32 s10, s10, 32768
    s_sub_u32 s14, s14, 1
    s_cmp_lg_u32 s14, 0
    s_cbranch_scc1 dl_65
    s_mov_b32 m0, 65536
    s_add_u32 s10, s52, 262144
    s_mov_b32 s14, 8
dl_66:
    s_waitcnt vmcnt(16)
    buffer_load_dwordx4 v32, s[48:51], s10 offen offset:0 lds
    buffer_load_dwordx4 v33, s[48:51], s10 offen offset:1024 lds
    buffer_load_dwordx4 v34, s[48:51], s10 offen offset:2048 lds
    buffer_load_dwordx4 v35, s[48:51], s10 offen offset:3072 lds
    s_add_u32 m0, m0, 4096
    s_add_u32 s10, s10, 32768
    s_sub_u32 s14, s14, 1
    s_cmp_lg_u32 s14, 0
    s_cbranch_scc1 dl_66
    s_waitcnt vmcnt(0)
    ds_write_b32 v11, v1 offset:496
    s_mov_b32 s48, s26
    s_mov_b32 s49, s27
    s_mov_b32 s50, 0x80000
    s_mov_b32 s51, 0x20000
    s_mov_b32 s15, 0
sp_67:
    s_sleep 1
    ds_read_b32 v9, v18 offset:96
    s_add_u32 s15, s15, 1
    s_cmp_gt_u32 s15, 4000000
    s_cbranch_scc1 sp_67_x
    s_waitcnt lgkmcnt(0)
    v_cmp_ne_u32 vcc, 1, v9
    s_cbranch_vccnz sp_67
sp_67_x:
    s_waitcnt lgkmcnt(0)
    s_mov_b32 s15, 0
sp_68:
    s_sleep 1
    ds_read_b32 v9, v18 offset:96
    s_add_u32 s15, s15, 1
    s_cmp_gt_u32 s15, 4000000
    s_cbranch_scc1 sp_68_x
    s_waitcnt lgkmcnt(0)
    v_cmp_ne_u32 vcc, 1, v9
    s_cbranch_vccnz sp_68
sp_68_x:
    s_waitcnt lgkmcnt(0)
    s_mov_b32 m0, 98304
    s_add_u32 s10, s52, 0
    s_mov_b32 s14, 8
dl_69:
    s_waitcnt vmcnt(16)
    buffer_load_dwordx4 v32, s[48:51], s10 offen offset:0 lds
    buffer_load_dwordx4 v33, s[48:51], s10 offen offset:1024 lds
    buffer_load_dwordx4 v34, s[48:51], s10 offen offset:2048 lds
    buffer_load_dwordx4 v35, s[48:51], s10 offen offset:3072 lds
    s_add_u32 m0, m0, 4096
    s_add_u32 s10, s10, 32768
    s_sub_u32 s14, s14, 1
    s_cmp_lg_u32 s14, 0
    s_cbranch_scc1 dl_69
    s_mov_b32 m0, 0
    s_add_u32 s10, s52, 262144
    s_mov_b32 s14, 8
dl_70:
    s_waitcnt vmcnt(16)
    buffer_load_dwordx4 v32, s[48:51], s10 offen offset:0 lds
    buffer_load_dwordx4 v33, s[48:51], s10 offen offset:1024 lds
    buffer_load_dwordx4 v34, s[48:51], s10 offen offset:2048 lds
    buffer_load_dwordx4 v35, s[48:51], s10 offen offset:3072 lds
    s_add_u32 m0, m0, 4096
    s_add_u32 s10, s10, 32768
    s_sub_u32 s14, s14, 1
    s_cmp_lg_u32 s14, 0
    s_cbranch_scc1 dl_70
    s_waitcnt vmcnt(0)
    ds_write_b32 v11, v1 offset:512
    s_mov_b32 s48, s28
    s_mov_b32 s49, s29
    s_mov_b32 s50, 0x1c0000
    s_mov_b32 s51, 0x20000
    s_mul_i32 s52, s13, 224
    s_mov_b32 s15, 0
sp_71:
    s_sleep 1
    ds_read_b32 v9, v18 offset:112
    s_add_u32 s15, s15, 1
    s_cmp_gt_u32 s15, 4000000
    s_cbranch_scc1 sp_71_x
    s_waitcnt lgkmcnt(0)
    v_cmp_ne_u32 vcc, 1, v9
    s_cbranch_vccnz sp_71
sp_71_x:
    s_waitcnt lgkmcnt(0)
    s_mov_b32 s15, 0
sp_72:
    s_sleep 1
    ds_read_b32 v9, v10 offset:656
    s_add_u32 s15, s15, 1
    s_cmp_gt_u32 s15, 4000000
    s_cbranch_scc1 sp_72_x
    s_waitcnt lgkmcnt(0)
    v_cmp_ne_u32 vcc, 1, v9
    s_cbranch_vccnz sp_72
sp_72_x:
    s_waitcnt lgkmcnt(0)
    s_mov_b32 m0, 32768
    s_add_u32 s10, s52, 0
    s_mov_b32 s14, 9
w3_73:
    s_waitcnt vmcnt(16)
    buffer_load_dwordx4 v20, s[48:51], s10 offen offset:0 lds
    buffer_load_dwordx4 v21, s[48:51], s10 offen offset:1024 lds
    buffer_load_dwordx4 v22, s[48:51], s10 offen offset:2048 lds
    buffer_load_dwordx4 v23, s[48:51], s10 offen offset:3072 lds
    s_add_u32 m0, m0, 4096
    s_nop 0
    buffer_load_dwordx4 v24, s[48:51], s10 offen offset:0 lds
    buffer_load_dwordx4 v25, s[48:51], s10 offen offset:1024 lds
    buffer_load_dwordx4 v26, s[48:51], s10 offen offset:2048 lds
    s_add_u32 m0, m0, 3072
    s_add_u32 s10, s10, 114688
    s_sub_u32 s14, s14, 1
    s_cmp_lg_u32 s14, 0
    s_cbranch_scc1 w3_73
    s_waitcnt vmcnt(0)
    ds_write_b32 v11, v1 offset:528
    s_mov_b32 s15, 0
sp_74:
    s_sleep 1
    ds_read_b32 v9, v18 offset:48
    s_add_u32 s15, s15, 1
    s_cmp_gt_u32 s15, 4000000
    s_cbranch_scc1 sp_74_x
    s_waitcnt lgkmcnt(0)
    v_cmp_ne_u32 vcc, 1, v9
    s_cbranch_vccnz sp_74
sp_74_x:
    s_waitcnt lgkmcnt(0)
    s_mov_b32 m0, 131072
    s_add_u32 s10, s52, 1032192
    s_mov_b32 s14, 4
w3_75:
    s_waitcnt vmcnt(16)
    buffer_load_dwordx4 v20, s[48:51], s10 offen offset:0 lds
    buffer_load_dwordx4 v21, s[48:51], s10 offen offset:1024 lds
    buffer_load_dwordx4 v22, s[48:51], s10 offen offset:2048 lds
    buffer_load_dwordx4 v23, s[48:51], s10 offen offset:3072 lds
    s_add_u32 m0, m0, 4096
    s_nop 0
    buffer_load_dwordx4 v24, s[48:51], s10 offen offset:0 lds
    buffer_load_dwordx4 v25, s[48:51], s10 offen offset:1024 lds
    buffer_load_dwordx4 v26, s[48:51], s10 offen offset:2048 lds
    s_add_u32 m0, m0, 3072
    s_add_u32 s10, s10, 114688
    s_sub_u32 s14, s14, 1
    s_cmp_lg_u32 s14, 0
    s_cbranch_scc1 w3_75
    s_waitcnt vmcnt(0)
    ds_write_b32 v11, v1 offset:544
    s_mov_b32 s15, 0
sp_76:
    s_sleep 1
    ds_read_b32 v9, v18 offset:128
    s_add_u32 s15, s15, 1
    s_cmp_gt_u32 s15, 4000000
    s_cbranch_scc1 sp_76_x
    s_waitcnt lgkmcnt(0)
    v_cmp_ne_u32 vcc, 1, v9
    s_cbranch_vccnz sp_76
sp_76_x:
    s_waitcnt lgkmcnt(0)
    s_mov_b32 m0, 98304
    s_add_u32 s10, s52, 1490944
    s_mov_b32 s14, 3
w3_77:
    s_waitcnt vmcnt(16)
    buffer_load_dwordx4 v20, s[48:51], s10 offen offset:0 lds
    buffer_load_dwordx4 v21, s[48:51], s10 offen offset:1024 lds
    buffer_load_dwordx4 v22, s[48:51], s10 offen offset:2048 lds
    buffer_load_dwordx4 v23, s[48:51], s10 offen offset:3072 lds
    s_add_u32 m0, m0, 4096
    s_nop 0
    buffer_load_dwordx4 v24, s[48:51], s10 offen offset:0 lds
    buffer_load_dwordx4 v25, s[48:51], s10 offen offset:1024 lds
    buffer_load_dwordx4 v26, s[48:51], s10 offen offset:2048 lds
    s_add_u32 m0, m0, 3072
    s_add_u32 s10, s10, 114688
    s_sub_u32 s14, s14, 1
    s_cmp_lg_u32 s14, 0
    s_cbranch_scc1 w3_77
    s_waitcnt vmcnt(0)
    ds_write_b32 v11, v1 offset:560
    s_mov_b32 s48, s30
    s_mov_b32 s49, s31
    s_mov_b32 s50, 0x1c0000
    s_mov_b32 s51, 0x20000
    s_lshl_b32 s52, s7, 7
    s_mov_b32 s15, 0
sp_78:
    s_sleep 1
    ds_read_b32 v9, v18 offset:64
    s_add_u32 s15, s15, 1
    s_cmp_gt_u32 s15, 4000000
    s_cbranch_scc1 sp_78_x
    s_waitcnt lgkmcnt(0)
    v_cmp_ne_u32 vcc, 1, v9
    s_cbranch_vccnz sp_78
sp_78_x:
    s_waitcnt lgkmcnt(0)
    s_mov_b32 m0, 0
    s_add_u32 s10, s52, 0
    s_mov_b32 s14, 8
dl_79:
    s_waitcnt vmcnt(16)
    buffer_load_dwordx4 v32, s[48:51], s10 offen offset:0 lds
    buffer_load_dwordx4 v33, s[48:51], s10 offen offset:1024 lds
    buffer_load_dwordx4 v34, s[48:51], s10 offen offset:2048 lds
    buffer_load_dwordx4 v35, s[48:51], s10 offen offset:3072 lds
    s_add_u32 m0, m0, 4096
    s_add_u32 s10, s10, 32768
    s_sub_u32 s14, s14, 1
    s_cmp_lg_u32 s14, 0
    s_cbranch_scc1 dl_79
    s_mov_b32 m0, 122880
    s_add_u32 s10, s52, 262144
    s_mov_b32 s14, 2
dl_80:
    s_waitcnt vmcnt(16)
    buffer_load_dwordx4 v32, s[48:51], s10 offen offset:0 lds
    buffer_load_dwordx4 v33, s[48:51], s10 offen offset:1024 lds
    buffer_load_dwordx4 v34, s[48:51], s10 offen offset:2048 lds
    buffer_load_dwordx4 v35, s[48:51], s10 offen offset:3072 lds
    s_add_u32 m0, m0, 4096
    s_add_u32 s10, s10, 32768
    s_sub_u32 s14, s14, 1
    s_cmp_lg_u32 s14, 0
    s_cbranch_scc1 dl_80
    s_waitcnt vmcnt(0)
    ds_write_b32 v11, v1 offset:576
    s_mov_b32 s15, 0
sp_81:
    s_sleep 1
    ds_read_b32 v9, v18 offset:144
    s_add_u32 s15, s15, 1
    s_cmp_gt_u32 s15, 4000000
    s_cbranch_scc1 sp_81_x
    s_waitcnt lgkmcnt(0)
    v_cmp_ne_u32 vcc, 1, v9
    s_cbranch_vccnz sp_81
sp_81_x:
    s_waitcnt lgkmcnt(0)
    s_mov_b32 s15, 0
sp_82:
    s_sleep 1
    ds_read_b32 v9, v10 offset:672
    s_add_u32 s15, s15, 1
    s_cmp_gt_u32 s15, 4000000
    s_cbranch_scc1 sp_82_x
    s_waitcnt lgkmcnt(0)
    v_cmp_ne_u32 vcc, 1, v9
    s_cbranch_vccnz sp_82
sp_82_x:
    s_waitcnt lgkmcnt(0)
    s_mov_b32 m0, 32768
    s_add_u32 s10, s52, 327680
    s_mov_b32 s14, 14
dl_83:
    s_waitcnt vmcnt(16)
    buffer_load_dwordx4 v32, s[48:51], s10 offen offset:0 lds
    buffer_load_dwordx4 v33, s[48:51], s10 offen offset:1024 lds
    buffer_load_dwordx4 v34, s[48:51], s10 offen offset:2048 lds
    buffer_load_dwordx4 v35, s[48:51], s10 offen offset:3072 lds
    s_add_u32 m0, m0, 4096
    s_add_u32 s10, s10, 32768
    s_sub_u32 s14, s14, 1
    s_cmp_lg_u32 s14, 0
    s_cbranch_scc1 dl_83
    s_mov_b32 m0, 90112
    s_add_u32 s10, s52, 786432
    s_mov_b32 s14, 8
dl_84:
    s_waitcnt vmcnt(16)
    buffer_load_dwordx4 v32, s[48:51], s10 offen offset:0 lds
    buffer_load_dwordx4 v33, s[48:51], s10 offen offset:1024 lds
    buffer_load_dwordx4 v34, s[48:51], s10 offen offset:2048 lds
    buffer_load_dwordx4 v35, s[48:51], s10 offen offset:3072 lds
    s_add_u32 m0, m0, 4096
    s_add_u32 s10, s10, 32768
    s_sub_u32 s14, s14, 1
    s_cmp_lg_u32 s14, 0
    s_cbranch_scc1 dl_84
    s_waitcnt vmcnt(32)
    ds_write_b32 v11, v1 offset:592
    s_mov_b32 m0, 131072
    s_add_u32 s10, s52, 1048576
    s_mov_b32 s14, 6
dl_85:
    s_waitcnt vmcnt(16)
    buffer_load_dwordx4 v32, s[48:51], s10 offen offset:0 lds
    buffer_load_dwordx4 v33, s[48:51], s10 offen offset:1024 lds
    buffer_load_dwordx4 v34, s[48:51], s10 offen offset:2048 lds
    buffer_load_dwordx4 v35, s[48:51], s10 offen offset:3072 lds
    s_add_u32 m0, m0, 4096
    s_add_u32 s10, s10, 32768
    s_sub_u32 s14, s14, 1
    s_cmp_lg_u32 s14, 0
    s_cbranch_scc1 dl_85
    s_waitcnt vmcnt(0)
    ds_write_b32 v11, v1 offset:608
    s_mov_b32 s15, 0
sp_86:
    s_sleep 1
    ds_read_b32 v9, v18 offset:160
    s_add_u32 s15, s15, 1
    s_cmp_gt_u32 s15, 4000000
    s_cbranch_scc1 sp_86_x
    s_waitcnt lgkmcnt(0)
    v_cmp_ne_u32 vcc, 1, v9
    s_cbranch_vccnz sp_86
sp_86_x:
    s_waitcnt lgkmcnt(0)
    s_mov_b32 m0, 0
    s_add_u32 s10, s52, 1245184
    s_mov_b32 s14, 8
dl_87:
    s_waitcnt vmcnt(16)
    buffer_load_dwordx4 v32, s[48:51], s10 offen offset:0 lds
    buffer_load_dwordx4 v33, s[48:51], s10 offen offset:1024 lds
    buffer_load_dwordx4 v34, s[48:51], s10 offen offset:2048 lds
    buffer_load_dwordx4 v35, s[48:51], s10 offen offset:3072 lds
    s_add_u32 m0, m0, 4096
    s_add_u32 s10, s10, 32768
    s_sub_u32 s14, s14, 1
    s_cmp_lg_u32 s14, 0
    s_cbranch_scc1 dl_87
    s_mov_b32 m0, 122880
    s_add_u32 s10, s52, 1507328
    s_mov_b32 s14, 2
dl_88:
    s_waitcnt vmcnt(16)
    buffer_load_dwordx4 v32, s[48:51], s10 offen offset:0 lds
    buffer_load_dwordx4 v33, s[48:51], s10 offen offset:1024 lds
    buffer_load_dwordx4 v34, s[48:51], s10 offen offset:2048 lds
    buffer_load_dwordx4 v35, s[48:51], s10 offen offset:3072 lds
    s_add_u32 m0, m0, 4096
    s_add_u32 s10, s10, 32768
    s_sub_u32 s14, s14, 1
    s_cmp_lg_u32 s14, 0
    s_cbranch_scc1 dl_88
    s_waitcnt vmcnt(0)
    ds_write_b32 v11, v1 offset:624
    s_mov_b32 s15, 0
sp_89:
    s_sleep 1
    ds_read_b32 v9, v18 offset:176
    s_add_u32 s15, s15, 1
    s_cmp_gt_u32 s15, 4000000
    s_cbranch_scc1 sp_89_x
    s_waitcnt lgkmcnt(0)
    v_cmp_ne_u32 vcc, 1, v9
    s_cbranch_vccnz sp_89
sp_89_x:
    s_waitcnt lgkmcnt(0)
    s_mov_b32 m0, 32768
    s_add_u32 s10, s52, 1572864
    s_mov_b32 s14, 8
dl_90:
    s_waitcnt vmcnt(16)
    buffer_load_dwordx4 v32, s[48:51], s10 offen offset:0 lds
    buffer_load_dwordx4 v33, s[48:51], s10 offen offset:1024 lds
    buffer_load_dwordx4 v34, s[48:51], s10 offen offset:2048 lds
    buffer_load_dwordx4 v35, s[48:51], s10 offen offset:3072 lds
    s_add_u32 m0, m0, 4096
    s_add_u32 s10, s10, 32768
    s_sub_u32 s14, s14, 1
    s_cmp_lg_u32 s14, 0
    s_cbranch_scc1 dl_90
    s_mov_b32 s15, 0
sp_91:
    s_sleep 1
    ds_read_b32 v9, v18 offset:192
    s_add_u32 s15, s15, 1
    s_cmp_gt_u32 s15, 4000000
    s_cbranch_scc1 sp_91_x
    s_waitcnt lgkmcnt(0)
    v_cmp_ne_u32 vcc, 1, v9
    s_cbranch_vccnz sp_91
sp_91_x:
    s_waitcnt lgkmcnt(0)
    s_waitcnt vmcnt(0)
    ds_write_b32 v11, v1 offset:640
    s_endpgm
kp_aux2:
    s_setprio 0
    s_waitcnt lgkmcnt(0)
    s_load_dword s36, s[40:41], 0x0
    s_add_u32 s9, s4, 1
    s_lshl_b32 s9, s9, 21
    s_add_u32 s44, s40, s9
    s_addc_u32 s45, s41, 0
    s_mov_b32 s46, 0x200000
    s_mov_b32 s47, 0x20000
    s_mov_b32 s72, s40
    s_mov_b32 s73, s41
    s_mov_b32 s74, 0x2000000
    s_mov_b32 s75, 0x20000
    s_lshl_b32 s9, s4, 5
    s_add_u32 s42, s42, s9
    s_addc_u32 s43, s43, 0
    s_waitcnt lgkmcnt(0)
    s_mul_i32 s36, s36, 1664525
    s_add_u32 s36, s36, 1013904221
    s_or_b32 s36, s36, 1
    v_mov_b32 v8, s36
    v_bfe_u32 v12, v2, 2, 2
    v_lshl_add_u32 v12, v3, 3, v12
    v_lshlrev_b32 v12, 6, v12
    v_and_b32 v14, 3, v2
    v_lshl_add_u32 v12, v14, 3, v12
    v_and_b32 v14, 1, v3
    v_lshl_add_u32 v12, v14, 5, v12
    v_add_u32 v12, 65536, v12
    v_xor_b32 v13, 32, v12
    v_add_u32 v57, 141312, v5
    s_mov_b32 s15, 0
sp_92:
    s_sleep 2
    ds_read_b32 v9, v10 offset:704
    s_add_u32 s15, s15, 1
    s_cmp_gt_u32 s15, 4000000
    s_cbranch_scc1 sp_92_x
    s_waitcnt lgkmcnt(0)
    v_cmp_ne_u32 vcc, 1, v9
    s_cbranch_vccnz sp_92
sp_92_x:
    s_waitcnt lgkmcnt(0)
    ds_read_b128 a[0:3], v57 offset:0
    ds_read_b128 a[4:7], v57 offset:1024
    ds_read_b128 a[8:11], v57 offset:2048
    ds_read_b128 a[12:15], v57 offset:3072
    ds_read_b128 a[16:19], v57 offset:4096
    ds_read_b128 a[20:23], v57 offset:5120
    ds_read_b128 a[24:27], v57 offset:6144
    ds_read_b128 a[28:31], v57 offset:7168
    ds_read_b128 a[32:35], v57 offset:8192
    ds_read_b128 a[36:39], v57 offset:9216
    ds_read_b128 a[40:43], v57 offset:10240
    ds_read_b128 a[44:47], v57 offset:11264
    ds_read_b128 a[48:51], v57 offset:12288
    ds_read_b128 a[52:55], v57 offset:13312
    ds_read_b128 a[56:59], v57 offset:14336
    ds_read_b128 a[60:63], v57 offset:15360
    s_mov_b32 s15, 0
sp_93:
    s_sleep 1
    ds_read_b32 v9, v10 offset:352
    s_add_u32 s15, s15, 1
    s_cmp_gt_u32 s15, 4000000
    s_cbranch_scc1 sp_93_x
    s_waitcnt lgkmcnt(0)
    v_cmp_ne_u32 vcc, 1, v9
    s_cbranch_vccnz sp_93
sp_93_x:
    s_waitcnt lgkmcnt(0)
    ds_read_b64_tr_b16 v[24:25], v12 offset:0
    ds_read_b64_tr_b16 v[26:27], v12 offset:256
    ds_read_b64_tr_b16 v[28:29], v13 offset:0
    ds_read_b64_tr_b16 v[30:31], v13 offset:256
    ds_read_b64_tr_b16 v[32:33], v12 offset:2048
    ds_read_b64_tr_b16 v[34:35], v12 offset:2304
    ds_read_b64_tr_b16 v[36:37], v13 offset:2048
    ds_read_b64_tr_b16 v[38:39], v13 offset:2304
    ds_read_b64_tr_b16 v[40:41], v12 offset:4096
    ds_read_b64_tr_b16 v[42:43], v12 offset:4352
    ds_read_b64_tr_b16 v[44:45], v13 offset:4096
    ds_read_b64_tr_b16 v[46:47], v13 offset:4352
    ds_read_b64_tr_b16 v[48:49], v12 offset:6144
    ds_read_b64_tr_b16 v[50:51], v12 offset:6400
    ds_read_b64_tr_b16 v[52:53], v13 offset:6144
    ds_read_b64_tr_b16 v[54:55], v13 offset:6400
    s_waitcnt lgkmcnt(12)
    v_mfma_f32_16x16x32_bf16 v[16:19], a[0:3], v[24:27], 0
    v_mfma_f32_16x16x32_bf16 v[20:23], a[0:3], v[28:31], 0
    s_waitcnt lgkmcnt(8)
    v_mfma_f32_16x16x32_bf16 v[16:19], a[4:7], v[32:35], v[16:19]
    v_mfma_f32_16x16x32_bf16 v[20:23], a[4:7], v[36:39], v[20:23]
    s_waitcnt lgkmcnt(4)
    v_mfma_f32_16x16x32_bf16 v[16:19], a[8:11], v[40:43], v[16:19]
    v_mfma_f32_16x16x32_bf16 v[20:23], a[8:11], v[44:47], v[20:23]
    s_waitcnt lgkmcnt(0)
    v_mfma_f32_16x16x32_bf16 v[16:19], a[12:15], v[48:51], v[16:19]
    v_mfma_f32_16x16x32_bf16 v[20:23], a[12:15], v[52:55], v[20:23]
    s_mov_b32 s15, 0
sp_94:
    s_sleep 1
    ds_read_b32 v9, v10 offset:368
    s_add_u32 s15, s15, 1
    s_cmp_gt_u32 s15, 4000000
    s_cbranch_scc1 sp_94_x
    s_waitcnt lgkmcnt(0)
    v_cmp_ne_u32 vcc, 1, v9
    s_cbranch_vccnz sp_94
sp_94_x:
    s_waitcnt lgkmcnt(0)
    ds_read_b64_tr_b16 v[24:25], v12 offset:8192
    ds_read_b64_tr_b16 v[26:27], v12 offset:8448
    ds_read_b64_tr_b16 v[28:29], v13 offset:8192
    ds_read_b64_tr_b16 v[30:31], v13 offset:8448
    ds_read_b64_tr_b16 v[32:33], v12 offset:10240
    ds_read_b64_tr_b16 v[34:35], v12 offset:10496
    ds_read_b64_tr_b16 v[36:37], v13 offset:10240
    ds_read_b64_tr_b16 v[38:39], v13 offset:10496
    ds_read_b64_tr_b16 v[40:41], v12 offset:12288
    ds_read_b64_tr_b16 v[42:43], v12 offset:12544
    ds_read_b64_tr_b16 v[44:45], v13 offset:12288
    ds_read_b64_tr_b16 v[46:47], v13 offset:12544
    ds_read_b64_tr_b16 v[48:49], v12 offset:14336
    ds_read_b64_tr_b16 v[50:51], v12 offset:14592
    ds_read_b64_tr_b16 v[52:53], v13 offset:14336
    ds_read_b64_tr_b16 v[54:55], v13 offset:14592
    s_waitcnt lgkmcnt(12)
    v_mfma_f32_16x16x32_bf16 v[16:19], a[16:19], v[24:27], v[16:19]
    v_mfma_f32_16x16x32_bf16 v[20:23], a[16:19], v[28:31], v[20:23]
    s_waitcnt lgkmcnt(8)
    v_mfma_f32_16x16x32_bf16 v[16:19], a[20:23], v[32:35], v[16:19]
    v_mfma_f32_16x16x32_bf16 v[20:23], a[20:23], v[36:39], v[20:23]
    s_waitcnt lgkmcnt(4)
    v_mfma_f32_16x16x32_bf16 v[16:19], a[24:27], v[40:43], v[16:19]
    v_mfma_f32_16x16x32_bf16 v[20:23], a[24:27], v[44:47], v[20:23]
    s_waitcnt lgkmcnt(0)
    v_mfma_f32_16x16x32_bf16 v[16:19], a[28:31], v[48:51], v[16:19]
    v_mfma_f32_16x16x32_bf16 v[20:23], a[28:31], v[52:55], v[20:23]
    s_mov_b32 s15, 0
sp_95:
    s_sleep 1
    ds_read_b32 v9, v10 offset:384
    s_add_u32 s15, s15, 1
    s_cmp_gt_u32 s15, 4000000
    s_cbranch_scc1 sp_95_x
    s_waitcnt lgkmcnt(0)
    v_cmp_ne_u32 vcc, 1, v9
    s_cbranch_vccnz sp_95
sp_95_x:
    s_waitcnt lgkmcnt(0)
    ds_read_b64_tr_b16 v[24:25], v12 offset:16384
    ds_read_b64_tr_b16 v[26:27], v12 offset:16640
    ds_read_b64_tr_b16 v[28:29], v13 offset:16384
    ds_read_b64_tr_b16 v[30:31], v13 offset:16640
    ds_read_b64_tr_b16 v[32:33], v12 offset:18432
    ds_read_b64_tr_b16 v[34:35], v12 offset:18688
    ds_read_b64_tr_b16 v[36:37], v13 offset:18432
    ds_read_b64_tr_b16 v[38:39], v13 offset:18688
    ds_read_b64_tr_b16 v[40:41], v12 offset:20480
    ds_read_b64_tr_b16 v[42:43], v12 offset:20736
    ds_read_b64_tr_b16 v[44:45], v13 offset:20480
    ds_read_b64_tr_b16 v[46:47], v13 offset:20736
    ds_read_b64_tr_b16 v[48:49], v12 offset:22528
    ds_read_b64_tr_b16 v[50:51], v12 offset:22784
    ds_read_b64_tr_b16 v[52:53], v13 offset:22528
    ds_read_b64_tr_b16 v[54:55], v13 offset:22784
    s_waitcnt lgkmcnt(12)
    v_mfma_f32_16x16x32_bf16 v[16:19], a[32:35], v[24:27], v[16:19]
    v_mfma_f32_16x16x32_bf16 v[20:23], a[32:35], v[28:31], v[20:23]
    s_waitcnt lgkmcnt(8)
    v_mfma_f32_16x16x32_bf16 v[16:19], a[36:39], v[32:35], v[16:19]
    v_mfma_f32_16x16x32_bf16 v[20:23], a[36:39], v[36:39], v[20:23]
    s_waitcnt lgkmcnt(4)
    v_mfma_f32_16x16x32_bf16 v[16:19], a[40:43], v[40:43], v[16:19]
    v_mfma_f32_16x16x32_bf16 v[20:23], a[40:43], v[44:47], v[20:23]
    s_waitcnt lgkmcnt(0)
    v_mfma_f32_16x16x32_bf16 v[16:19], a[44:47], v[48:51], v[16:19]
    v_mfma_f32_16x16x32_bf16 v[20:23], a[44:47], v[52:55], v[20:23]
    s_mov_b32 s15, 0
sp_96:
    s_sleep 1
    ds_read_b32 v9, v10 offset:400
    s_add_u32 s15, s15, 1
    s_cmp_gt_u32 s15, 4000000
    s_cbranch_scc1 sp_96_x
    s_waitcnt lgkmcnt(0)
    v_cmp_ne_u32 vcc, 1, v9
    s_cbranch_vccnz sp_96
sp_96_x:
    s_waitcnt lgkmcnt(0)
    ds_read_b64_tr_b16 v[24:25], v12 offset:24576
    ds_read_b64_tr_b16 v[26:27], v12 offset:24832
    ds_read_b64_tr_b16 v[28:29], v13 offset:24576
    ds_read_b64_tr_b16 v[30:31], v13 offset:24832
    ds_read_b64_tr_b16 v[32:33], v12 offset:26624
    ds_read_b64_tr_b16 v[34:35], v12 offset:26880
    ds_read_b64_tr_b16 v[36:37], v13 offset:26624
    ds_read_b64_tr_b16 v[38:39], v13 offset:26880
    ds_read_b64_tr_b16 v[40:41], v12 offset:28672
    ds_read_b64_tr_b16 v[42:43], v12 offset:28928
    ds_read_b64_tr_b16 v[44:45], v13 offset:28672
    ds_read_b64_tr_b16 v[46:47], v13 offset:28928
    ds_read_b64_tr_b16 v[48:49], v12 offset:30720
    ds_read_b64_tr_b16 v[50:51], v12 offset:30976
    ds_read_b64_tr_b16 v[52:53], v13 offset:30720
    ds_read_b64_tr_b16 v[54:55], v13 offset:30976
    s_waitcnt lgkmcnt(12)
    v_mfma_f32_16x16x32_bf16 v[16:19], a[48:51], v[24:27], v[16:19]
    v_mfma_f32_16x16x32_bf16 v[20:23], a[48:51], v[28:31], v[20:23]
    s_waitcnt lgkmcnt(8)
    v_mfma_f32_16x16x32_bf16 v[16:19], a[52:55], v[32:35], v[16:19]
    v_mfma_f32_16x16x32_bf16 v[20:23], a[52:55], v[36:39], v[20:23]
    s_waitcnt lgkmcnt(4)
    v_mfma_f32_16x16x32_bf16 v[16:19], a[56:59], v[40:43], v[16:19]
    v_mfma_f32_16x16x32_bf16 v[20:23], a[56:59], v[44:47], v[20:23]
    s_waitcnt lgkmcnt(0)
    v_mfma_f32_16x16x32_bf16 v[16:19], a[60:63], v[48:51], v[16:19]
    v_mfma_f32_16x16x32_bf16 v[20:23], a[60:63], v[52:55], v[20:23]
    s_nop 6
    v_cvt_pk_bf16_f32 v24, v16, v17
    v_cvt_pk_bf16_f32 v25, v18, v19
    v_cvt_pk_bf16_f32 v26, v20, v21
    v_cvt_pk_bf16_f32 v27, v22, v23
    v_add_u32 v14, 132096, v5
    ds_write_b128 v14, v[24:27]
    s_waitcnt lgkmcnt(0)
    ds_write_b32 v11, v1 offset:432
    v_mov_b32 v20, 0x3f803f80
    v_mov_b32 v21, 0x3f803f80
    v_mov_b32 v22, 0x3f803f80
    v_mov_b32 v23, 0x3f803f80
    v_lshlrev_b32 v24, 4, v3
    v_add_u32 v24, 159744, v24
    s_setprio 0
    s_mov_b32 s15, 0
sp_97:
    s_sleep 2
    ds_read_b32 v9, v10 offset:480
    s_add_u32 s15, s15, 1
    s_cmp_gt_u32 s15, 4000000
    s_cbranch_scc1 sp_97_x
    s_waitcnt lgkmcnt(0)
    v_cmp_ne_u32 vcc, 1, v9
    s_cbranch_vccnz sp_97
sp_97_x:
    s_waitcnt lgkmcnt(0)
    s_mov_b32 s53, 0xc000
    s_mov_b32 s20, 0x07060302
    s_mov_b32 s21, 0x05040100
    s_mov_b32 s15, 0
sp_98:
    s_sleep 2
    buffer_load_dwordx4 v[56:59], v5, s[44:47], s53 offen offset:0 sc1
    buffer_load_dwordx4 v[60:63], v5, s[44:47], s53 offen offset:1024 sc1
    buffer_load_dwordx4 v[64:67], v5, s[44:47], s53 offen offset:2048 sc1
    buffer_load_dwordx4 v[68:71], v5, s[44:47], s53 offen offset:3072 sc1
    s_add_u32 s15, s15, 1
    s_cmp_gt_u32 s15, 100000
    s_cbranch_scc1 sp_98_x
    s_waitcnt vmcnt(0)
    v_xor_b32 v9, v8, v57
    v_xor_b32 v16, v8, v59
    v_or_b32 v9, v9, v16
    v_xor_b32 v16, v8, v61
    v_or_b32 v9, v9, v16
    v_xor_b32 v16, v8, v63
    v_or_b32 v9, v9, v16
    v_xor_b32 v16, v8, v65
    v_or_b32 v9, v9, v16
    v_xor_b32 v16, v8, v67
    v_or_b32 v9, v9, v16
    v_xor_b32 v16, v8, v69
    v_or_b32 v9, v9, v16
    v_xor_b32 v16, v8, v71
    v_or_b32 v9, v9, v16
    v_cmp_ne_u32 vcc, 0, v9
    s_cbranch_vccnz sp_98
sp_98_x:
    s_waitcnt vmcnt(0)
    v_lshlrev_b32 v12, 2, v2
    v_add_u32 v12, 141312, v12
    v_perm_b32 v57, v58, v56, s20
    v_perm_b32 v59, v58, v56, s21
    ds_write_b32 v12, v20 offset:0
    ds_write_b32 v12, v57 offset:1024
    ds_write_b32 v12, v59 offset:2048
    v_perm_b32 v61, v62, v60, s20
    v_perm_b32 v63, v62, v60, s21
    ds_write_b32 v12, v20 offset:256
    ds_write_b32 v12, v61 offset:1280
    ds_write_b32 v12, v63 offset:2304
    v_perm_b32 v65, v66, v64, s20
    v_perm_b32 v67, v66, v64, s21
    ds_write_b32 v12, v20 offset:512
    ds_write_b32 v12, v65 offset:1536
    ds_write_b32 v12, v67 offset:2560
    v_perm_b32 v69, v70, v68, s20
    v_perm_b32 v71, v70, v68, s21
    ds_write_b32 v12, v20 offset:768
    ds_write_b32 v12, v69 offset:1792
    ds_write_b32 v12, v71 offset:2816
    v_min_u32 v16, 2, v4
    v_lshlrev_b32 v12, 10, v16
    v_lshl_add_u32 v12, v3, 3, v12
    v_add_u32 v12, 141312, v12
    s_waitcnt lgkmcnt(0)
    ds_read2_b64 v[56:59], v12 offset0:0 offset1:4
    ds_read2_b64 v[60:63], v12 offset0:8 offset1:12
    ds_read2_b64 v[64:67], v12 offset0:16 offset1:20
    ds_read2_b64 v[68:71], v12 offset0:24 offset1:28
    ds_read2_b64 v[72:75], v12 offset0:32 offset1:36
    ds_read2_b64 v[76:79], v12 offset0:40 offset1:44
    ds_read2_b64 v[80:83], v12 offset0:48 offset1:52
    ds_read2_b64 v[84:87], v12 offset0:56 offset1:60
    ds_read2_b64 v[88:91], v12 offset0:64 offset1:68
    ds_read2_b64 v[92:95], v12 offset0:72 offset1:76
    ds_read2_b64 v[96:99], v12 offset0:80 offset1:84
    ds_read2_b64 v[100:103], v12 offset0:88 offset1:92
    ds_read2_b64 v[104:107], v12 offset0:96 offset1:100
    ds_read2_b64 v[108:111], v12 offset0:104 offset1:108
    ds_read2_b64 v[112:115], v12 offset0:112 offset1:116
    ds_read2_b64 v[116:119], v12 offset0:120 offset1:124
    v_lshlrev_b32 v120, 8, v16
    v_add_u32 v120, 2304, v120
    v_cmp_eq_u32 vcc, 0, v4
    s_nop 1
    v_cndmask_b32 v120, v120, 0, vcc
    v_add_u32 v120, v120, v24
    s_waitcnt lgkmcnt(0)
    v_mfma_f32_16x16x32_bf16 v[28:31], v[56:59], v[56:59], 0
    v_mfma_f32_16x16x32_bf16 v[28:31], v[60:63], v[60:63], v[28:31]
    v_mfma_f32_16x16x32_bf16 v[28:31], v[64:67], v[64:67], v[28:31]
    v_mfma_f32_16x16x32_bf16 v[28:31], v[68:71], v[68:71], v[28:31]
    v_mfma_f32_16x16x32_bf16 v[28:31], v[72:75], v[72:75], v[28:31]
    v_mfma_f32_16x16x32_bf16 v[28:31], v[76:79], v[76:79], v[28:31]
    v_mfma_f32_16x16x32_bf16 v[28:31], v[80:83], v[80:83], v[28:31]
    v_mfma_f32_16x16x32_bf16 v[28:31], v[84:87], v[84:87], v[28:31]
    v_mfma_f32_16x16x32_bf16 v[28:31], v[88:91], v[88:91], v[28:31]
    v_mfma_f32_16x16x32_bf16 v[28:31], v[92:95], v[92:95], v[28:31]
    v_mfma_f32_16x16x32_bf16 v[28:31], v[96:99], v[96:99], v[28:31]
    v_mfma_f32_16x16x32_bf16 v[28:31], v[100:103], v[100:103], v[28:31]
    v_mfma_f32_16x16x32_bf16 v[28:31], v[104:107], v[104:107], v[28:31]
    v_mfma_f32_16x16x32_bf16 v[28:31], v[108:111], v[108:111], v[28:31]
    v_mfma_f32_16x16x32_bf16 v[28:31], v[112:115], v[112:115], v[28:31]
    v_mfma_f32_16x16x32_bf16 v[28:31], v[116:119], v[116:119], v[28:31]
    v_add_u32 v16, 161520, v5
    s_mov_b64 exec, 6
    s_nop 5
    ds_write_b128 v16, v[28:31]
    s_mov_b64 exec, -1
    v_lshrrev_b32 v12, 2, v2
    v_lshlrev_b32 v12, 7, v12
    v_and_b32 v16, 3, v2
    v_lshl_add_u32 v12, v16, 3, v12
    v_bfe_u32 v16, v2, 3, 2
    v_lshl_add_u32 v12, v16, 5, v12
    v_add_u32 v12, 32768, v12
    v_xor_b32 v13, 32, v12
    v_xor_b32 v14, 64, v12
    v_xor_b32 v15, 96, v12
    s_mov_b32 s15, 0
sp_99:
    s_sleep 2
    ds_read_b32 v16, v10 offset:496
    s_add_u32 s15, s15, 1
    s_cmp_gt_u32 s15, 4000000
    s_cbranch_scc1 sp_99_x
    s_waitcnt lgkmcnt(0)
    v_cmp_ne_u32 vcc, 1, v16
    s_cbranch_vccnz sp_99
sp_99_x:
    s_waitcnt lgkmcnt(0)
    ds_read_b64_tr_b16 a[0:1], v12 offset:0
    ds_read_b64_tr_b16 a[2:3], v12 offset:2048
    ds_read_b64_tr_b16 a[4:5], v13 offset:0
    ds_read_b64_tr_b16 a[6:7], v13 offset:2048
    ds_read_b64_tr_b16 a[8:9], v14 offset:0
    ds_read_b64_tr_b16 a[10:11], v14 offset:2048
    ds_read_b64_tr_b16 a[12:13], v15 offset:0
    ds_read_b64_tr_b16 a[14:15], v15 offset:2048
    s_waitcnt lgkmcnt(6)
    v_mfma_f32_16x16x32_bf16 v[28:31], a[0:3], v[56:59], 0
    s_waitcnt lgkmcnt(4)
    v_mfma_f32_16x16x32_bf16 v[32:35], a[4:7], v[56:59], 0
    s_waitcnt lgkmcnt(2)
    v_mfma_f32_16x16x32_bf16 v[36:39], a[8:11], v[56:59], 0
    s_waitcnt lgkmcnt(0)
    v_mfma_f32_16x16x32_bf16 v[40:43], a[12:15], v[56:59], 0
    ds_read_b64_tr_b16 a[28:29], v12 offset:4096
    ds_read_b64_tr_b16 a[30:31], v12 offset:6144
    ds_read_b64_tr_b16 a[32:33], v13 offset:4096
    ds_read_b64_tr_b16 a[34:35], v13 offset:6144
    ds_read_b64_tr_b16 a[36:37], v14 offset:4096
    ds_read_b64_tr_b16 a[38:39], v14 offset:6144
    ds_read_b64_tr_b16 a[40:41], v15 offset:4096
    ds_read_b64_tr_b16 a[42:43], v15 offset:6144
    s_waitcnt lgkmcnt(6)
    v_mfma_f32_16x16x32_bf16 v[28:31], a[28:31], v[60:63], v[28:31]
    s_waitcnt lgkmcnt(4)
    v_mfma_f32_16x16x32_bf16 v[32:35], a[32:35], v[60:63], v[32:35]
    s_waitcnt lgkmcnt(2)
    v_mfma_f32_16x16x32_bf16 v[36:39], a[36:39], v[60:63], v[36:39]
    s_waitcnt lgkmcnt(0)
    v_mfma_f32_16x16x32_bf16 v[40:43], a[40:43], v[60:63], v[40:43]
    ds_read_b64_tr_b16 a[0:1], v12 offset:8192
    ds_read_b64_tr_b16 a[2:3], v12 offset:10240
    ds_read_b64_tr_b16 a[4:5], v13 offset:8192
    ds_read_b64_tr_b16 a[6:7], v13 offset:10240
    ds_read_b64_tr_b16 a[8:9], v14 offset:8192
    ds_read_b64_tr_b16 a[10:11], v14 offset:10240
    ds_read_b64_tr_b16 a[12:13], v15 offset:8192
    ds_read_b64_tr_b16 a[14:15], v15 offset:10240
    s_waitcnt lgkmcnt(6)
    v_mfma_f32_16x16x32_bf16 v[28:31], a[0:3], v[64:67], v[28:31]
    s_waitcnt lgkmcnt(4)
    v_mfma_f32_16x16x32_bf16 v[32:35], a[4:7], v[64:67], v[32:35]
    s_waitcnt lgkmcnt(2)
    v_mfma_f32_16x16x32_bf16 v[36:39], a[8:11], v[64:67], v[36:39]
    s_waitcnt lgkmcnt(0)
    v_mfma_f32_16x16x32_bf16 v[40:43], a[12:15], v[64:67], v[40:43]
    ds_read_b64_tr_b16 a[28:29], v12 offset:12288
    ds_read_b64_tr_b16 a[30:31], v12 offset:14336
    ds_read_b64_tr_b16 a[32:33], v13 offset:12288
    ds_read_b64_tr_b16 a[34:35], v13 offset:14336
    ds_read_b64_tr_b16 a[36:37], v14 offset:12288
    ds_read_b64_tr_b16 a[38:39], v14 offset:14336
    ds_read_b64_tr_b16 a[40:41], v15 offset:12288
    ds_read_b64_tr_b16 a[42:43], v15 offset:14336
    s_waitcnt lgkmcnt(6)
    v_mfma_f32_16x16x32_bf16 v[28:31], a[28:31], v[68:71], v[28:31]
    s_waitcnt lgkmcnt(4)
    v_mfma_f32_16x16x32_bf16 v[32:35], a[32:35], v[68:71], v[32:35]
    s_waitcnt lgkmcnt(2)
    v_mfma_f32_16x16x32_bf16 v[36:39], a[36:39], v[68:71], v[36:39]
    s_waitcnt lgkmcnt(0)
    v_mfma_f32_16x16x32_bf16 v[40:43], a[40:43], v[68:71], v[40:43]
    ds_read_b64_tr_b16 a[0:1], v12 offset:16384
    ds_read_b64_tr_b16 a[2:3], v12 offset:18432
    ds_read_b64_tr_b16 a[4:5], v13 offset:16384
    ds_read_b64_tr_b16 a[6:7], v13 offset:18432
    ds_read_b64_tr_b16 a[8:9], v14 offset:16384
    ds_read_b64_tr_b16 a[10:11], v14 offset:18432
    ds_read_b64_tr_b16 a[12:13], v15 offset:16384
    ds_read_b64_tr_b16 a[14:15], v15 offset:18432
    s_waitcnt lgkmcnt(6)
    v_mfma_f32_16x16x32_bf16 v[28:31], a[0:3], v[72:75], v[28:31]
    s_waitcnt lgkmcnt(4)
    v_mfma_f32_16x16x32_bf16 v[32:35], a[4:7], v[72:75], v[32:35]
    s_waitcnt lgkmcnt(2)
    v_mfma_f32_16x16x32_bf16 v[36:39], a[8:11], v[72:75], v[36:39]
    s_waitcnt lgkmcnt(0)
    v_mfma_f32_16x16x32_bf16 v[40:43], a[12:15], v[72:75], v[40:43]
    ds_read_b64_tr_b16 a[28:29], v12 offset:20480
    ds_read_b64_tr_b16 a[30:31], v12 offset:22528
    ds_read_b64_tr_b16 a[32:33], v13 offset:20480
    ds_read_b64_tr_b16 a[34:35], v13 offset:22528
    ds_read_b64_tr_b16 a[36:37], v14 offset:20480
    ds_read_b64_tr_b16 a[38:39], v14 offset:22528
    ds_read_b64_tr_b16 a[40:41], v15 offset:20480
    ds_read_b64_tr_b16 a[42:43], v15 offset:22528
    s_waitcnt lgkmcnt(6)
    v_mfma_f32_16x16x32_bf16 v[28:31], a[28:31], v[76:79], v[28:31]
    s_waitcnt lgkmcnt(4)
    v_mfma_f32_16x16x32_bf16 v[32:35], a[32:35], v[76:79], v[32:35]
    s_waitcnt lgkmcnt(2)
    v_mfma_f32_16x16x32_bf16 v[36:39], a[36:39], v[76:79], v[36:39]
    s_waitcnt lgkmcnt(0)
    v_mfma_f32_16x16x32_bf16 v[40:43], a[40:43], v[76:79], v[40:43]
    ds_read_b64_tr_b16 a[0:1], v12 offset:24576
    ds_read_b64_tr_b16 a[2:3], v12 offset:26624
    ds_read_b64_tr_b16 a[4:5], v13 offset:24576
    ds_read_b64_tr_b16 a[6:7], v13 offset:26624
    ds_read_b64_tr_b16 a[8:9], v14 offset:24576
    ds_read_b64_tr_b16 a[10:11], v14 offset:26624
    ds_read_b64_tr_b16 a[12:13], v15 offset:24576
    ds_read_b64_tr_b16 a[14:15], v15 offset:26624
    s_waitcnt lgkmcnt(6)
    v_mfma_f32_16x16x32_bf16 v[28:31], a[0:3], v[80:83], v[28:31]
    s_waitcnt lgkmcnt(4)
    v_mfma_f32_16x16x32_bf16 v[32:35], a[4:7], v[80:83], v[32:35]
    s_waitcnt lgkmcnt(2)
    v_mfma_f32_16x16x32_bf16 v[36:39], a[8:11], v[80:83], v[36:39]
    s_waitcnt lgkmcnt(0)
    v_mfma_f32_16x16x32_bf16 v[40:43], a[12:15], v[80:83], v[40:43]
    ds_read_b64_tr_b16 a[28:29], v12 offset:28672
    ds_read_b64_tr_b16 a[30:31], v12 offset:30720
    ds_read_b64_tr_b16 a[32:33], v13 offset:28672
    ds_read_b64_tr_b16 a[34:35], v13 offset:30720
    ds_read_b64_tr_b16 a[36:37], v14 offset:28672
    ds_read_b64_tr_b16 a[38:39], v14 offset:30720
    ds_read_b64_tr_b16 a[40:41], v15 offset:28672
    ds_read_b64_tr_b16 a[42:43], v15 offset:30720
    s_waitcnt lgkmcnt(6)
    v_mfma_f32_16x16x32_bf16 v[28:31], a[28:31], v[84:87], v[28:31]
    s_waitcnt lgkmcnt(4)
    v_mfma_f32_16x16x32_bf16 v[32:35], a[32:35], v[84:87], v[32:35]
    s_waitcnt lgkmcnt(2)
    v_mfma_f32_16x16x32_bf16 v[36:39], a[36:39], v[84:87], v[36:39]
    s_waitcnt lgkmcnt(0)
    v_mfma_f32_16x16x32_bf16 v[40:43], a[40:43], v[84:87], v[40:43]
    ds_read_b64_tr_b16 a[0:1], v12 offset:32768
    ds_read_b64_tr_b16 a[2:3], v12 offset:34816
    ds_read_b64_tr_b16 a[4:5], v13 offset:32768
    ds_read_b64_tr_b16 a[6:7], v13 offset:34816
    ds_read_b64_tr_b16 a[8:9], v14 offset:32768
    ds_read_b64_tr_b16 a[10:11], v14 offset:34816
    ds_read_b64_tr_b16 a[12:13], v15 offset:32768
    ds_read_b64_tr_b16 a[14:15], v15 offset:34816
    s_waitcnt lgkmcnt(6)
    v_mfma_f32_16x16x32_bf16 v[28:31], a[0:3], v[88:91], v[28:31]
    s_waitcnt lgkmcnt(4)
    v_mfma_f32_16x16x32_bf16 v[32:35], a[4:7], v[88:91], v[32:35]
    s_waitcnt lgkmcnt(2)
    v_mfma_f32_16x16x32_bf16 v[36:39], a[8:11], v[88:91], v[36:39]
    s_waitcnt lgkmcnt(0)
    v_mfma_f32_16x16x32_bf16 v[40:43], a[12:15], v[88:91], v[40:43]
    ds_read_b64_tr_b16 a[28:29], v12 offset:36864
    ds_read_b64_tr_b16 a[30:31], v12 offset:38912
    ds_read_b64_tr_b16 a[32:33], v13 offset:36864
    ds_read_b64_tr_b16 a[34:35], v13 offset:38912
    ds_read_b64_tr_b16 a[36:37], v14 offset:36864
    ds_read_b64_tr_b16 a[38:39], v14 offset:38912
    ds_read_b64_tr_b16 a[40:41], v15 offset:36864
    ds_read_b64_tr_b16 a[42:43], v15 offset:38912
    s_waitcnt lgkmcnt(6)
    v_mfma_f32_16x16x32_bf16 v[28:31], a[28:31], v[92:95], v[28:31]
    s_waitcnt lgkmcnt(4)
    v_mfma_f32_16x16x32_bf16 v[32:35], a[32:35], v[92:95], v[32:35]
    s_waitcnt lgkmcnt(2)
    v_mfma_f32_16x16x32_bf16 v[36:39], a[36:39], v[92:95], v[36:39]
    s_waitcnt lgkmcnt(0)
    v_mfma_f32_16x16x32_bf16 v[40:43], a[40:43], v[92:95], v[40:43]
    ds_read_b64_tr_b16 a[0:1], v12 offset:40960
    ds_read_b64_tr_b16 a[2:3], v12 offset:43008
    ds_read_b64_tr_b16 a[4:5], v13 offset:40960
    ds_read_b64_tr_b16 a[6:7], v13 offset:43008
    ds_read_b64_tr_b16 a[8:9], v14 offset:40960
    ds_read_b64_tr_b16 a[10:11], v14 offset:43008
    ds_read_b64_tr_b16 a[12:13], v15 offset:40960
    ds_read_b64_tr_b16 a[14:15], v15 offset:43008
    s_waitcnt lgkmcnt(6)
    v_mfma_f32_16x16x32_bf16 v[28:31], a[0:3], v[96:99], v[28:31]
    s_waitcnt lgkmcnt(4)
    v_mfma_f32_16x16x32_bf16 v[32:35], a[4:7], v[96:99], v[32:35]
    s_waitcnt lgkmcnt(2)
    v_mfma_f32_16x16x32_bf16 v[36:39], a[8:11], v[96:99], v[36:39]
    s_waitcnt lgkmcnt(0)
    v_mfma_f32_16x16x32_bf16 v[40:43], a[12:15], v[96:99], v[40:43]
    ds_read_b64_tr_b16 a[28:29], v12 offset:45056
    ds_read_b64_tr_b16 a[30:31], v12 offset:47104
    ds_read_b64_tr_b16 a[32:33], v13 offset:45056
    ds_read_b64_tr_b16 a[34:35], v13 offset:47104
    ds_read_b64_tr_b16 a[36:37], v14 offset:45056
    ds_read_b64_tr_b16 a[38:39], v14 offset:47104
    ds_read_b64_tr_b16 a[40:41], v15 offset:45056
    ds_read_b64_tr_b16 a[42:43], v15 offset:47104
    s_waitcnt lgkmcnt(6)
    v_mfma_f32_16x16x32_bf16 v[28:31], a[28:31], v[100:103], v[28:31]
    s_waitcnt lgkmcnt(4)
    v_mfma_f32_16x16x32_bf16 v[32:35], a[32:35], v[100:103], v[32:35]
    s_waitcnt lgkmcnt(2)
    v_mfma_f32_16x16x32_bf16 v[36:39], a[36:39], v[100:103], v[36:39]
    s_waitcnt lgkmcnt(0)
    v_mfma_f32_16x16x32_bf16 v[40:43], a[40:43], v[100:103], v[40:43]
    ds_read_b64_tr_b16 a[0:1], v12 offset:49152
    ds_read_b64_tr_b16 a[2:3], v12 offset:51200
    ds_read_b64_tr_b16 a[4:5], v13 offset:49152
    ds_read_b64_tr_b16 a[6:7], v13 offset:51200
    ds_read_b64_tr_b16 a[8:9], v14 offset:49152
    ds_read_b64_tr_b16 a[10:11], v14 offset:51200
    ds_read_b64_tr_b16 a[12:13], v15 offset:49152
    ds_read_b64_tr_b16 a[14:15], v15 offset:51200
    s_waitcnt lgkmcnt(6)
    v_mfma_f32_16x16x32_bf16 v[28:31], a[0:3], v[104:107], v[28:31]
    s_waitcnt lgkmcnt(4)
    v_mfma_f32_16x16x32_bf16 v[32:35], a[4:7], v[104:107], v[32:35]
    s_waitcnt lgkmcnt(2)
    v_mfma_f32_16x16x32_bf16 v[36:39], a[8:11], v[104:107], v[36:39]
    s_waitcnt lgkmcnt(0)
    v_mfma_f32_16x16x32_bf16 v[40:43], a[12:15], v[104:107], v[40:43]
    ds_read_b64_tr_b16 a[28:29], v12 offset:53248
    ds_read_b64_tr_b16 a[30:31], v12 offset:55296
    ds_read_b64_tr_b16 a[32:33], v13 offset:53248
    ds_read_b64_tr_b16 a[34:35], v13 offset:55296
    ds_read_b64_tr_b16 a[36:37], v14 offset:53248
    ds_read_b64_tr_b16 a[38:39], v14 offset:55296
    ds_read_b64_tr_b16 a[40:41], v15 offset:53248
    ds_read_b64_tr_b16 a[42:43], v15 offset:55296
    s_waitcnt lgkmcnt(6)
    v_mfma_f32_16x16x32_bf16 v[28:31], a[28:31], v[108:111], v[28:31]
    s_waitcnt lgkmcnt(4)
    v_mfma_f32_16x16x32_bf16 v[32:35], a[32:35], v[108:111], v[32:35]
    s_waitcnt lgkmcnt(2)
    v_mfma_f32_16x16x32_bf16 v[36:39], a[36:39], v[108:111], v[36:39]
    s_waitcnt lgkmcnt(0)
    v_mfma_f32_16x16x32_bf16 v[40:43], a[40:43], v[108:111], v[40:43]
    ds_read_b64_tr_b16 a[0:1], v12 offset:57344
    ds_read_b64_tr_b16 a[2:3], v12 offset:59392
    ds_read_b64_tr_b16 a[4:5], v13 offset:57344
    ds_read_b64_tr_b16 a[6:7], v13 offset:59392
    ds_read_b64_tr_b16 a[8:9], v14 offset:57344
    ds_read_b64_tr_b16 a[10:11], v14 offset:59392
    ds_read_b64_tr_b16 a[12:13], v15 offset:57344
    ds_read_b64_tr_b16 a[14:15], v15 offset:59392
    s_waitcnt lgkmcnt(6)
    v_mfma_f32_16x16x32_bf16 v[28:31], a[0:3], v[112:115], v[28:31]
    s_waitcnt lgkmcnt(4)
    v_mfma_f32_16x16x32_bf16 v[32:35], a[4:7], v[112:115], v[32:35]
    s_waitcnt lgkmcnt(2)
    v_mfma_f32_16x16x32_bf16 v[36:39], a[8:11], v[112:115], v[36:39]
    s_waitcnt lgkmcnt(0)
    v_mfma_f32_16x16x32_bf16 v[40:43], a[12:15], v[112:115], v[40:43]
    ds_read_b64_tr_b16 a[28:29], v12 offset:61440
    ds_read_b64_tr_b16 a[30:31], v12 offset:63488
    ds_read_b64_tr_b16 a[32:33], v13 offset:61440
    ds_read_b64_tr_b16 a[34:35], v13 offset:63488
    ds_read_b64_tr_b16 a[36:37], v14 offset:61440
    ds_read_b64_tr_b16 a[38:39], v14 offset:63488
    ds_read_b64_tr_b16 a[40:41], v15 offset:61440
    ds_read_b64_tr_b16 a[42:43], v15 offset:63488
    s_waitcnt lgkmcnt(6)
    v_mfma_f32_16x16x32_bf16 v[28:31], a[28:31], v[116:119], v[28:31]
    s_waitcnt lgkmcnt(4)
    v_mfma_f32_16x16x32_bf16 v[32:35], a[32:35], v[116:119], v[32:35]
    s_waitcnt lgkmcnt(2)
    v_mfma_f32_16x16x32_bf16 v[36:39], a[36:39], v[116:119], v[36:39]
    s_waitcnt lgkmcnt(0)
    v_mfma_f32_16x16x32_bf16 v[40:43], a[40:43], v[116:119], v[40:43]
    s_nop 1
    ds_write_b128 v120, v[28:31] offset:1024
    s_nop 0
    ds_write_b128 v120, v[32:35] offset:1088
    s_nop 0
    ds_write_b128 v120, v[36:39] offset:1152
    s_nop 0
    ds_write_b128 v120, v[40:43] offset:1216
    s_waitcnt lgkmcnt(0)
    ds_write_b32 v11, v1 offset:656
    s_setprio 0
    v_lshrrev_b32 v12, 2, v2
    v_mul_u32_u24 v12, 224, v12
    v_and_b32 v16, 3, v2
    v_lshl_add_u32 v12, v16, 3, v12
    s_mov_b32 s15, 0
sp_100:
    s_sleep 2
    ds_read_b32 v16, v10 offset:528
    s_add_u32 s15, s15, 1
    s_cmp_gt_u32 s15, 4000000
    s_cbranch_scc1 sp_100_x
    s_waitcnt lgkmcnt(0)
    v_cmp_ne_u32 vcc, 1, v16
    s_cbranch_vccnz sp_100
sp_100_x:
    s_waitcnt lgkmcnt(0)
    ds_read_b64_tr_b16 a[0:1], v12 offset:32768
    ds_read_b64_tr_b16 a[2:3], v12 offset:36352
    ds_read_b64_tr_b16 a[4:5], v12 offset:32800
    ds_read_b64_tr_b16 a[6:7], v12 offset:36384
    ds_read_b64_tr_b16 a[8:9], v12 offset:32832
    ds_read_b64_tr_b16 a[10:11], v12 offset:36416
    ds_read_b64_tr_b16 a[12:13], v12 offset:32864
    ds_read_b64_tr_b16 a[14:15], v12 offset:36448
    ds_read_b64_tr_b16 a[16:17], v12 offset:32896
    ds_read_b64_tr_b16 a[18:19], v12 offset:36480
    ds_read_b64_tr_b16 a[20:21], v12 offset:32928
    ds_read_b64_tr_b16 a[22:23], v12 offset:36512
    ds_read_b64_tr_b16 a[24:25], v12 offset:32960
    ds_read_b64_tr_b16 a[26:27], v12 offset:36544
    s_waitcnt lgkmcnt(12)
    v_mfma_f32_16x16x32_bf16 v[28:31], a[0:3], v[20:23], 0
    s_waitcnt lgkmcnt(10)
    v_mfma_f32_16x16x32_bf16 v[32:35], a[4:7], v[20:23], 0
    s_waitcnt lgkmcnt(8)
    v_mfma_f32_16x16x32_bf16 v[36:39], a[8:11], v[20:23], 0
    s_waitcnt lgkmcnt(6)
    v_mfma_f32_16x16x32_bf16 v[40:43], a[12:15], v[20:23], 0
    s_waitcnt lgkmcnt(4)
    v_mfma_f32_16x16x32_bf16 v[44:47], a[16:19], v[20:23], 0
    s_waitcnt lgkmcnt(2)
    v_mfma_f32_16x16x32_bf16 v[48:51], a[20:23], v[20:23], 0
    s_waitcnt lgkmcnt(0)
    v_mfma_f32_16x16x32_bf16 v[52:55], a[24:27], v[20:23], 0
    ds_read_b64_tr_b16 a[28:29], v12 offset:39936
    ds_read_b64_tr_b16 a[30:31], v12 offset:43520
    ds_read_b64_tr_b16 a[32:33], v12 offset:39968
    ds_read_b64_tr_b16 a[34:35], v12 offset:43552
    ds_read_b64_tr_b16 a[36:37], v12 offset:40000
    ds_read_b64_tr_b16 a[38:39], v12 offset:43584
    ds_read_b64_tr_b16 a[40:41], v12 offset:40032
    ds_read_b64_tr_b16 a[42:43], v12 offset:43616
    ds_read_b64_tr_b16 a[44:45], v12 offset:40064
    ds_read_b64_tr_b16 a[46:47], v12 offset:43648
    ds_read_b64_tr_b16 a[48:49], v12 offset:40096
    ds_read_b64_tr_b16 a[50:51], v12 offset:43680
    ds_read_b64_tr_b16 a[52:53], v12 offset:40128
    ds_read_b64_tr_b16 a[54:55], v12 offset:43712
    s_waitcnt lgkmcnt(12)
    v_mfma_f32_16x16x32_bf16 v[28:31], a[28:31], v[20:23], v[28:31]
    s_waitcnt lgkmcnt(10)
    v_mfma_f32_16x16x32_bf16 v[32:35], a[32:35], v[20:23], v[32:35]
    s_waitcnt lgkmcnt(8)
    v_mfma_f32_16x16x32_bf16 v[36:39], a[36:39], v[20:23], v[36:39]
    s_waitcnt lgkmcnt(6)
    v_mfma_f32_16x16x32_bf16 v[40:43], a[40:43], v[20:23], v[40:43]
    s_waitcnt lgkmcnt(4)
    v_mfma_f32_16x16x32_bf16 v[44:47], a[44:47], v[20:23], v[44:47]
    s_waitcnt lgkmcnt(2)
    v_mfma_f32_16x16x32_bf16 v[48:51], a[48:51], v[20:23], v[48:51]
    s_waitcnt lgkmcnt(0)
    v_mfma_f32_16x16x32_bf16 v[52:55], a[52:55], v[20:23], v[52:55]
    ds_read_b64_tr_b16 a[0:1], v12 offset:47104
    ds_read_b64_tr_b16 a[2:3], v12 offset:50688
    ds_read_b64_tr_b16 a[4:5], v12 offset:47136
    ds_read_b64_tr_b16 a[6:7], v12 offset:50720
    ds_read_b64_tr_b16 a[8:9], v12 offset:47168
    ds_read_b64_tr_b16 a[10:11], v12 offset:50752
    ds_read_b64_tr_b16 a[12:13], v12 offset:47200
    ds_read_b64_tr_b16 a[14:15], v12 offset:50784
    ds_read_b64_tr_b16 a[16:17], v12 offset:47232
    ds_read_b64_tr_b16 a[18:19], v12 offset:50816
    ds_read_b64_tr_b16 a[20:21], v12 offset:47264
    ds_read_b64_tr_b16 a[22:23], v12 offset:50848
    ds_read_b64_tr_b16 a[24:25], v12 offset:47296
    ds_read_b64_tr_b16 a[26:27], v12 offset:50880
    s_waitcnt lgkmcnt(12)
    v_mfma_f32_16x16x32_bf16 v[28:31], a[0:3], v[20:23], v[28:31]
    s_waitcnt lgkmcnt(10)
    v_mfma_f32_16x16x32_bf16 v[32:35], a[4:7], v[20:23], v[32:35]
    s_waitcnt lgkmcnt(8)
    v_mfma_f32_16x16x32_bf16 v[36:39], a[8:11], v[20:23], v[36:39]
    s_waitcnt lgkmcnt(6)
    v_mfma_f32_16x16x32_bf16 v[40:43], a[12:15], v[20:23], v[40:43]
    s_waitcnt lgkmcnt(4)
    v_mfma_f32_16x16x32_bf16 v[44:47], a[16:19], v[20:23], v[44:47]
    s_waitcnt lgkmcnt(2)
    v_mfma_f32_16x16x32_bf16 v[48:51], a[20:23], v[20:23], v[48:51]
    s_waitcnt lgkmcnt(0)
    v_mfma_f32_16x16x32_bf16 v[52:55], a[24:27], v[20:23], v[52:55]
    ds_read_b64_tr_b16 a[28:29], v12 offset:54272
    ds_read_b64_tr_b16 a[30:31], v12 offset:57856
    ds_read_b64_tr_b16 a[32:33], v12 offset:54304
    ds_read_b64_tr_b16 a[34:35], v12 offset:57888
    ds_read_b64_tr_b16 a[36:37], v12 offset:54336
    ds_read_b64_tr_b16 a[38:39], v12 offset:57920
    ds_read_b64_tr_b16 a[40:41], v12 offset:54368
    ds_read_b64_tr_b16 a[42:43], v12 offset:57952
    ds_read_b64_tr_b16 a[44:45], v12 offset:54400
    ds_read_b64_tr_b16 a[46:47], v12 offset:57984
    ds_read_b64_tr_b16 a[48:49], v12 offset:54432
    ds_read_b64_tr_b16 a[50:51], v12 offset:58016
    ds_read_b64_tr_b16 a[52:53], v12 offset:54464
    ds_read_b64_tr_b16 a[54:55], v12 offset:58048
    s_waitcnt lgkmcnt(12)
    v_mfma_f32_16x16x32_bf16 v[28:31], a[28:31], v[20:23], v[28:31]
    s_waitcnt lgkmcnt(10)
    v_mfma_f32_16x16x32_bf16 v[32:35], a[32:35], v[20:23], v[32:35]
    s_waitcnt lgkmcnt(8)
    v_mfma_f32_16x16x32_bf16 v[36:39], a[36:39], v[20:23], v[36:39]
    s_waitcnt lgkmcnt(6)
    v_mfma_f32_16x16x32_bf16 v[40:43], a[40:43], v[20:23], v[40:43]
    s_waitcnt lgkmcnt(4)
    v_mfma_f32_16x16x32_bf16 v[44:47], a[44:47], v[20:23], v[44:47]
    s_waitcnt lgkmcnt(2)
    v_mfma_f32_16x16x32_bf16 v[48:51], a[48:51], v[20:23], v[48:51]
    s_waitcnt lgkmcnt(0)
    v_mfma_f32_16x16x32_bf16 v[52:55], a[52:55], v[20:23], v[52:55]
    ds_read_b64_tr_b16 a[0:1], v12 offset:61440
    ds_read_b64_tr_b16 a[2:3], v12 offset:65024
    ds_read_b64_tr_b16 a[4:5], v12 offset:61472
    ds_read_b64_tr_b16 a[6:7], v12 offset:65056
    ds_read_b64_tr_b16 a[8:9], v12 offset:61504
    ds_read_b64_tr_b16 a[10:11], v12 offset:65088
    ds_read_b64_tr_b16 a[12:13], v12 offset:61536
    ds_read_b64_tr_b16 a[14:15], v12 offset:65120
    ds_read_b64_tr_b16 a[16:17], v12 offset:61568
    ds_read_b64_tr_b16 a[18:19], v12 offset:65152
    ds_read_b64_tr_b16 a[20:21], v12 offset:61600
    ds_read_b64_tr_b16 a[22:23], v12 offset:65184
    ds_read_b64_tr_b16 a[24:25], v12 offset:61632
    ds_read_b64_tr_b16 a[26:27], v12 offset:65216
    s_waitcnt lgkmcnt(12)
    v_mfma_f32_16x16x32_bf16 v[28:31], a[0:3], v[20:23], v[28:31]
    s_waitcnt lgkmcnt(10)
    v_mfma_f32_16x16x32_bf16 v[32:35], a[4:7], v[20:23], v[32:35]
    s_waitcnt lgkmcnt(8)
    v_mfma_f32_16x16x32_bf16 v[36:39], a[8:11], v[20:23], v[36:39]
    s_waitcnt lgkmcnt(6)
    v_mfma_f32_16x16x32_bf16 v[40:43], a[12:15], v[20:23], v[40:43]
    s_waitcnt lgkmcnt(4)
    v_mfma_f32_16x16x32_bf16 v[44:47], a[16:19], v[20:23], v[44:47]
    s_waitcnt lgkmcnt(2)
    v_mfma_f32_16x16x32_bf16 v[48:51], a[20:23], v[20:23], v[48:51]
    s_waitcnt lgkmcnt(0)
    v_mfma_f32_16x16x32_bf16 v[52:55], a[24:27], v[20:23], v[52:55]
    v_add_u32 v12, 0x10000, v12
    ds_read_b64_tr_b16 a[28:29], v12 offset:3072
    ds_read_b64_tr_b16 a[30:31], v12 offset:6656
    ds_read_b64_tr_b16 a[32:33], v12 offset:3104
    ds_read_b64_tr_b16 a[34:35], v12 offset:6688
    ds_read_b64_tr_b16 a[36:37], v12 offset:3136
    ds_read_b64_tr_b16 a[38:39], v12 offset:6720
    ds_read_b64_tr_b16 a[40:41], v12 offset:3168
    ds_read_b64_tr_b16 a[42:43], v12 offset:6752
    ds_read_b64_tr_b16 a[44:45], v12 offset:3200
    ds_read_b64_tr_b16 a[46:47], v12 offset:6784
    ds_read_b64_tr_b16 a[48:49], v12 offset:3232
    ds_read_b64_tr_b16 a[50:51], v12 offset:6816
    ds_read_b64_tr_b16 a[52:53], v12 offset:3264
    ds_read_b64_tr_b16 a[54:55], v12 offset:6848
    s_waitcnt lgkmcnt(12)
    v_mfma_f32_16x16x32_bf16 v[28:31], a[28:31], v[20:23], v[28:31]
    s_waitcnt lgkmcnt(10)
    v_mfma_f32_16x16x32_bf16 v[32:35], a[32:35], v[20:23], v[32:35]
    s_waitcnt lgkmcnt(8)
    v_mfma_f32_16x16x32_bf16 v[36:39], a[36:39], v[20:23], v[36:39]
    s_waitcnt lgkmcnt(6)
    v_mfma_f32_16x16x32_bf16 v[40:43], a[40:43], v[20:23], v[40:43]
    s_waitcnt lgkmcnt(4)
    v_mfma_f32_16x16x32_bf16 v[44:47], a[44:47], v[20:23], v[44:47]
    s_waitcnt lgkmcnt(2)
    v_mfma_f32_16x16x32_bf16 v[48:51], a[48:51], v[20:23], v[48:51]
    s_waitcnt lgkmcnt(0)
    v_mfma_f32_16x16x32_bf16 v[52:55], a[52:55], v[20:23], v[52:55]
    ds_read_b64_tr_b16 a[0:1], v12 offset:10240
    ds_read_b64_tr_b16 a[2:3], v12 offset:13824
    ds_read_b64_tr_b16 a[4:5], v12 offset:10272
    ds_read_b64_tr_b16 a[6:7], v12 offset:13856
    ds_read_b64_tr_b16 a[8:9], v12 offset:10304
    ds_read_b64_tr_b16 a[10:11], v12 offset:13888
    ds_read_b64_tr_b16 a[12:13], v12 offset:10336
    ds_read_b64_tr_b16 a[14:15], v12 offset:13920
    ds_read_b64_tr_b16 a[16:17], v12 offset:10368
    ds_read_b64_tr_b16 a[18:19], v12 offset:13952
    ds_read_b64_tr_b16 a[20:21], v12 offset:10400
    ds_read_b64_tr_b16 a[22:23], v12 offset:13984
    ds_read_b64_tr_b16 a[24:25], v12 offset:10432
    ds_read_b64_tr_b16 a[26:27], v12 offset:14016
    s_waitcnt lgkmcnt(12)
    v_mfma_f32_16x16x32_bf16 v[28:31], a[0:3], v[20:23], v[28:31]
    s_waitcnt lgkmcnt(10)
    v_mfma_f32_16x16x32_bf16 v[32:35], a[4:7], v[20:23], v[32:35]
    s_waitcnt lgkmcnt(8)
    v_mfma_f32_16x16x32_bf16 v[36:39], a[8:11], v[20:23], v[36:39]
    s_waitcnt lgkmcnt(6)
    v_mfma_f32_16x16x32_bf16 v[40:43], a[12:15], v[20:23], v[40:43]
    s_waitcnt lgkmcnt(4)
    v_mfma_f32_16x16x32_bf16 v[44:47], a[16:19], v[20:23], v[44:47]
    s_waitcnt lgkmcnt(2)
    v_mfma_f32_16x16x32_bf16 v[48:51], a[20:23], v[20:23], v[48:51]
    s_waitcnt lgkmcnt(0)
    v_mfma_f32_16x16x32_bf16 v[52:55], a[24:27], v[20:23], v[52:55]
    ds_read_b64_tr_b16 a[28:29], v12 offset:17408
    ds_read_b64_tr_b16 a[30:31], v12 offset:20992
    ds_read_b64_tr_b16 a[32:33], v12 offset:17440
    ds_read_b64_tr_b16 a[34:35], v12 offset:21024
    ds_read_b64_tr_b16 a[36:37], v12 offset:17472
    ds_read_b64_tr_b16 a[38:39], v12 offset:21056
    ds_read_b64_tr_b16 a[40:41], v12 offset:17504
    ds_read_b64_tr_b16 a[42:43], v12 offset:21088
    ds_read_b64_tr_b16 a[44:45], v12 offset:17536
    ds_read_b64_tr_b16 a[46:47], v12 offset:21120
    ds_read_b64_tr_b16 a[48:49], v12 offset:17568
    ds_read_b64_tr_b16 a[50:51], v12 offset:21152
    ds_read_b64_tr_b16 a[52:53], v12 offset:17600
    ds_read_b64_tr_b16 a[54:55], v12 offset:21184
    s_waitcnt lgkmcnt(12)
    v_mfma_f32_16x16x32_bf16 v[28:31], a[28:31], v[20:23], v[28:31]
    s_waitcnt lgkmcnt(10)
    v_mfma_f32_16x16x32_bf16 v[32:35], a[32:35], v[20:23], v[32:35]
    s_waitcnt lgkmcnt(8)
    v_mfma_f32_16x16x32_bf16 v[36:39], a[36:39], v[20:23], v[36:39]
    s_waitcnt lgkmcnt(6)
    v_mfma_f32_16x16x32_bf16 v[40:43], a[40:43], v[20:23], v[40:43]
    s_waitcnt lgkmcnt(4)
    v_mfma_f32_16x16x32_bf16 v[44:47], a[44:47], v[20:23], v[44:47]
    s_waitcnt lgkmcnt(2)
    v_mfma_f32_16x16x32_bf16 v[48:51], a[48:51], v[20:23], v[48:51]
    s_waitcnt lgkmcnt(0)
    v_mfma_f32_16x16x32_bf16 v[52:55], a[52:55], v[20:23], v[52:55]
    ds_read_b64_tr_b16 a[0:1], v12 offset:24576
    ds_read_b64_tr_b16 a[2:3], v12 offset:28160
    ds_read_b64_tr_b16 a[4:5], v12 offset:24608
    ds_read_b64_tr_b16 a[6:7], v12 offset:28192
    ds_read_b64_tr_b16 a[8:9], v12 offset:24640
    ds_read_b64_tr_b16 a[10:11], v12 offset:28224
    ds_read_b64_tr_b16 a[12:13], v12 offset:24672
    ds_read_b64_tr_b16 a[14:15], v12 offset:28256
    ds_read_b64_tr_b16 a[16:17], v12 offset:24704
    ds_read_b64_tr_b16 a[18:19], v12 offset:28288
    ds_read_b64_tr_b16 a[20:21], v12 offset:24736
    ds_read_b64_tr_b16 a[22:23], v12 offset:28320
    ds_read_b64_tr_b16 a[24:25], v12 offset:24768
    ds_read_b64_tr_b16 a[26:27], v12 offset:28352
    s_waitcnt lgkmcnt(12)
    v_mfma_f32_16x16x32_bf16 v[28:31], a[0:3], v[20:23], v[28:31]
    s_waitcnt lgkmcnt(10)
    v_mfma_f32_16x16x32_bf16 v[32:35], a[4:7], v[20:23], v[32:35]
    s_waitcnt lgkmcnt(8)
    v_mfma_f32_16x16x32_bf16 v[36:39], a[8:11], v[20:23], v[36:39]
    s_waitcnt lgkmcnt(6)
    v_mfma_f32_16x16x32_bf16 v[40:43], a[12:15], v[20:23], v[40:43]
    s_waitcnt lgkmcnt(4)
    v_mfma_f32_16x16x32_bf16 v[44:47], a[16:19], v[20:23], v[44:47]
    s_waitcnt lgkmcnt(2)
    v_mfma_f32_16x16x32_bf16 v[48:51], a[20:23], v[20:23], v[48:51]
    s_waitcnt lgkmcnt(0)
    v_mfma_f32_16x16x32_bf16 v[52:55], a[24:27], v[20:23], v[52:55]
    ds_write_b32 v11, v1 offset:224
    s_mov_b32 s15, 0
sp_101:
    s_sleep 2
    ds_read_b32 v16, v10 offset:544
    s_add_u32 s15, s15, 1
    s_cmp_gt_u32 s15, 4000000
    s_cbranch_scc1 sp_101_x
    s_waitcnt lgkmcnt(0)
    v_cmp_ne_u32 vcc, 1, v16
    s_cbranch_vccnz sp_101
sp_101_x:
    s_waitcnt lgkmcnt(0)
    v_add_u32 v12, 0x10000, v12
    ds_read_b64_tr_b16 a[28:29], v12 offset:0
    ds_read_b64_tr_b16 a[30:31], v12 offset:3584
    ds_read_b64_tr_b16 a[32:33], v12 offset:32
    ds_read_b64_tr_b16 a[34:35], v12 offset:3616
    ds_read_b64_tr_b16 a[36:37], v12 offset:64
    ds_read_b64_tr_b16 a[38:39], v12 offset:3648
    ds_read_b64_tr_b16 a[40:41], v12 offset:96
    ds_read_b64_tr_b16 a[42:43], v12 offset:3680
    ds_read_b64_tr_b16 a[44:45], v12 offset:128
    ds_read_b64_tr_b16 a[46:47], v12 offset:3712
    ds_read_b64_tr_b16 a[48:49], v12 offset:160
    ds_read_b64_tr_b16 a[50:51], v12 offset:3744
    ds_read_b64_tr_b16 a[52:53], v12 offset:192
    ds_read_b64_tr_b16 a[54:55], v12 offset:3776
    s_waitcnt lgkmcnt(12)
    v_mfma_f32_16x16x32_bf16 v[28:31], a[28:31], v[20:23], v[28:31]
    s_waitcnt lgkmcnt(10)
    v_mfma_f32_16x16x32_bf16 v[32:35], a[32:35], v[20:23], v[32:35]
    s_waitcnt lgkmcnt(8)
    v_mfma_f32_16x16x32_bf16 v[36:39], a[36:39], v[20:23], v[36:39]
    s_waitcnt lgkmcnt(6)
    v_mfma_f32_16x16x32_bf16 v[40:43], a[40:43], v[20:23], v[40:43]
    s_waitcnt lgkmcnt(4)
    v_mfma_f32_16x16x32_bf16 v[44:47], a[44:47], v[20:23], v[44:47]
    s_waitcnt lgkmcnt(2)
    v_mfma_f32_16x16x32_bf16 v[48:51], a[48:51], v[20:23], v[48:51]
    s_waitcnt lgkmcnt(0)
    v_mfma_f32_16x16x32_bf16 v[52:55], a[52:55], v[20:23], v[52:55]
    ds_read_b64_tr_b16 a[0:1], v12 offset:7168
    ds_read_b64_tr_b16 a[2:3], v12 offset:10752
    ds_read_b64_tr_b16 a[4:5], v12 offset:7200
    ds_read_b64_tr_b16 a[6:7], v12 offset:10784
    ds_read_b64_tr_b16 a[8:9], v12 offset:7232
    ds_read_b64_tr_b16 a[10:11], v12 offset:10816
    ds_read_b64_tr_b16 a[12:13], v12 offset:7264
    ds_read_b64_tr_b16 a[14:15], v12 offset:10848
    ds_read_b64_tr_b16 a[16:17], v12 offset:7296
    ds_read_b64_tr_b16 a[18:19], v12 offset:10880
    ds_read_b64_tr_b16 a[20:21], v12 offset:7328
    ds_read_b64_tr_b16 a[22:23], v12 offset:10912
    ds_read_b64_tr_b16 a[24:25], v12 offset:7360
    ds_read_b64_tr_b16 a[26:27], v12 offset:10944
    s_waitcnt lgkmcnt(12)
    v_mfma_f32_16x16x32_bf16 v[28:31], a[0:3], v[20:23], v[28:31]
    s_waitcnt lgkmcnt(10)
    v_mfma_f32_16x16x32_bf16 v[32:35], a[4:7], v[20:23], v[32:35]
    s_waitcnt lgkmcnt(8)
    v_mfma_f32_16x16x32_bf16 v[36:39], a[8:11], v[20:23], v[36:39]
    s_waitcnt lgkmcnt(6)
    v_mfma_f32_16x16x32_bf16 v[40:43], a[12:15], v[20:23], v[40:43]
    s_waitcnt lgkmcnt(4)
    v_mfma_f32_16x16x32_bf16 v[44:47], a[16:19], v[20:23], v[44:47]
    s_waitcnt lgkmcnt(2)
    v_mfma_f32_16x16x32_bf16 v[48:51], a[20:23], v[20:23], v[48:51]
    s_waitcnt lgkmcnt(0)
    v_mfma_f32_16x16x32_bf16 v[52:55], a[24:27], v[20:23], v[52:55]
    ds_read_b64_tr_b16 a[28:29], v12 offset:14336
    ds_read_b64_tr_b16 a[30:31], v12 offset:17920
    ds_read_b64_tr_b16 a[32:33], v12 offset:14368
    ds_read_b64_tr_b16 a[34:35], v12 offset:17952
    ds_read_b64_tr_b16 a[36:37], v12 offset:14400
    ds_read_b64_tr_b16 a[38:39], v12 offset:17984
    ds_read_b64_tr_b16 a[40:41], v12 offset:14432
    ds_read_b64_tr_b16 a[42:43], v12 offset:18016
    ds_read_b64_tr_b16 a[44:45], v12 offset:14464
    ds_read_b64_tr_b16 a[46:47], v12 offset:18048
    ds_read_b64_tr_b16 a[48:49], v12 offset:14496
    ds_read_b64_tr_b16 a[50:51], v12 offset:18080
    ds_read_b64_tr_b16 a[52:53], v12 offset:14528
    ds_read_b64_tr_b16 a[54:55], v12 offset:18112
    s_waitcnt lgkmcnt(12)
    v_mfma_f32_16x16x32_bf16 v[28:31], a[28:31], v[20:23], v[28:31]
    s_waitcnt lgkmcnt(10)
    v_mfma_f32_16x16x32_bf16 v[32:35], a[32:35], v[20:23], v[32:35]
    s_waitcnt lgkmcnt(8)
    v_mfma_f32_16x16x32_bf16 v[36:39], a[36:39], v[20:23], v[36:39]
    s_waitcnt lgkmcnt(6)
    v_mfma_f32_16x16x32_bf16 v[40:43], a[40:43], v[20:23], v[40:43]
    s_waitcnt lgkmcnt(4)
    v_mfma_f32_16x16x32_bf16 v[44:47], a[44:47], v[20:23], v[44:47]
    s_waitcnt lgkmcnt(2)
    v_mfma_f32_16x16x32_bf16 v[48:51], a[48:51], v[20:23], v[48:51]
    s_waitcnt lgkmcnt(0)
    v_mfma_f32_16x16x32_bf16 v[52:55], a[52:55], v[20:23], v[52:55]
    ds_read_b64_tr_b16 a[0:1], v12 offset:21504
    ds_read_b64_tr_b16 a[2:3], v12 offset:25088
    ds_read_b64_tr_b16 a[4:5], v12 offset:21536
    ds_read_b64_tr_b16 a[6:7], v12 offset:25120
    ds_read_b64_tr_b16 a[8:9], v12 offset:21568
    ds_read_b64_tr_b16 a[10:11], v12 offset:25152
    ds_read_b64_tr_b16 a[12:13], v12 offset:21600
    ds_read_b64_tr_b16 a[14:15], v12 offset:25184
    ds_read_b64_tr_b16 a[16:17], v12 offset:21632
    ds_read_b64_tr_b16 a[18:19], v12 offset:25216
    ds_read_b64_tr_b16 a[20:21], v12 offset:21664
    ds_read_b64_tr_b16 a[22:23], v12 offset:25248
    ds_read_b64_tr_b16 a[24:25], v12 offset:21696
    ds_read_b64_tr_b16 a[26:27], v12 offset:25280
    s_waitcnt lgkmcnt(12)
    v_mfma_f32_16x16x32_bf16 v[28:31], a[0:3], v[20:23], v[28:31]
    s_waitcnt lgkmcnt(10)
    v_mfma_f32_16x16x32_bf16 v[32:35], a[4:7], v[20:23], v[32:35]
    s_waitcnt lgkmcnt(8)
    v_mfma_f32_16x16x32_bf16 v[36:39], a[8:11], v[20:23], v[36:39]
    s_waitcnt lgkmcnt(6)
    v_mfma_f32_16x16x32_bf16 v[40:43], a[12:15], v[20:23], v[40:43]
    s_waitcnt lgkmcnt(4)
    v_mfma_f32_16x16x32_bf16 v[44:47], a[16:19], v[20:23], v[44:47]
    s_waitcnt lgkmcnt(2)
    v_mfma_f32_16x16x32_bf16 v[48:51], a[20:23], v[20:23], v[48:51]
    s_waitcnt lgkmcnt(0)
    v_mfma_f32_16x16x32_bf16 v[52:55], a[24:27], v[20:23], v[52:55]
    s_mov_b32 s15, 0
sp_102:
    s_sleep 2
    ds_read_b32 v16, v10 offset:560
    s_add_u32 s15, s15, 1
    s_cmp_gt_u32 s15, 4000000
    s_cbranch_scc1 sp_102_x
    s_waitcnt lgkmcnt(0)
    v_cmp_ne_u32 vcc, 1, v16
    s_cbranch_vccnz sp_102
sp_102_x:
    s_waitcnt lgkmcnt(0)
    v_add_u32 v12, 0xffff0000, v12
    ds_read_b64_tr_b16 a[28:29], v12 offset:32768
    ds_read_b64_tr_b16 a[30:31], v12 offset:36352
    ds_read_b64_tr_b16 a[32:33], v12 offset:32800
    ds_read_b64_tr_b16 a[34:35], v12 offset:36384
    ds_read_b64_tr_b16 a[36:37], v12 offset:32832
    ds_read_b64_tr_b16 a[38:39], v12 offset:36416
    ds_read_b64_tr_b16 a[40:41], v12 offset:32864
    ds_read_b64_tr_b16 a[42:43], v12 offset:36448
    ds_read_b64_tr_b16 a[44:45], v12 offset:32896
    ds_read_b64_tr_b16 a[46:47], v12 offset:36480
    ds_read_b64_tr_b16 a[48:49], v12 offset:32928
    ds_read_b64_tr_b16 a[50:51], v12 offset:36512
    ds_read_b64_tr_b16 a[52:53], v12 offset:32960
    ds_read_b64_tr_b16 a[54:55], v12 offset:36544
    s_waitcnt lgkmcnt(12)
    v_mfma_f32_16x16x32_bf16 v[28:31], a[28:31], v[20:23], v[28:31]
    s_waitcnt lgkmcnt(10)
    v_mfma_f32_16x16x32_bf16 v[32:35], a[32:35], v[20:23], v[32:35]
    s_waitcnt lgkmcnt(8)
    v_mfma_f32_16x16x32_bf16 v[36:39], a[36:39], v[20:23], v[36:39]
    s_waitcnt lgkmcnt(6)
    v_mfma_f32_16x16x32_bf16 v[40:43], a[40:43], v[20:23], v[40:43]
    s_waitcnt lgkmcnt(4)
    v_mfma_f32_16x16x32_bf16 v[44:47], a[44:47], v[20:23], v[44:47]
    s_waitcnt lgkmcnt(2)
    v_mfma_f32_16x16x32_bf16 v[48:51], a[48:51], v[20:23], v[48:51]
    s_waitcnt lgkmcnt(0)
    v_mfma_f32_16x16x32_bf16 v[52:55], a[52:55], v[20:23], v[52:55]
    ds_read_b64_tr_b16 a[0:1], v12 offset:39936
    ds_read_b64_tr_b16 a[2:3], v12 offset:43520
    ds_read_b64_tr_b16 a[4:5], v12 offset:39968
    ds_read_b64_tr_b16 a[6:7], v12 offset:43552
    ds_read_b64_tr_b16 a[8:9], v12 offset:40000
    ds_read_b64_tr_b16 a[10:11], v12 offset:43584
    ds_read_b64_tr_b16 a[12:13], v12 offset:40032
    ds_read_b64_tr_b16 a[14:15], v12 offset:43616
    ds_read_b64_tr_b16 a[16:17], v12 offset:40064
    ds_read_b64_tr_b16 a[18:19], v12 offset:43648
    ds_read_b64_tr_b16 a[20:21], v12 offset:40096
    ds_read_b64_tr_b16 a[22:23], v12 offset:43680
    ds_read_b64_tr_b16 a[24:25], v12 offset:40128
    ds_read_b64_tr_b16 a[26:27], v12 offset:43712
    s_waitcnt lgkmcnt(12)
    v_mfma_f32_16x16x32_bf16 v[28:31], a[0:3], v[20:23], v[28:31]
    s_waitcnt lgkmcnt(10)
    v_mfma_f32_16x16x32_bf16 v[32:35], a[4:7], v[20:23], v[32:35]
    s_waitcnt lgkmcnt(8)
    v_mfma_f32_16x16x32_bf16 v[36:39], a[8:11], v[20:23], v[36:39]
    s_waitcnt lgkmcnt(6)
    v_mfma_f32_16x16x32_bf16 v[40:43], a[12:15], v[20:23], v[40:43]
    s_waitcnt lgkmcnt(4)
    v_mfma_f32_16x16x32_bf16 v[44:47], a[16:19], v[20:23], v[44:47]
    s_waitcnt lgkmcnt(2)
    v_mfma_f32_16x16x32_bf16 v[48:51], a[20:23], v[20:23], v[48:51]
    s_waitcnt lgkmcnt(0)
    v_mfma_f32_16x16x32_bf16 v[52:55], a[24:27], v[20:23], v[52:55]
    ds_read_b64_tr_b16 a[28:29], v12 offset:47104
    ds_read_b64_tr_b16 a[30:31], v12 offset:50688
    ds_read_b64_tr_b16 a[32:33], v12 offset:47136
    ds_read_b64_tr_b16 a[34:35], v12 offset:50720
    ds_read_b64_tr_b16 a[36:37], v12 offset:47168
    ds_read_b64_tr_b16 a[38:39], v12 offset:50752
    ds_read_b64_tr_b16 a[40:41], v12 offset:47200
    ds_read_b64_tr_b16 a[42:43], v12 offset:50784
    ds_read_b64_tr_b16 a[44:45], v12 offset:47232
    ds_read_b64_tr_b16 a[46:47], v12 offset:50816
    ds_read_b64_tr_b16 a[48:49], v12 offset:47264
    ds_read_b64_tr_b16 a[50:51], v12 offset:50848
    ds_read_b64_tr_b16 a[52:53], v12 offset:47296
    ds_read_b64_tr_b16 a[54:55], v12 offset:50880
    s_waitcnt lgkmcnt(12)
    v_mfma_f32_16x16x32_bf16 v[28:31], a[28:31], v[20:23], v[28:31]
    s_waitcnt lgkmcnt(10)
    v_mfma_f32_16x16x32_bf16 v[32:35], a[32:35], v[20:23], v[32:35]
    s_waitcnt lgkmcnt(8)
    v_mfma_f32_16x16x32_bf16 v[36:39], a[36:39], v[20:23], v[36:39]
    s_waitcnt lgkmcnt(6)
    v_mfma_f32_16x16x32_bf16 v[40:43], a[40:43], v[20:23], v[40:43]
    s_waitcnt lgkmcnt(4)
    v_mfma_f32_16x16x32_bf16 v[44:47], a[44:47], v[20:23], v[44:47]
    s_waitcnt lgkmcnt(2)
    v_mfma_f32_16x16x32_bf16 v[48:51], a[48:51], v[20:23], v[48:51]
    s_waitcnt lgkmcnt(0)
    v_mfma_f32_16x16x32_bf16 v[52:55], a[52:55], v[20:23], v[52:55]
    ds_write_b128 v24, v[28:31] offset:1280
    ds_write_b128 v24, v[32:35] offset:1344
    ds_write_b128 v24, v[36:39] offset:1408
    ds_write_b128 v24, v[40:43] offset:1472
    ds_write_b128 v24, v[44:47] offset:1536
    s_nop 0
    ds_write_b128 v24, v[48:51] offset:1600
    s_nop 0
    ds_write_b128 v24, v[52:55] offset:1664
    s_waitcnt lgkmcnt(0)
    ds_write_b32 v11, v1 offset:672
    s_endpgm
kp_aux:
    s_setprio 0
    s_waitcnt lgkmcnt(0)
    s_load_dword s36, s[40:41], 0x0
    s_add_u32 s9, s4, 1
    s_lshl_b32 s9, s9, 21
    s_add_u32 s44, s40, s9
    s_addc_u32 s45, s41, 0
    s_mov_b32 s46, 0x200000
    s_mov_b32 s47, 0x20000
    s_mov_b32 s72, s40
    s_mov_b32 s73, s41
    s_mov_b32 s74, 0x2000000
    s_mov_b32 s75, 0x20000
    s_lshl_b32 s9, s4, 5
    s_add_u32 s42, s42, s9
    s_addc_u32 s43, s43, 0
    s_waitcnt lgkmcnt(0)
    s_mul_i32 s36, s36, 1664525
    s_add_u32 s36, s36, 1013904221
    s_or_b32 s36, s36, 1
    v_mov_b32 v8, s36
    v_lshlrev_b32 v16, 2, v2
    v_lshlrev_b32 v13, 3, v2
    s_lshl_b32 s55, s7, 9
    s_add_u32 s55, s55, 0x40000
    v_and_b32 v14, 3, v2
    v_lshl_add_u32 v14, v14, 2, v10
    v_bfe_u32 v88, v2, 2, 2
    v_lshl_add_u32 v88, v3, 3, v88
    v_lshlrev_b32 v88, 6, v88
    v_and_b32 v90, 3, v2
    v_lshl_add_u32 v88, v90, 3, v88
    v_and_b32 v90, 1, v3
    v_lshl_add_u32 v88, v90, 5, v88
    v_add_u32 v88, 32768, v88
    v_xor_b32 v89, 32, v88
    v_add_u32 v133, 141312, v5
    v_lshlrev_b32 v132, 2, v4
    s_mov_b32 s52, 0x200
    s_mul_i32 s53, s12, 458752
    s_add_u32 s53, s53, 0x20000
    s_sleep 60
    s_mov_b32 s15, 0
sp_103:
    s_sleep 1
    buffer_load_dword v9, v132, s[44:47], s52 offen sc1
    s_add_u32 s15, s15, 1
    s_cmp_gt_u32 s15, 100000
    s_cbranch_scc1 sp_103_x
    s_waitcnt vmcnt(0)
    v_cmp_ne_u32 vcc, s36, v9
    s_cbranch_vccnz sp_103
sp_103_x:
    s_waitcnt vmcnt(0)
    s_mov_b32 m0, 141312
    s_nop 0
    buffer_load_dwordx4 v5, s[44:47], s53 offen offset:0 sc1 lds
    buffer_load_dwordx4 v5, s[44:47], s53 offen offset:1024 sc1 lds
    buffer_load_dwordx4 v5, s[44:47], s53 offen offset:2048 sc1 lds
    buffer_load_dwordx4 v5, s[44:47], s53 offen offset:3072 sc1 lds
    s_add_u32 s53, s53, 4096
    s_mov_b32 m0, 145408
    s_nop 0
    buffer_load_dwordx4 v5, s[44:47], s53 offen offset:0 sc1 lds
    buffer_load_dwordx4 v5, s[44:47], s53 offen offset:1024 sc1 lds
    buffer_load_dwordx4 v5, s[44:47], s53 offen offset:2048 sc1 lds
    buffer_load_dwordx4 v5, s[44:47], s53 offen offset:3072 sc1 lds
    s_add_u32 s53, s53, 4096
    s_mov_b32 m0, 149504
    s_nop 0
    buffer_load_dwordx4 v5, s[44:47], s53 offen offset:0 sc1 lds
    buffer_load_dwordx4 v5, s[44:47], s53 offen offset:1024 sc1 lds
    buffer_load_dwordx4 v5, s[44:47], s53 offen offset:2048 sc1 lds
    buffer_load_dwordx4 v5, s[44:47], s53 offen offset:3072 sc1 lds
    s_add_u32 s53, s53, 4096
    s_mov_b32 m0, 153600
    s_nop 0
    buffer_load_dwordx4 v5, s[44:47], s53 offen offset:0 sc1 lds
    buffer_load_dwordx4 v5, s[44:47], s53 offen offset:1024 sc1 lds
    buffer_load_dwordx4 v5, s[44:47], s53 offen offset:2048 sc1 lds
    buffer_load_dwordx4 v5, s[44:47], s53 offen offset:3072 sc1 lds
    s_add_u32 s53, s53, 4096
    s_waitcnt vmcnt(0)
    ds_write_b32 v11, v1 offset:704
    s_mov_b32 s15, 0
sp_104:
    s_sleep 1
    ds_read_b32 v9, v14 offset:0
    s_add_u32 s15, s15, 1
    s_cmp_gt_u32 s15, 4000000
    s_cbranch_scc1 sp_104_x
    s_waitcnt lgkmcnt(0)
    v_cmp_ne_u32 vcc, 1, v9
    s_cbranch_vccnz sp_104
sp_104_x:
    s_waitcnt lgkmcnt(0)
    s_mov_b32 s10, s55
    buffer_load_dwordx2 v[18:19], v13, s[72:75], s10 offen sc1
    s_add_u32 s10, s10, 4096
    buffer_load_dwordx2 v[20:21], v13, s[72:75], s10 offen sc1
    s_add_u32 s10, s10, 4096
    buffer_load_dwordx2 v[22:23], v13, s[72:75], s10 offen sc1
    s_add_u32 s10, s10, 4096
    buffer_load_dwordx2 v[24:25], v13, s[72:75], s10 offen sc1
    s_add_u32 s10, s10, 4096
    buffer_load_dwordx2 v[26:27], v13, s[72:75], s10 offen sc1
    s_add_u32 s10, s10, 4096
    buffer_load_dwordx2 v[28:29], v13, s[72:75], s10 offen sc1
    s_add_u32 s10, s10, 4096
    buffer_load_dwordx2 v[30:31], v13, s[72:75], s10 offen sc1
    s_add_u32 s10, s10, 4096
    buffer_load_dwordx2 v[32:33], v13, s[72:75], s10 offen sc1
    s_add_u32 s10, s10, 4096
    buffer_load_dwordx2 v[34:35], v13, s[72:75], s10 offen sc1
    s_add_u32 s10, s10, 4096
    buffer_load_dwordx2 v[36:37], v13, s[72:75], s10 offen sc1
    s_add_u32 s10, s10, 4096
    buffer_load_dwordx2 v[38:39], v13, s[72:75], s10 offen sc1
    s_add_u32 s10, s10, 4096
    buffer_load_dwordx2 v[40:41], v13, s[72:75], s10 offen sc1
    s_add_u32 s10, s10, 4096
    buffer_load_dwordx2 v[42:43], v13, s[72:75], s10 offen sc1
    s_add_u32 s10, s10, 4096
    buffer_load_dwordx2 v[44:45], v13, s[72:75], s10 offen sc1
    s_add_u32 s10, s10, 4096
    buffer_load_dwordx2 v[46:47], v13, s[72:75], s10 offen sc1
    s_add_u32 s10, s10, 4096
    buffer_load_dwordx2 v[48:49], v13, s[72:75], s10 offen sc1
    s_add_u32 s10, s10, 4096
    buffer_load_dwordx2 v[50:51], v13, s[72:75], s10 offen sc1
    s_add_u32 s10, s10, 4096
    buffer_load_dwordx2 v[52:53], v13, s[72:75], s10 offen sc1
    s_add_u32 s10, s10, 4096
    buffer_load_dwordx2 v[54:55], v13, s[72:75], s10 offen sc1
    s_add_u32 s10, s10, 4096
    buffer_load_dwordx2 v[56:57], v13, s[72:75], s10 offen sc1
    s_add_u32 s10, s10, 4096
    buffer_load_dwordx2 v[58:59], v13, s[72:75], s10 offen sc1
    s_add_u32 s10, s10, 4096
    buffer_load_dwordx2 v[60:61], v13, s[72:75], s10 offen sc1
    s_add_u32 s10, s10, 4096
    buffer_load_dwordx2 v[62:63], v13, s[72:75], s10 offen sc1
    s_add_u32 s10, s10, 4096
    buffer_load_dwordx2 v[64:65], v13, s[72:75], s10 offen sc1
    s_add_u32 s10, s10, 4096
    buffer_load_dwordx2 v[66:67], v13, s[72:75], s10 offen sc1
    s_add_u32 s10, s10, 4096
    buffer_load_dwordx2 v[68:69], v13, s[72:75], s10 offen sc1
    s_add_u32 s10, s10, 4096
    buffer_load_dwordx2 v[70:71], v13, s[72:75], s10 offen sc1
    s_add_u32 s10, s10, 4096
    buffer_load_dwordx2 v[72:73], v13, s[72:75], s10 offen sc1
    s_add_u32 s10, s10, 4096
    buffer_load_dwordx2 v[74:75], v13, s[72:75], s10 offen sc1
    s_add_u32 s10, s10, 4096
    buffer_load_dwordx2 v[76:77], v13, s[72:75], s10 offen sc1
    s_add_u32 s10, s10, 4096
    buffer_load_dwordx2 v[78:79], v13, s[72:75], s10 offen sc1
    s_add_u32 s10, s10, 4096
    buffer_load_dwordx2 v[80:81], v13, s[72:75], s10 offen sc1
    s_add_u32 s10, s10, 4096
    ds_read_b128 a[0:3], v133 offset:0
    ds_read_b128 a[4:7], v133 offset:1024
    ds_read_b128 a[8:11], v133 offset:2048
    ds_read_b128 a[12:15], v133 offset:3072
    ds_read_b128 a[16:19], v133 offset:4096
    ds_read_b128 a[20:23], v133 offset:5120
    ds_read_b128 a[24:27], v133 offset:6144
    ds_read_b128 a[28:31], v133 offset:7168
    ds_read_b128 a[32:35], v133 offset:8192
    ds_read_b128 a[36:39], v133 offset:9216
    ds_read_b128 a[40:43], v133 offset:10240
    ds_read_b128 a[44:47], v133 offset:11264
    ds_read_b128 a[48:51], v133 offset:12288
    ds_read_b128 a[52:55], v133 offset:13312
    ds_read_b128 a[56:59], v133 offset:14336
    ds_read_b128 a[60:63], v133 offset:15360
    s_mov_b32 s15, 0
sp_105:
    s_sleep 1
    ds_read_b32 v9, v10 offset:352
    s_add_u32 s15, s15, 1
    s_cmp_gt_u32 s15, 4000000
    s_cbranch_scc1 sp_105_x
    s_waitcnt lgkmcnt(0)
    v_cmp_ne_u32 vcc, 1, v9
    s_cbranch_vccnz sp_105
sp_105_x:
    s_waitcnt lgkmcnt(0)
    ds_read_b64_tr_b16 v[100:101], v88 offset:0
    ds_read_b64_tr_b16 v[102:103], v88 offset:256
    ds_read_b64_tr_b16 v[104:105], v89 offset:0
    ds_read_b64_tr_b16 v[106:107], v89 offset:256
    ds_read_b64_tr_b16 v[108:109], v88 offset:2048
    ds_read_b64_tr_b16 v[110:111], v88 offset:2304
    ds_read_b64_tr_b16 v[112:113], v89 offset:2048
    ds_read_b64_tr_b16 v[114:115], v89 offset:2304
    ds_read_b64_tr_b16 v[116:117], v88 offset:4096
    ds_read_b64_tr_b16 v[118:119], v88 offset:4352
    ds_read_b64_tr_b16 v[120:121], v89 offset:4096
    ds_read_b64_tr_b16 v[122:123], v89 offset:4352
    ds_read_b64_tr_b16 v[124:125], v88 offset:6144
    ds_read_b64_tr_b16 v[126:127], v88 offset:6400
    ds_read_b64_tr_b16 v[128:129], v89 offset:6144
    ds_read_b64_tr_b16 v[130:131], v89 offset:6400
    s_waitcnt lgkmcnt(12)
    v_mfma_f32_16x16x32_bf16 v[92:95], v[100:103], a[0:3], 0
    v_mfma_f32_16x16x32_bf16 v[96:99], v[104:107], a[0:3], 0
    s_waitcnt lgkmcnt(8)
    v_mfma_f32_16x16x32_bf16 v[92:95], v[108:111], a[4:7], v[92:95]
    v_mfma_f32_16x16x32_bf16 v[96:99], v[112:115], a[4:7], v[96:99]
    s_waitcnt lgkmcnt(4)
    v_mfma_f32_16x16x32_bf16 v[92:95], v[116:119], a[8:11], v[92:95]
    v_mfma_f32_16x16x32_bf16 v[96:99], v[120:123], a[8:11], v[96:99]
    s_waitcnt lgkmcnt(0)
    v_mfma_f32_16x16x32_bf16 v[92:95], v[124:127], a[12:15], v[92:95]
    v_mfma_f32_16x16x32_bf16 v[96:99], v[128:131], a[12:15], v[96:99]
    s_mov_b32 s15, 0
sp_106:
    s_sleep 1
    ds_read_b32 v9, v10 offset:368
    s_add_u32 s15, s15, 1
    s_cmp_gt_u32 s15, 4000000
    s_cbranch_scc1 sp_106_x
    s_waitcnt lgkmcnt(0)
    v_cmp_ne_u32 vcc, 1, v9
    s_cbranch_vccnz sp_106
sp_106_x:
    s_waitcnt lgkmcnt(0)
    ds_read_b64_tr_b16 v[100:101], v88 offset:8192
    ds_read_b64_tr_b16 v[102:103], v88 offset:8448
    ds_read_b64_tr_b16 v[104:105], v89 offset:8192
    ds_read_b64_tr_b16 v[106:107], v89 offset:8448
    ds_read_b64_tr_b16 v[108:109], v88 offset:10240
    ds_read_b64_tr_b16 v[110:111], v88 offset:10496
    ds_read_b64_tr_b16 v[112:113], v89 offset:10240
    ds_read_b64_tr_b16 v[114:115], v89 offset:10496
    ds_read_b64_tr_b16 v[116:117], v88 offset:12288
    ds_read_b64_tr_b16 v[118:119], v88 offset:12544
    ds_read_b64_tr_b16 v[120:121], v89 offset:12288
    ds_read_b64_tr_b16 v[122:123], v89 offset:12544
    ds_read_b64_tr_b16 v[124:125], v88 offset:14336
    ds_read_b64_tr_b16 v[126:127], v88 offset:14592
    ds_read_b64_tr_b16 v[128:129], v89 offset:14336
    ds_read_b64_tr_b16 v[130:131], v89 offset:14592
    s_waitcnt lgkmcnt(12)
    v_mfma_f32_16x16x32_bf16 v[92:95], v[100:103], a[16:19], v[92:95]
    v_mfma_f32_16x16x32_bf16 v[96:99], v[104:107], a[16:19], v[96:99]
    s_waitcnt lgkmcnt(8)
    v_mfma_f32_16x16x32_bf16 v[92:95], v[108:111], a[20:23], v[92:95]
    v_mfma_f32_16x16x32_bf16 v[96:99], v[112:115], a[20:23], v[96:99]
    s_waitcnt lgkmcnt(4)
    v_mfma_f32_16x16x32_bf16 v[92:95], v[116:119], a[24:27], v[92:95]
    v_mfma_f32_16x16x32_bf16 v[96:99], v[120:123], a[24:27], v[96:99]
    s_waitcnt lgkmcnt(0)
    v_mfma_f32_16x16x32_bf16 v[92:95], v[124:127], a[28:31], v[92:95]
    v_mfma_f32_16x16x32_bf16 v[96:99], v[128:131], a[28:31], v[96:99]
    s_mov_b32 s15, 0
sp_107:
    s_sleep 1
    ds_read_b32 v9, v10 offset:384
    s_add_u32 s15, s15, 1
    s_cmp_gt_u32 s15, 4000000
    s_cbranch_scc1 sp_107_x
    s_waitcnt lgkmcnt(0)
    v_cmp_ne_u32 vcc, 1, v9
    s_cbranch_vccnz sp_107
sp_107_x:
    s_waitcnt lgkmcnt(0)
    ds_read_b64_tr_b16 v[100:101], v88 offset:16384
    ds_read_b64_tr_b16 v[102:103], v88 offset:16640
    ds_read_b64_tr_b16 v[104:105], v89 offset:16384
    ds_read_b64_tr_b16 v[106:107], v89 offset:16640
    ds_read_b64_tr_b16 v[108:109], v88 offset:18432
    ds_read_b64_tr_b16 v[110:111], v88 offset:18688
    ds_read_b64_tr_b16 v[112:113], v89 offset:18432
    ds_read_b64_tr_b16 v[114:115], v89 offset:18688
    ds_read_b64_tr_b16 v[116:117], v88 offset:20480
    ds_read_b64_tr_b16 v[118:119], v88 offset:20736
    ds_read_b64_tr_b16 v[120:121], v89 offset:20480
    ds_read_b64_tr_b16 v[122:123], v89 offset:20736
    ds_read_b64_tr_b16 v[124:125], v88 offset:22528
    ds_read_b64_tr_b16 v[126:127], v88 offset:22784
    ds_read_b64_tr_b16 v[128:129], v89 offset:22528
    ds_read_b64_tr_b16 v[130:131], v89 offset:22784
    s_waitcnt lgkmcnt(12)
    v_mfma_f32_16x16x32_bf16 v[92:95], v[100:103], a[32:35], v[92:95]
    v_mfma_f32_16x16x32_bf16 v[96:99], v[104:107], a[32:35], v[96:99]
    s_waitcnt lgkmcnt(8)
    v_mfma_f32_16x16x32_bf16 v[92:95], v[108:111], a[36:39], v[92:95]
    v_mfma_f32_16x16x32_bf16 v[96:99], v[112:115], a[36:39], v[96:99]
    s_waitcnt lgkmcnt(4)
    v_mfma_f32_16x16x32_bf16 v[92:95], v[116:119], a[40:43], v[92:95]
    v_mfma_f32_16x16x32_bf16 v[96:99], v[120:123], a[40:43], v[96:99]
    s_waitcnt lgkmcnt(0)
    v_mfma_f32_16x16x32_bf16 v[92:95], v[124:127], a[44:47], v[92:95]
    v_mfma_f32_16x16x32_bf16 v[96:99], v[128:131], a[44:47], v[96:99]
    s_mov_b32 s15, 0
sp_108:
    s_sleep 1
    ds_read_b32 v9, v10 offset:400
    s_add_u32 s15, s15, 1
    s_cmp_gt_u32 s15, 4000000
    s_cbranch_scc1 sp_108_x
    s_waitcnt lgkmcnt(0)
    v_cmp_ne_u32 vcc, 1, v9
    s_cbranch_vccnz sp_108
sp_108_x:
    s_waitcnt lgkmcnt(0)
    ds_read_b64_tr_b16 v[100:101], v88 offset:24576
    ds_read_b64_tr_b16 v[102:103], v88 offset:24832
    ds_read_b64_tr_b16 v[104:105], v89 offset:24576
    ds_read_b64_tr_b16 v[106:107], v89 offset:24832
    ds_read_b64_tr_b16 v[108:109], v88 offset:26624
    ds_read_b64_tr_b16 v[110:111], v88 offset:26880
    ds_read_b64_tr_b16 v[112:113], v89 offset:26624
    ds_read_b64_tr_b16 v[114:115], v89 offset:26880
    ds_read_b64_tr_b16 v[116:117], v88 offset:28672
    ds_read_b64_tr_b16 v[118:119], v88 offset:28928
    ds_read_b64_tr_b16 v[120:121], v89 offset:28672
    ds_read_b64_tr_b16 v[122:123], v89 offset:28928
    ds_read_b64_tr_b16 v[124:125], v88 offset:30720
    ds_read_b64_tr_b16 v[126:127], v88 offset:30976
    ds_read_b64_tr_b16 v[128:129], v89 offset:30720
    ds_read_b64_tr_b16 v[130:131], v89 offset:30976
    s_waitcnt lgkmcnt(12)
    v_mfma_f32_16x16x32_bf16 v[92:95], v[100:103], a[48:51], v[92:95]
    v_mfma_f32_16x16x32_bf16 v[96:99], v[104:107], a[48:51], v[96:99]
    s_waitcnt lgkmcnt(8)
    v_mfma_f32_16x16x32_bf16 v[92:95], v[108:111], a[52:55], v[92:95]
    v_mfma_f32_16x16x32_bf16 v[96:99], v[112:115], a[52:55], v[96:99]
    s_waitcnt lgkmcnt(4)
    v_mfma_f32_16x16x32_bf16 v[92:95], v[116:119], a[56:59], v[92:95]
    v_mfma_f32_16x16x32_bf16 v[96:99], v[120:123], a[56:59], v[96:99]
    s_waitcnt lgkmcnt(0)
    v_mfma_f32_16x16x32_bf16 v[92:95], v[124:127], a[60:63], v[92:95]
    v_mfma_f32_16x16x32_bf16 v[96:99], v[128:131], a[60:63], v[96:99]
    s_nop 6
    v_cvt_pk_bf16_f32 v100, v92, v93
    v_cvt_pk_bf16_f32 v101, v94, v95
    v_cvt_pk_bf16_f32 v102, v96, v97
    v_cvt_pk_bf16_f32 v103, v98, v99
    v_add_u32 v90, 131072, v5
    ds_write_b128 v90, v[100:103]
    s_waitcnt lgkmcnt(0)
    ds_write_b32 v11, v1 offset:416
    s_waitcnt vmcnt(0)
    v_xor_b32 v9, v8, v19
    v_xor_b32 v12, v8, v21
    v_or_b32 v9, v9, v12
    v_xor_b32 v12, v8, v23
    v_or_b32 v9, v9, v12
    v_xor_b32 v12, v8, v25
    v_or_b32 v9, v9, v12
    v_xor_b32 v12, v8, v27
    v_or_b32 v9, v9, v12
    v_xor_b32 v12, v8, v29
    v_or_b32 v9, v9, v12
    v_xor_b32 v12, v8, v31
    v_or_b32 v9, v9, v12
    v_xor_b32 v12, v8, v33
    v_or_b32 v9, v9, v12
    v_xor_b32 v12, v8, v35
    v_or_b32 v9, v9, v12
    v_xor_b32 v12, v8, v37
    v_or_b32 v9, v9, v12
    v_xor_b32 v12, v8, v39
    v_or_b32 v9, v9, v12
    v_xor_b32 v12, v8, v41
    v_or_b32 v9, v9, v12
    v_xor_b32 v12, v8, v43
    v_or_b32 v9, v9, v12
    v_xor_b32 v12, v8, v45
    v_or_b32 v9, v9, v12
    v_xor_b32 v12, v8, v47
    v_or_b32 v9, v9, v12
    v_xor_b32 v12, v8, v49
    v_or_b32 v9, v9, v12
    v_xor_b32 v12, v8, v51
    v_or_b32 v9, v9, v12
    v_xor_b32 v12, v8, v53
    v_or_b32 v9, v9, v12
    v_xor_b32 v12, v8, v55
    v_or_b32 v9, v9, v12
    v_xor_b32 v12, v8, v57
    v_or_b32 v9, v9, v12
    v_xor_b32 v12, v8, v59
    v_or_b32 v9, v9, v12
    v_xor_b32 v12, v8, v61
    v_or_b32 v9, v9, v12
    v_xor_b32 v12, v8, v63
    v_or_b32 v9, v9, v12
    v_xor_b32 v12, v8, v65
    v_or_b32 v9, v9, v12
    v_xor_b32 v12, v8, v67
    v_or_b32 v9, v9, v12
    v_xor_b32 v12, v8, v69
    v_or_b32 v9, v9, v12
    v_xor_b32 v12, v8, v71
    v_or_b32 v9, v9, v12
    v_xor_b32 v12, v8, v73
    v_or_b32 v9, v9, v12
    v_xor_b32 v12, v8, v75
    v_or_b32 v9, v9, v12
    v_xor_b32 v12, v8, v77
    v_or_b32 v9, v9, v12
    v_xor_b32 v12, v8, v79
    v_or_b32 v9, v9, v12
    v_xor_b32 v12, v8, v81
    v_or_b32 v9, v9, v12
    v_cmp_ne_u32 vcc, 0, v9
    s_cbranch_vccnz fm_109
fm_109_r:
    v_add_f32 v18, v18, v50
    v_add_f32 v20, v20, v52
    v_add_f32 v22, v22, v54
    v_add_f32 v24, v24, v56
    v_add_f32 v26, v26, v58
    v_add_f32 v28, v28, v60
    v_add_f32 v30, v30, v62
    v_add_f32 v32, v32, v64
    v_add_f32 v34, v34, v66
    v_add_f32 v36, v36, v68
    v_add_f32 v38, v38, v70
    v_add_f32 v40, v40, v72
    v_add_f32 v42, v42, v74
    v_add_f32 v44, v44, v76
    v_add_f32 v46, v46, v78
    v_add_f32 v48, v48, v80
    v_add_f32 v18, v18, v34
    v_add_f32 v20, v20, v36
    v_add_f32 v22, v22, v38
    v_add_f32 v24, v24, v40
    v_add_f32 v26, v26, v42
    v_add_f32 v28, v28, v44
    v_add_f32 v30, v30, v46
    v_add_f32 v32, v32, v48
    v_add_f32 v82, v18, v26
    v_add_f32 v83, v20, v28
    v_add_f32 v84, v22, v30
    v_add_f32 v85, v24, v32
    v_cvt_pk_bf16_f32 v82, v82, v82
    v_and_b32 v82, 0xffff0000, v82
    v_cvt_pk_bf16_f32 v83, v83, v83
    v_and_b32 v83, 0xffff0000, v83
    v_cvt_pk_bf16_f32 v84, v84, v84
    v_and_b32 v84, 0xffff0000, v84
    v_cvt_pk_bf16_f32 v85, v85, v85
    v_and_b32 v85, 0xffff0000, v85
    v_add_f32 v84, 1.0, v84
    v_cvt_pk_bf16_f32 v84, v84, v84
    v_and_b32 v84, 0xffff0000, v84
    v_add_u32 v12, 159744, v16
    ds_write_b32 v12, v82 offset:0
    ds_write_b32 v12, v83 offset:256
    ds_write_b32 v12, v84 offset:512
    ds_write_b32 v12, v85 offset:768
    v_lshrrev_b32 v86, 16, v83
    v_or_b32 v86, v86, v84
    v_mov_b32 v87, v8
    v_lshlrev_b32 v13, 3, v2
    s_lshl_b32 s53, s7, 9
    s_add_u32 s53, s53, 0xc000
    s_cmp_lg_u32 s37, 1
    s_cbranch_scc1 ps_110
pd_111_f:
    buffer_store_dwordx2 v[86:87], v13, s[44:47], s53 offen
pd_111:
    s_waitcnt lgkmcnt(0)
    ds_write_b32 v11, v1 offset:480
    s_lshl_b32 s10, s5, 13
    s_add_u32 s10, s10, 0xc0000
    s_add_u32 s76, s28, s10
    s_addc_u32 s77, s29, 0
    s_mov_b32 s14, 8
sm_112:
    s_load_dword s80, s[76:77], 0
    s_load_dword s80, s[76:77], 64
    s_load_dword s80, s[76:77], 128
    s_load_dword s80, s[76:77], 192
    s_load_dword s80, s[76:77], 256
    s_load_dword s80, s[76:77], 320
    s_load_dword s80, s[76:77], 384
    s_load_dword s80, s[76:77], 448
    s_load_dword s80, s[76:77], 512
    s_load_dword s80, s[76:77], 576
    s_load_dword s80, s[76:77], 640
    s_load_dword s80, s[76:77], 704
    s_load_dword s80, s[76:77], 768
    s_load_dword s80, s[76:77], 832
    s_load_dword s80, s[76:77], 896
    s_load_dword s80, s[76:77], 960
    s_add_u32 s76, s76, 1024
    s_addc_u32 s77, s77, 0
    s_sub_u32 s14, s14, 1
    s_cmp_lg_u32 s14, 0
    s_cbranch_scc1 sm_112
    s_lshl_b32 s10, s5, 13
    s_add_u32 s10, s10, 0x100000
    s_add_u32 s76, s28, s10
    s_addc_u32 s77, s29, 0
    s_mov_b32 s14, 8
sm_113:
    s_load_dword s80, s[76:77], 0
    s_load_dword s80, s[76:77], 64
    s_load_dword s80, s[76:77], 128
    s_load_dword s80, s[76:77], 192
    s_load_dword s80, s[76:77], 256
    s_load_dword s80, s[76:77], 320
    s_load_dword s80, s[76:77], 384
    s_load_dword s80, s[76:77], 448
    s_load_dword s80, s[76:77], 512
    s_load_dword s80, s[76:77], 576
    s_load_dword s80, s[76:77], 640
    s_load_dword s80, s[76:77], 704
    s_load_dword s80, s[76:77], 768
    s_load_dword s80, s[76:77], 832
    s_load_dword s80, s[76:77], 896
    s_load_dword s80, s[76:77], 960
    s_add_u32 s76, s76, 1024
    s_addc_u32 s77, s77, 0
    s_sub_u32 s14, s14, 1
    s_cmp_lg_u32 s14, 0
    s_cbranch_scc1 sm_113
    s_lshl_b32 s10, s5, 13
    s_add_u32 s10, s10, 0x140000
    s_add_u32 s76, s28, s10
    s_addc_u32 s77, s29, 0
    s_mov_b32 s14, 8
sm_114:
    s_load_dword s80, s[76:77], 0
    s_load_dword s80, s[76:77], 64
    s_load_dword s80, s[76:77], 128
    s_load_dword s80, s[76:77], 192
    s_load_dword s80, s[76:77], 256
    s_load_dword s80, s[76:77], 320
    s_load_dword s80, s[76:77], 384
    s_load_dword s80, s[76:77], 448
    s_load_dword s80, s[76:77], 512
    s_load_dword s80, s[76:77], 576
    s_load_dword s80, s[76:77], 640
    s_load_dword s80, s[76:77], 704
    s_load_dword s80, s[76:77], 768
    s_load_dword s80, s[76:77], 832
    s_load_dword s80, s[76:77], 896
    s_load_dword s80, s[76:77], 960
    s_add_u32 s76, s76, 1024
    s_addc_u32 s77, s77, 0
    s_sub_u32 s14, s14, 1
    s_cmp_lg_u32 s14, 0
    s_cbranch_scc1 sm_114
    s_lshl_b32 s10, s5, 13
    s_add_u32 s10, s10, 0x180000
    s_add_u32 s76, s28, s10
    s_addc_u32 s77, s29, 0
    s_mov_b32 s14, 8
sm_115:
    s_load_dword s80, s[76:77], 0
    s_load_dword s80, s[76:77], 64
    s_load_dword s80, s[76:77], 128
    s_load_dword s80, s[76:77], 192
    s_load_dword s80, s[76:77], 256
    s_load_dword s80, s[76:77], 320
    s_load_dword s80, s[76:77], 384
    s_load_dword s80, s[76:77], 448
    s_load_dword s80, s[76:77], 512
    s_load_dword s80, s[76:77], 576
    s_load_dword s80, s[76:77], 640
    s_load_dword s80, s[76:77], 704
    s_load_dword s80, s[76:77], 768
    s_load_dword s80, s[76:77], 832
    s_load_dword s80, s[76:77], 896
    s_load_dword s80, s[76:77], 960
    s_add_u32 s76, s76, 1024
    s_addc_u32 s77, s77, 0
    s_sub_u32 s14, s14, 1
    s_cmp_lg_u32 s14, 0
    s_cbranch_scc1 sm_115
    s_waitcnt lgkmcnt(0)
    s_endpgm
kp_compute:
    s_setprio 1
    s_lshl_b32 s9, s3, 2
    v_add_u32 v11, s9, v11
    s_add_u32 s52, s5, 1
    s_cmp_eq_u32 s5, 16
    s_cselect_b32 s52, 0, s52
    s_lshl_b32 s10, s4, 4
    s_add_u32 s10, s10, s52
    s_max_u32 s10, s10, 1
    s_sub_u32 s10, s10, 1
    s_lshl_b32 s53, s10, 14
    s_lshl_b32 s9, s3, 12
    s_add_u32 s53, s53, s9
    v_lshlrev_b32 v65, 10, v4
    v_lshl_add_u32 v65, v3, 4, v65
    s_waitcnt lgkmcnt(0)
    s_load_dword s36, s[40:41], 0x0
    s_add_u32 s9, s4, 1
    s_lshl_b32 s9, s9, 21
    s_add_u32 s44, s40, s9
    s_addc_u32 s45, s41, 0
    s_mov_b32 s46, 0x200000
    s_mov_b32 s47, 0x20000
    s_mov_b32 s72, s40
    s_mov_b32 s73, s41
    s_mov_b32 s74, 0x2000000
    s_mov_b32 s75, 0x20000
    s_lshl_b32 s9, s4, 5
    s_add_u32 s42, s42, s9
    s_addc_u32 s43, s43, 0
    s_mov_b32 s48, s16
    s_mov_b32 s49, s17
    s_mov_b32 s50, 0x200000
    s_mov_b32 s51, 0x20000
    s_cmp_gt_u32 s5, 16
    s_cbranch_scc1 fb_116_0
    s_mov_b32 s56, s64
    s_mov_b32 s57, s65
    s_mov_b32 s58, 0x400
    s_mov_b32 s59, 0x20000
    buffer_load_dwordx4 v[44:47], v5, s[56:59], 0 offen
    buffer_load_dwordx4 v[76:79], v5, s[48:51], s53 offen offset:0
    buffer_load_dwordx4 v[80:83], v5, s[48:51], s53 offen offset:1024
    buffer_load_dwordx4 v[84:87], v5, s[48:51], s53 offen offset:2048
    buffer_load_dwordx4 v[88:91], v5, s[48:51], s53 offen offset:3072
fb_116_0:
    s_lshl_b32 s34, s6, 2
    s_mov_b32 s9, s3
    s_add_u32 s34, s34, s9
    s_lshl_b32 s14, s12, 3
    s_lshl_b32 s9, s3, 1
    s_add_u32 s14, s14, s9
    v_bfe_u32 v66, v2, 2, 2
    v_lshl_add_u32 v66, v3, 3, v66
    v_lshlrev_b32 v66, 6, v66
    v_and_b32 v65, 3, v2
    v_lshl_add_u32 v66, v65, 3, v66
    v_and_b32 v65, 1, v3
    v_lshl_add_u32 v66, v65, 5, v66
    v_xor_b32 v67, 32, v66
    v_add_u32 v68, 0x10000, v66
    v_add_u32 v69, 0x10000, v67
    v_and_b32 v59, 7, v2
    v_lshlrev_b32 v59, 2, v59
    v_lshlrev_b32 v58, 4, v3
    v_add_u32 v58, 159744, v58
    v_lshlrev_b32 v60, 2, v4
    v_lshlrev_b32 v61, 6, v4
    v_lshl_add_u32 v61, v3, 4, v61
    v_lshrrev_b32 v9, 1, v3
    v_lshlrev_b32 v62, 6, v4
    v_lshl_add_u32 v62, v9, 2, v62
    v_lshlrev_b32 v63, 10, v4
    v_lshl_add_u32 v63, v3, 3, v63
    v_mov_b32 v52, 0xbdd2d3e8
    v_mov_b32 v53, 0xc0135761
    s_lshl_b32 s60, s4, 18
    s_lshl_b32 s9, s34, 14
    s_add_u32 s60, s60, s9
    s_lshl_b32 s9, s7, 7
    s_add_u32 s60, s60, s9
    s_lshl_b32 s61, s34, 5
    s_lshl_b32 s62, s34, 5
    s_lshl_b32 s9, s7, 2
    s_add_u32 s62, s62, s9
    s_lshl_b32 s63, s34, 10
    s_lshl_b32 s39, s34, 10
    s_lshl_b32 s9, s7, 3
    s_add_u32 s39, s39, s9
    s_lshl_b32 s76, s34, 14
    s_lshl_b32 s77, s34, 14
    s_lshl_b32 s9, s7, 11
    s_add_u32 s77, s77, s9
    s_mul_i32 s29, s34, 57344
    s_add_u32 s29, s29, 0x32000
    s_lshl_b32 s90, s7, 11
    s_mov_b32 s9, s29
    s_add_u32 s90, s90, s9
    s_lshr_b32 s78, s34, 1
    s_lshl_b32 s78, s78, 6
    s_add_u32 s80, s78, 0x500
    s_add_u32 s81, s39, 0x4000
    s_add_u32 s82, s62, 0x900
    s_add_u32 s83, s61, 0x900
    s_add_u32 s84, s63, 0x4000
    s_add_u32 s85, s77, 0x11c000
    s_add_u32 s87, s62, 0xd00
    s_add_u32 s88, s61, 0xd00
    s_add_u32 s91, s62, 0x1180
    s_add_u32 s92, s61, 0x1160
    s_add_u32 s93, s39, 0x8000
    s_add_u32 s94, s62, 0x1600
    s_add_u32 s95, s78, 0x1a00
    s_lshl_b32 s89, s34, 12
    s_add_u32 s89, s89, 0x10000
    s_lshl_b32 s86, s7, 5
    s_mov_b32 s9, s89
    s_add_u32 s86, s86, s9
    s_mov_b32 s30, 0x200
    s_lshl_b32 s9, s3, 1
    v_and_b32 v9, 1, v3
    v_add3_u32 v9, v9, s9, 1
    v_and_b32 v9, 3, v9
    v_lshlrev_b32 v9, 6, v9
    v_add_u32 v64, v9, v60
    s_mul_i32 s31, s14, 57344
    s_add_u32 s31, s31, 0x2e000
    s_lshl_b32 s10, s34, 4
    s_add_u32 s10, s10, 0x10
    s_lshl_b32 s58, s4, 8
    s_lshl_b32 s9, s34, 4
    s_add_u32 s58, s58, s9
    v_add_u32 v65, -1, v4
    v_add_u32 v9, s58, v65
    v_cmp_le_u32 vcc, 0x800, v9
    v_add_u32 v70, s10, v65
    v_and_b32 v9, 15, v70
    v_lshrrev_b32 v70, 4, v70
    v_mul_u32_u24 v70, 57344, v70
    v_lshl_add_u32 v70, v9, 4, v70
    v_lshl_add_u32 v70, v3, 8, v70
    v_add_u32 v70, 147456, v70
    v_mov_b32 v9, 0x7fff0000
    v_cndmask_b32 v70, v70, v9, vcc
    v_add_u32 v65, 1, v4
    v_add_u32 v9, s58, v65
    v_cmp_le_u32 vcc, 0x800, v9
    v_add_u32 v71, s10, v65
    v_and_b32 v9, 15, v71
    v_lshrrev_b32 v71, 4, v71
    v_mul_u32_u24 v71, 57344, v71
    v_lshl_add_u32 v71, v9, 4, v71
    v_lshl_add_u32 v71, v3, 8, v71
    v_add_u32 v71, 151552, v71
    v_mov_b32 v9, 0x7fff0000
    v_cndmask_b32 v71, v71, v9, vcc
    v_add_u32 v65, -2, v4
    v_add_u32 v9, s58, v65
    v_cmp_le_u32 vcc, 0x800, v9
    v_add_u32 v72, s10, v65
    v_and_b32 v9, 15, v72
    v_lshrrev_b32 v72, 4, v72
    v_mul_u32_u24 v72, 57344, v72
    v_lshl_add_u32 v72, v9, 4, v72
    v_lshl_add_u32 v72, v3, 8, v72
    v_add_u32 v72, 155648, v72
    v_mov_b32 v9, 0x7fff0000
    v_cndmask_b32 v72, v72, v9, vcc
    v_add_u32 v65, 2, v4
    v_add_u32 v9, s58, v65
    v_cmp_le_u32 vcc, 0x800, v9
    v_add_u32 v73, s10, v65
    v_and_b32 v9, 15, v73
    v_lshrrev_b32 v73, 4, v73
    v_mul_u32_u24 v73, 57344, v73
    v_lshl_add_u32 v73, v9, 4, v73
    v_lshl_add_u32 v73, v3, 8, v73
    v_add_u32 v73, 159744, v73
    v_mov_b32 v9, 0x7fff0000
    v_cndmask_b32 v73, v73, v9, vcc
    s_cmp_eq_u32 s58, 0
    s_cselect_b32 s9, 32, 0
    s_cmp_eq_u32 s58, 2032
    s_cselect_b32 s10, 32, 64
    v_mov_b32 v74, s9
    v_mov_b32 v65, s10
    v_and_b32 v9, 2, v2
    v_cmp_eq_u32 vcc, 0, v9
    s_nop 1
    v_cndmask_b32 v74, v65, v74, vcc
    v_and_b32 v9, 8, v2
    v_cmp_ne_u32 vcc, 0, v9
    s_nop 1
    v_cndmask_b32 v74, 32, v74, vcc
    v_add_u32 v74, v74, v59
    s_cmp_gt_u32 s5, 16
    s_cbranch_scc1 fb_116
    v_lshrrev_b32 v152, 2, v2
    v_lshlrev_b32 v152, 7, v152
    v_and_b32 v146, 3, v2
    v_lshl_add_u32 v152, v146, 3, v152
    v_bfe_u32 v146, v2, 3, 2
    v_lshl_add_u32 v152, v146, 5, v152
    s_lshl_b32 s9, s3, 5
    v_xor_b32 v152, s9, v152
    v_add_u32 v152, 98304, v152
    s_lshl_b32 s10, s3, 10
    s_add_u32 s10, s10, 0x1a000
    v_add_u32 v154, s10, v5
    s_lshl_b32 s9, s4, 7
    s_add_u32 s10, s10, s9
    v_lshlrev_b32 v153, 3, v3
    v_add_u32 v153, s10, v153
    v_lshlrev_b32 v144, 10, v4
    v_lshl_add_u32 v144, v3, 4, v144
    v_lshlrev_b32 v155, 4, v4
    s_cmp_ge_u32 s3, 2
    s_cselect_b32 s58, 1.0, 0
    s_lshl_b32 s57, s52, 8
    s_lshl_b32 s9, s3, 6
    s_add_u32 s57, s57, s9
    s_add_u32 s57, s57, 0x2000
    s_lshl_b32 s53, s3, 8
    s_add_u32 s53, s53, 0x2000
    s_mov_b32 s54, 0x3000
    s_mul_i32 s55, s3, 57344
    s_lshl_b32 s9, s5, 10
    s_add_u32 s55, s55, s9
    s_add_u32 s55, s55, 0x20000
    s_lshl_b32 s59, s5, 10
    s_add_u32 s59, s59, 0x100000
    s_lshl_b32 s56, s3, 6
    s_lshl_b32 s9, s5, 2
    s_add_u32 s56, s56, s9
    s_add_u32 s56, s56, 0x200
    s_lshl_b32 s20, s5, 12
    s_lshl_b32 s9, s3, 10
    s_add_u32 s20, s20, s9
    s_add_u32 s20, s20, 0x20000
    s_lshl_b32 s21, s4, 7
    s_mov_b32 s9, s20
    s_add_u32 s21, s21, s9
    v_lshlrev_b32 v146, 5, v3
    v_lshl_add_u32 v146, v4, 4, v146
    v_cmp_eq_u32 s[22:23], 0, v4
    s_waitcnt vmcnt(4)
    v_lshlrev_b32 v112, 16, v44
    v_and_b32 v113, 0xffff0000, v44
    v_lshlrev_b32 v114, 16, v45
    v_and_b32 v115, 0xffff0000, v45
    v_lshlrev_b32 v116, 16, v46
    v_and_b32 v117, 0xffff0000, v46
    v_lshlrev_b32 v118, 16, v47
    v_and_b32 v119, 0xffff0000, v47
    v_mul_f32 v120, 0xbfb8aa3b, v112
    v_mul_f32 v121, 0xbfb8aa3b, v113
    v_mul_f32 v122, 0xbfb8aa3b, v114
    v_mul_f32 v123, 0xbfb8aa3b, v115
    v_mul_f32 v124, 0xbfb8aa3b, v116
    v_mul_f32 v125, 0xbfb8aa3b, v117
    v_mul_f32 v126, 0xbfb8aa3b, v118
    v_mul_f32 v127, 0xbfb8aa3b, v119
    v_exp_f32 v120, v120
    v_exp_f32 v121, v121
    v_exp_f32 v122, v122
    v_exp_f32 v123, v123
    v_exp_f32 v124, v124
    v_exp_f32 v125, v125
    v_exp_f32 v126, v126
    v_exp_f32 v127, v127
    v_pk_add_f32 v[120:121], v[120:121], 1.0 op_sel_hi:[1,0]
    v_pk_add_f32 v[122:123], v[122:123], 1.0 op_sel_hi:[1,0]
    v_pk_add_f32 v[124:125], v[124:125], 1.0 op_sel_hi:[1,0]
    v_pk_add_f32 v[126:127], v[126:127], 1.0 op_sel_hi:[1,0]
    v_rcp_f32 v120, v120
    v_rcp_f32 v121, v121
    v_rcp_f32 v122, v122
    v_rcp_f32 v123, v123
    v_rcp_f32 v124, v124
    v_rcp_f32 v125, v125
    v_rcp_f32 v126, v126
    v_rcp_f32 v127, v127
    v_pk_mul_f32 v[112:113], v[112:113], v[120:121]
    v_pk_mul_f32 v[114:115], v[114:115], v[122:123]
    v_pk_mul_f32 v[116:117], v[116:117], v[124:125]
    v_pk_mul_f32 v[118:119], v[118:119], v[126:127]
    v_cvt_pk_bf16_f32 v44, v112, v113
    v_cvt_pk_bf16_f32 v45, v114, v115
    v_cvt_pk_bf16_f32 v46, v116, v117
    v_cvt_pk_bf16_f32 v47, v118, v119
    ds_write_b128 v154, v[44:47]
    s_waitcnt lgkmcnt(0)
    s_mul_i32 s36, s36, 1664525
    s_add_u32 s36, s36, 1013904221
    s_or_b32 s36, s36, 1
    v_mov_b32 v8, s36
    v_and_b32 v48, 7, v2
    v_lshlrev_b32 v48, 2, v48
    global_load_dword v48, v48, s[42:43] sc1
    v_mov_b32 v45, v8
    v_mov_b32 v47, v8
    s_cmp_eq_u32 s5, 16
    s_cbranch_scc1 nomod_118
    ds_read2_b64 v[120:123], v153 offset0:0 offset1:4
    ds_read2_b64 v[124:127], v153 offset0:8 offset1:12
    s_mov_b32 s15, 0
sp_119:
    ds_read_b32 v9, v10 offset:688
    s_add_u32 s15, s15, 1
    s_cmp_gt_u32 s15, 4000000
    s_cbranch_scc1 sp_119_x
    s_waitcnt lgkmcnt(0)
    v_cmp_ne_u32 vcc, 1, v9
    s_cbranch_vccnz sp_119
sp_119_x:
    s_waitcnt lgkmcnt(0)
    ds_read_b64_tr_b16 v[112:113], v152 offset:0
    ds_read_b64_tr_b16 v[114:115], v152 offset:2048
    ds_read_b64_tr_b16 v[116:117], v152 offset:4096
    ds_read_b64_tr_b16 v[118:119], v152 offset:6144
    s_waitcnt lgkmcnt(0)
    v_mfma_f32_16x16x32_bf16 v[132:135], v[112:115], v[120:123], 0
    v_mfma_f32_16x16x32_bf16 v[132:135], v[116:119], v[124:127], v[132:135]
    s_nop 7
    v_cndmask_b32 v44, v134, v132, s[22:23]
    v_cndmask_b32 v46, v135, v133, s[22:23]
    s_mov_b32 exec_lo, 0x30003
    s_mov_b32 exec_hi, 0x30003
    buffer_store_dwordx4 v[44:47], v146, s[72:75], s21 offen sc1
    s_mov_b64 exec, -1
    s_lshl_b32 s10, s4, 4
    s_add_u32 s10, s10, s3
    s_and_b32 s27, s5, 15
    s_lshl_b32 s27, s27, 6
    s_max_u32 s9, s10, 1
    s_sub_u32 s9, s9, 1
    s_lshl_b32 s9, s9, 14
    s_add_u32 s9, s9, s27
    buffer_load_dwordx4 v[92:95], v144, s[48:51], s9 offen
    s_add_u32 s9, s10, 3
    s_lshl_b32 s9, s9, 14
    s_add_u32 s9, s9, s27
    buffer_load_dwordx4 v[96:99], v144, s[48:51], s9 offen
    s_add_u32 s9, s10, 7
    s_lshl_b32 s9, s9, 14
    s_add_u32 s9, s9, s27
    buffer_load_dwordx4 v[100:103], v144, s[48:51], s9 offen
    s_add_u32 s9, s10, 11
    s_lshl_b32 s9, s9, 14
    s_add_u32 s9, s9, s27
    buffer_load_dwordx4 v[104:107], v144, s[48:51], s9 offen
    s_lshl_b32 s9, s4, 4
    s_add_u32 s9, s9, 15
    s_lshl_b32 s9, s9, 14
    s_add_u32 s9, s9, s27
    buffer_load_dwordx4 v[108:111], v144, s[48:51], s9 offen
nomod_118:
    s_waitcnt vmcnt(6)
    s_cmp_lg_u32 s5, 16
    s_cbranch_scc1 x16_120
    s_waitcnt vmcnt(0)
x16_120:
    v_cmp_ne_u32 vcc, s38, v48
    s_nop 0
    s_cmp_eq_u64 vcc, 0
    s_cselect_b32 s37, 1, 0
    v_lshlrev_b32 v12, 16, v76
    v_and_b32 v13, 0xffff0000, v76
    v_lshlrev_b32 v14, 16, v77
    v_and_b32 v15, 0xffff0000, v77
    v_lshlrev_b32 v16, 16, v78
    v_and_b32 v17, 0xffff0000, v78
    v_lshlrev_b32 v18, 16, v79
    v_and_b32 v19, 0xffff0000, v79
    v_lshlrev_b32 v20, 16, v80
    v_and_b32 v21, 0xffff0000, v80
    v_lshlrev_b32 v22, 16, v81
    v_and_b32 v23, 0xffff0000, v81
    v_lshlrev_b32 v24, 16, v82
    v_and_b32 v25, 0xffff0000, v82
    v_lshlrev_b32 v26, 16, v83
    v_and_b32 v27, 0xffff0000, v83
    v_lshlrev_b32 v28, 16, v84
    v_and_b32 v29, 0xffff0000, v84
    v_lshlrev_b32 v30, 16, v85
    v_and_b32 v31, 0xffff0000, v85
    v_lshlrev_b32 v32, 16, v86
    v_and_b32 v33, 0xffff0000, v86
    v_lshlrev_b32 v34, 16, v87
    v_and_b32 v35, 0xffff0000, v87
    v_lshlrev_b32 v36, 16, v88
    v_and_b32 v37, 0xffff0000, v88
    v_lshlrev_b32 v38, 16, v89
    v_and_b32 v39, 0xffff0000, v89
    v_lshlrev_b32 v40, 16, v90
    v_and_b32 v41, 0xffff0000, v90
    v_lshlrev_b32 v42, 16, v91
    v_and_b32 v43, 0xffff0000, v91
    v_pk_add_f32 v[112:113], v[12:13], v[14:15]
    v_pk_mul_f32 v[120:121], v[12:13], v[12:13]
    v_pk_add_f32 v[114:115], v[20:21], v[22:23]
    v_pk_mul_f32 v[122:123], v[20:21], v[20:21]
    v_pk_add_f32 v[116:117], v[28:29], v[30:31]
    v_pk_mul_f32 v[124:125], v[28:29], v[28:29]
    v_pk_add_f32 v[118:119], v[36:37], v[38:39]
    v_pk_mul_f32 v[126:127], v[36:37], v[36:37]
    v_pk_fma_f32 v[120:121], v[14:15], v[14:15], v[120:121]
    v_pk_fma_f32 v[122:123], v[22:23], v[22:23], v[122:123]
    v_pk_fma_f32 v[124:125], v[30:31], v[30:31], v[124:125]
    v_pk_fma_f32 v[126:127], v[38:39], v[38:39], v[126:127]
    v_pk_add_f32 v[112:113], v[112:113], v[16:17]
    v_pk_fma_f32 v[120:121], v[16:17], v[16:17], v[120:121]
    v_pk_add_f32 v[114:115], v[114:115], v[24:25]
    v_pk_fma_f32 v[122:123], v[24:25], v[24:25], v[122:123]
    v_pk_add_f32 v[116:117], v[116:117], v[32:33]
    v_pk_fma_f32 v[124:125], v[32:33], v[32:33], v[124:125]
    v_pk_add_f32 v[118:119], v[118:119], v[40:41]
    v_pk_fma_f32 v[126:127], v[40:41], v[40:41], v[126:127]
    v_pk_add_f32 v[112:113], v[112:113], v[18:19]
    v_pk_fma_f32 v[120:121], v[18:19], v[18:19], v[120:121]
    v_pk_add_f32 v[114:115], v[114:115], v[26:27]
    v_pk_fma_f32 v[122:123], v[26:27], v[26:27], v[122:123]
    v_pk_add_f32 v[116:117], v[116:117], v[34:35]
    v_pk_fma_f32 v[124:125], v[34:35], v[34:35], v[124:125]
    v_pk_add_f32 v[118:119], v[118:119], v[42:43]
    v_pk_fma_f32 v[126:127], v[42:43], v[42:43], v[126:127]
    v_add_f32 v112, v112, v113
    v_add_f32 v114, v114, v115
    v_add_f32 v116, v116, v117
    v_add_f32 v118, v118, v119
    v_add_f32 v120, v120, v121
    v_add_f32 v122, v122, v123
    v_add_f32 v124, v124, v125
    v_add_f32 v126, v126, v127
    v_permlane32_swap_b32 v112, v116
    v_permlane32_swap_b32 v114, v118
    v_permlane32_swap_b32 v120, v124
    v_permlane32_swap_b32 v122, v126
    v_add_f32 v112, v112, v116
    v_add_f32 v114, v114, v118
    v_add_f32 v120, v120, v124
    v_add_f32 v122, v122, v126
    v_permlane16_swap_b32 v112, v114
    s_nop 0
    v_permlane16_swap_b32 v120, v122
    v_add_f32 v112, v112, v114
    v_add_f32 v120, v120, v122
    s_nop 0
    v_add_f32_dpp v112, v112, v112 row_ror:8 row_mask:0xf bank_mask:0xf
    v_add_f32_dpp v120, v120, v120 row_ror:8 row_mask:0xf bank_mask:0xf
    s_nop 0
    v_add_f32_dpp v112, v112, v112 row_ror:4 row_mask:0xf bank_mask:0xf
    v_add_f32_dpp v120, v120, v120 row_ror:4 row_mask:0xf bank_mask:0xf
    s_nop 0
    v_add_f32_dpp v112, v112, v112 row_ror:2 row_mask:0xf bank_mask:0xf
    v_add_f32_dpp v120, v120, v120 row_ror:2 row_mask:0xf bank_mask:0xf
    s_nop 0
    v_add_f32_dpp v112, v112, v112 row_ror:1 row_mask:0xf bank_mask:0xf
    v_add_f32_dpp v120, v120, v120 row_ror:1 row_mask:0xf bank_mask:0xf
    v_mul_f32 v112, 0x3b000000, v112
    v_mov_b32 v146, 0x3727c5ac
    v_fmac_f32 v146, 0x3b000000, v120
    v_fma_f32 v146, -v112, v112, v146
    v_max_f32 v146, 0x3727c5ac, v146
    v_rsq_f32 v150, v146
    s_nop 0
    v_mul_f32 v151, -v112, v150
    v_mov_b32 v44, v150
    v_mov_b32 v46, v151
    v_lshlrev_b32 v146, 4, v3
    s_cmp_eq_u32 s37, 1
    s_cbranch_scc1 cm_121
    v_and_b32 v9, 7, v2
    v_lshlrev_b32 v9, 2, v9
    global_load_dword v9, v9, s[42:43] sc1
    s_waitcnt vmcnt(0)
    v_cmp_ne_u32 vcc, s38, v9
    s_nop 0
    s_cmp_eq_u64 vcc, 0
    s_cselect_b32 s37, 1, 0
cm_121:
    s_mov_b32 exec_lo, 0x10001
    s_mov_b32 exec_hi, 0x10001
    s_cmp_lg_u32 s37, 1
    s_cbranch_scc1 ps_122
pd_123_f:
    buffer_store_dwordx4 v[44:47], v146, s[44:47], s57 offen
pd_123:
    s_mov_b64 exec, -1
    v_and_b32 v152, 3, v2
    v_lshl_add_u32 v152, v152, 2, v10
    s_cmp_eq_u32 s5, 16
    s_cbranch_scc1 fe_124
    buffer_load_dwordx4 v[132:135], v5, s[72:75], s20 offen sc1
    s_waitcnt vmcnt(2)
    v_lshlrev_b32 v12, 16, v92
    v_and_b32 v13, 0xffff0000, v92
    v_lshlrev_b32 v14, 16, v93
    v_and_b32 v15, 0xffff0000, v93
    v_lshlrev_b32 v16, 16, v94
    v_and_b32 v17, 0xffff0000, v94
    v_lshlrev_b32 v18, 16, v95
    v_and_b32 v19, 0xffff0000, v95
    v_lshlrev_b32 v20, 16, v96
    v_and_b32 v21, 0xffff0000, v96
    v_lshlrev_b32 v22, 16, v97
    v_and_b32 v23, 0xffff0000, v97
    v_lshlrev_b32 v24, 16, v98
    v_and_b32 v25, 0xffff0000, v98
    v_lshlrev_b32 v26, 16, v99
    v_and_b32 v27, 0xffff0000, v99
    v_lshlrev_b32 v28, 16, v100
    v_and_b32 v29, 0xffff0000, v100
    v_lshlrev_b32 v30, 16, v101
    v_and_b32 v31, 0xffff0000, v101
    v_lshlrev_b32 v32, 16, v102
    v_and_b32 v33, 0xffff0000, v102
    v_lshlrev_b32 v34, 16, v103
    v_and_b32 v35, 0xffff0000, v103
    v_lshlrev_b32 v36, 16, v104
    v_and_b32 v37, 0xffff0000, v104
    v_lshlrev_b32 v38, 16, v105
    v_and_b32 v39, 0xffff0000, v105
    v_lshlrev_b32 v40, 16, v106
    v_and_b32 v41, 0xffff0000, v106
    v_lshlrev_b32 v42, 16, v107
    v_and_b32 v43, 0xffff0000, v107
    v_lshlrev_b32 v136, 16, v108
    v_and_b32 v137, 0xffff0000, v108
    v_lshlrev_b32 v138, 16, v109
    v_and_b32 v139, 0xffff0000, v109
    v_lshlrev_b32 v140, 16, v110
    v_and_b32 v141, 0xffff0000, v110
    v_lshlrev_b32 v142, 16, v111
    v_and_b32 v143, 0xffff0000, v111
    v_and_b32 v154, 7, v2
    v_lshlrev_b32 v154, 3, v154
    s_lshl_b32 s9, s3, 6
    s_add_u32 s9, s9, 110592
    v_add_u32 v154, s9, v154
    v_lshlrev_b32 v153, 5, v3
    v_add_u32 v153, 110592, v153
    s_waitcnt vmcnt(0)
    v_xor_b32 v9, v8, v133
    v_xor_b32 v146, v8, v135
    v_or_b32 v9, v9, v146
    v_cmp_ne_u32 vcc, 0, v9
    s_cbranch_vccz ga_125
    s_mov_b32 s15, 0
sp_126:
    buffer_load_dwordx4 v[132:135], v5, s[72:75], s20 offen sc1
    s_add_u32 s15, s15, 1
    s_cmp_gt_u32 s15, 100000
    s_cbranch_scc1 sp_126_x
    s_waitcnt vmcnt(0)
    v_xor_b32 v9, v8, v133
    v_xor_b32 v146, v8, v135
    v_or_b32 v9, v9, v146
    v_cmp_ne_u32 vcc, 0, v9
    s_cbranch_vccnz sp_126
sp_126_x:
    s_waitcnt vmcnt(0)
ga_125:
    buffer_load_dwordx4 v[112:115], v155, s[44:47], s53 offen offset:0 sc1
    buffer_load_dwordx4 v[116:119], v155, s[44:47], s53 offen offset:1024 sc1
    buffer_load_dwordx4 v[120:123], v155, s[44:47], s53 offen offset:2048 sc1
    buffer_load_dwordx4 v[124:127], v155, s[44:47], s53 offen offset:3072 sc1
    buffer_load_dwordx4 v[128:131], v155, s[44:47], s54 offen offset:0 sc1
    v_add_f32_dpp v132, v132, v132 row_ror:8 row_mask:0xf bank_mask:0xf
    v_add_f32_dpp v134, v134, v134 row_ror:8 row_mask:0xf bank_mask:0xf
    s_nop 1
    v_permlane32_swap_b32 v132, v134
    v_add_f32 v132, v132, v134
    v_mov_b32 v146, v132
    s_nop 1
    v_permlane16_swap_b32 v132, v146
    v_add_f32 v132, v132, v146
    v_mov_b32 v134, v132
    s_nop 1
    v_permlane32_swap_b32 v132, v134
    v_cvt_pk_bf16_f32 v146, v132, v134
    v_lshlrev_b32 v132, 16, v146
    v_and_b32 v133, 0xffff0000, v146
    v_add_f32 v132, s58, v132
    v_add_f32 v133, s58, v133
    v_cvt_pk_bf16_f32 v146, v132, v133
    v_lshlrev_b32 v132, 16, v146
    v_and_b32 v133, 0xffff0000, v146
    ds_write_b64 v154, v[132:133]
    s_waitcnt lgkmcnt(0)
    ds_write_b32 v11, v1 offset:320
    s_waitcnt vmcnt(0)
    v_xor_b32 v9, v8, v113
    v_xor_b32 v146, v8, v115
    v_or_b32 v9, v9, v146
    v_xor_b32 v146, v8, v117
    v_or_b32 v9, v9, v146
    v_xor_b32 v146, v8, v119
    v_or_b32 v9, v9, v146
    v_xor_b32 v146, v8, v121
    v_or_b32 v9, v9, v146
    v_xor_b32 v146, v8, v123
    v_or_b32 v9, v9, v146
    v_xor_b32 v146, v8, v125
    v_or_b32 v9, v9, v146
    v_xor_b32 v146, v8, v127
    v_or_b32 v9, v9, v146
    v_xor_b32 v146, v8, v129
    v_or_b32 v9, v9, v146
    v_xor_b32 v146, v8, v131
    v_or_b32 v9, v9, v146
    v_cmp_ne_u32 vcc, 0, v9
    s_cbranch_vccz rs_127
    s_mov_b32 s15, 0
sp_128:
    buffer_load_dwordx4 v[112:115], v155, s[44:47], s53 offen offset:0 sc1
    buffer_load_dwordx4 v[116:119], v155, s[44:47], s53 offen offset:1024 sc1
    buffer_load_dwordx4 v[120:123], v155, s[44:47], s53 offen offset:2048 sc1
    buffer_load_dwordx4 v[124:127], v155, s[44:47], s53 offen offset:3072 sc1
    buffer_load_dwordx4 v[128:131], v155, s[44:47], s54 offen offset:0 sc1
    s_add_u32 s15, s15, 1
    s_cmp_gt_u32 s15, 100000
    s_cbranch_scc1 sp_128_x
    s_waitcnt vmcnt(0)
    v_xor_b32 v9, v8, v113
    v_xor_b32 v146, v8, v115
    v_or_b32 v9, v9, v146
    v_xor_b32 v146, v8, v117
    v_or_b32 v9, v9, v146
    v_xor_b32 v146, v8, v119
    v_or_b32 v9, v9, v146
    v_xor_b32 v146, v8, v121
    v_or_b32 v9, v9, v146
    v_xor_b32 v146, v8, v123
    v_or_b32 v9, v9, v146
    v_xor_b32 v146, v8, v125
    v_or_b32 v9, v9, v146
    v_xor_b32 v146, v8, v127
    v_or_b32 v9, v9, v146
    v_xor_b32 v146, v8, v129
    v_or_b32 v9, v9, v146
    v_xor_b32 v146, v8, v131
    v_or_b32 v9, v9, v146
    v_cmp_ne_u32 vcc, 0, v9
    s_cbranch_vccnz sp_128
sp_128_x:
    s_waitcnt vmcnt(0)
rs_127:
    v_pk_fma_f32 v[12:13], v[12:13], v[112:113], v[114:115] op_sel_hi:[1,0,0]
    v_pk_fma_f32 v[14:15], v[14:15], v[112:113], v[114:115] op_sel_hi:[1,0,0]
    v_pk_fma_f32 v[16:17], v[16:17], v[112:113], v[114:115] op_sel_hi:[1,0,0]
    v_pk_fma_f32 v[18:19], v[18:19], v[112:113], v[114:115] op_sel_hi:[1,0,0]
    v_pk_fma_f32 v[20:21], v[20:21], v[116:117], v[118:119] op_sel_hi:[1,0,0]
    v_pk_fma_f32 v[22:23], v[22:23], v[116:117], v[118:119] op_sel_hi:[1,0,0]
    v_pk_fma_f32 v[24:25], v[24:25], v[116:117], v[118:119] op_sel_hi:[1,0,0]
    v_pk_fma_f32 v[26:27], v[26:27], v[116:117], v[118:119] op_sel_hi:[1,0,0]
    v_pk_fma_f32 v[28:29], v[28:29], v[120:121], v[122:123] op_sel_hi:[1,0,0]
    v_pk_fma_f32 v[30:31], v[30:31], v[120:121], v[122:123] op_sel_hi:[1,0,0]
    v_pk_fma_f32 v[32:33], v[32:33], v[120:121], v[122:123] op_sel_hi:[1,0,0]
    v_pk_fma_f32 v[34:35], v[34:35], v[120:121], v[122:123] op_sel_hi:[1,0,0]
    v_pk_fma_f32 v[36:37], v[36:37], v[124:125], v[126:127] op_sel_hi:[1,0,0]
    v_pk_fma_f32 v[38:39], v[38:39], v[124:125], v[126:127] op_sel_hi:[1,0,0]
    v_pk_fma_f32 v[40:41], v[40:41], v[124:125], v[126:127] op_sel_hi:[1,0,0]
    v_pk_fma_f32 v[42:43], v[42:43], v[124:125], v[126:127] op_sel_hi:[1,0,0]
    v_pk_fma_f32 v[136:137], v[136:137], v[128:129], v[130:131] op_sel_hi:[1,0,0]
    v_pk_fma_f32 v[138:139], v[138:139], v[128:129], v[130:131] op_sel_hi:[1,0,0]
    v_pk_fma_f32 v[140:141], v[140:141], v[128:129], v[130:131] op_sel_hi:[1,0,0]
    v_pk_fma_f32 v[142:143], v[142:143], v[128:129], v[130:131] op_sel_hi:[1,0,0]
    s_mov_b32 s15, 0
sp_129:
    ds_read_b32 v9, v152 offset:320
    s_add_u32 s15, s15, 1
    s_cmp_gt_u32 s15, 4000000
    s_cbranch_scc1 sp_129_x
    s_waitcnt lgkmcnt(0)
    v_cmp_ne_u32 vcc, 1, v9
    s_cbranch_vccnz sp_129
sp_129_x:
    s_waitcnt lgkmcnt(0)
    ds_read_b128 v[112:115], v153 offset:0
    ds_read_b128 v[120:123], v153 offset:128
    ds_read_b128 v[116:119], v153 offset:16
    ds_read_b128 v[124:127], v153 offset:144
    s_add_u32 s24, s55, 229376
    s_add_u32 s25, s55, 458752
    s_add_u32 s26, s55, 688128
    s_waitcnt lgkmcnt(0)
    v_pk_fma_f32 v[12:13], v[12:13], v[120:121], v[112:113]
    v_pk_fma_f32 v[14:15], v[14:15], v[122:123], v[114:115]
    v_pk_fma_f32 v[16:17], v[16:17], v[124:125], v[116:117]
    v_pk_fma_f32 v[18:19], v[18:19], v[126:127], v[118:119]
    v_cvt_pk_bf16_f32 v92, v12, v13
    v_cvt_pk_bf16_f32 v93, v14, v15
    v_cvt_pk_bf16_f32 v94, v16, v17
    v_cvt_pk_bf16_f32 v95, v18, v19
    v_pk_fma_f32 v[20:21], v[20:21], v[120:121], v[112:113]
    v_pk_fma_f32 v[22:23], v[22:23], v[122:123], v[114:115]
    v_pk_fma_f32 v[24:25], v[24:25], v[124:125], v[116:117]
    v_pk_fma_f32 v[26:27], v[26:27], v[126:127], v[118:119]
    v_cvt_pk_bf16_f32 v96, v20, v21
    v_cvt_pk_bf16_f32 v97, v22, v23
    v_cvt_pk_bf16_f32 v98, v24, v25
    v_cvt_pk_bf16_f32 v99, v26, v27
    v_pk_fma_f32 v[28:29], v[28:29], v[120:121], v[112:113]
    v_pk_fma_f32 v[30:31], v[30:31], v[122:123], v[114:115]
    v_pk_fma_f32 v[32:33], v[32:33], v[124:125], v[116:117]
    v_pk_fma_f32 v[34:35], v[34:35], v[126:127], v[118:119]
    v_cvt_pk_bf16_f32 v100, v28, v29
    v_cvt_pk_bf16_f32 v101, v30, v31
    v_cvt_pk_bf16_f32 v102, v32, v33
    v_cvt_pk_bf16_f32 v103, v34, v35
    v_pk_fma_f32 v[36:37], v[36:37], v[120:121], v[112:113]
    v_pk_fma_f32 v[38:39], v[38:39], v[122:123], v[114:115]
    v_pk_fma_f32 v[40:41], v[40:41], v[124:125], v[116:117]
    v_pk_fma_f32 v[42:43], v[42:43], v[126:127], v[118:119]
    v_cvt_pk_bf16_f32 v104, v36, v37
    v_cvt_pk_bf16_f32 v105, v38, v39
    v_cvt_pk_bf16_f32 v106, v40, v41
    v_cvt_pk_bf16_f32 v107, v42, v43
    v_pk_fma_f32 v[136:137], v[136:137], v[120:121], v[112:113]
    v_pk_fma_f32 v[138:139], v[138:139], v[122:123], v[114:115]
    v_pk_fma_f32 v[140:141], v[140:141], v[124:125], v[116:117]
    v_pk_fma_f32 v[142:143], v[142:143], v[126:127], v[118:119]
    v_cvt_pk_bf16_f32 v108, v136, v137
    v_cvt_pk_bf16_f32 v109, v138, v139
    v_cvt_pk_bf16_f32 v110, v140, v141
    v_cvt_pk_bf16_f32 v111, v142, v143
    s_cmp_lg_u32 s37, 1
    s_cbranch_scc1 ps_130
pd_131_f:
    buffer_store_dwordx4 v[92:95], v5, s[44:47], s55 offen
    buffer_store_dwordx4 v[96:99], v5, s[44:47], s24 offen
    buffer_store_dwordx4 v[100:103], v5, s[44:47], s25 offen
    buffer_store_dwordx4 v[104:107], v5, s[44:47], s26 offen
    buffer_store_dwordx4 v[108:111], v5, s[44:47], s59 offen
pd_131:
    s_waitcnt vmcnt(0)
    s_mov_b64 exec, 1
    s_cmp_lg_u32 s37, 1
    s_cbranch_scc1 ps_132
pd_133_f:
    buffer_store_dword v8, v6, s[44:47], s56 offen
pd_133:
    s_mov_b64 exec, -1
fe_124:
fj_117:
    s_mov_b32 s53, s31
    s_add_u32 s54, s53, 57344
    s_mov_b32 s15, 0
sp_134:
    buffer_load_dword v9, v64, s[44:47], s30 offen sc1
    s_add_u32 s15, s15, 1
    s_cmp_gt_u32 s15, 100000
    s_cbranch_scc1 sp_134_x
    s_waitcnt vmcnt(0)
    v_cmp_ne_u32 vcc, s36, v9
    s_cbranch_vccnz sp_134
sp_134_x:
    s_waitcnt vmcnt(0)
    s_add_u32 s56, s53, 0
    buffer_load_dwordx4 a[0:3], v5, s[44:47], s56 offen offset:0 sc1
    s_add_u32 s57, s54, 0
    buffer_load_dwordx4 a[4:7], v5, s[44:47], s57 offen offset:0 sc1
    buffer_load_dwordx4 a[8:11], v5, s[44:47], s56 offen offset:1024 sc1
    buffer_load_dwordx4 a[12:15], v5, s[44:47], s57 offen offset:1024 sc1
    s_mov_b32 s15, 0
sp_135:
    ds_read_b32 v64, v10 offset:352
    s_add_u32 s15, s15, 1
    s_cmp_gt_u32 s15, 4000000
    s_cbranch_scc1 sp_135_x
    s_waitcnt lgkmcnt(0)
    v_cmp_ne_u32 vcc, 1, v64
    s_cbranch_vccnz sp_135
sp_135_x:
    s_waitcnt lgkmcnt(0)
    ds_read_b64_tr_b16 v[124:125], v66 offset:0
    ds_read_b64_tr_b16 v[126:127], v66 offset:256
    ds_read_b64_tr_b16 v[128:129], v67 offset:0
    ds_read_b64_tr_b16 v[130:131], v67 offset:256
    ds_read_b64_tr_b16 v[132:133], v66 offset:32768
    ds_read_b64_tr_b16 v[134:135], v66 offset:33024
    ds_read_b64_tr_b16 v[136:137], v67 offset:32768
    ds_read_b64_tr_b16 v[138:139], v67 offset:33024
    ds_read_b64_tr_b16 v[140:141], v68 offset:0
    ds_read_b64_tr_b16 v[142:143], v68 offset:256
    ds_read_b64_tr_b16 v[144:145], v69 offset:0
    ds_read_b64_tr_b16 v[146:147], v69 offset:256
    ds_read_b64_tr_b16 v[148:149], v66 offset:2048
    ds_read_b64_tr_b16 v[150:151], v66 offset:2304
    s_waitcnt vmcnt(2) lgkmcnt(10)
    v_mfma_f32_16x16x32_bf16 v[76:79], v[124:127], a[0:3], 0
    ds_read_b64_tr_b16 v[152:153], v67 offset:2048
    v_mfma_f32_16x16x32_bf16 v[80:83], v[124:127], a[4:7], 0
    ds_read_b64_tr_b16 v[154:155], v67 offset:2304
    v_mfma_f32_16x16x32_bf16 v[84:87], v[128:131], a[0:3], 0
    ds_read_b64_tr_b16 v[124:125], v66 offset:34816
    v_mfma_f32_16x16x32_bf16 v[88:91], v[128:131], a[4:7], 0
    ds_read_b64_tr_b16 v[126:127], v66 offset:35072
    buffer_load_dwordx4 a[16:19], v5, s[44:47], s56 offen offset:2048 sc1
    s_waitcnt lgkmcnt(10)
    v_mfma_f32_16x16x32_bf16 v[92:95], v[132:135], a[0:3], 0
    ds_read_b64_tr_b16 v[128:129], v67 offset:34816
    v_mfma_f32_16x16x32_bf16 v[96:99], v[132:135], a[4:7], 0
    ds_read_b64_tr_b16 v[130:131], v67 offset:35072
    buffer_load_dwordx4 a[20:23], v5, s[44:47], s57 offen offset:2048 sc1
    v_mfma_f32_16x16x32_bf16 v[100:103], v[136:139], a[0:3], 0
    ds_read_b64_tr_b16 v[132:133], v68 offset:2048
    v_mfma_f32_16x16x32_bf16 v[104:107], v[136:139], a[4:7], 0
    ds_read_b64_tr_b16 v[134:135], v68 offset:2304
    s_waitcnt lgkmcnt(10)
    v_mfma_f32_16x16x32_bf16 v[108:111], a[0:3], v[140:143], 0
    ds_read_b64_tr_b16 v[136:137], v69 offset:2048
    v_mfma_f32_16x16x32_bf16 v[112:115], a[4:7], v[140:143], 0
    ds_read_b64_tr_b16 v[138:139], v69 offset:2304
    buffer_load_dwordx4 a[24:27], v5, s[44:47], s56 offen offset:3072 sc1
    v_mfma_f32_16x16x32_bf16 v[116:119], a[0:3], v[144:147], 0
    ds_read_b64_tr_b16 v[140:141], v66 offset:4096
    v_mfma_f32_16x16x32_bf16 v[120:123], a[4:7], v[144:147], 0
    ds_read_b64_tr_b16 v[142:143], v66 offset:4352
    buffer_load_dwordx4 a[28:31], v5, s[44:47], s57 offen offset:3072 sc1
    s_waitcnt vmcnt(4) lgkmcnt(10)
    v_mfma_f32_16x16x32_bf16 v[76:79], v[148:151], a[8:11], v[76:79]
    ds_read_b64_tr_b16 v[144:145], v67 offset:4096
    v_mfma_f32_16x16x32_bf16 v[80:83], v[148:151], a[12:15], v[80:83]
    ds_read_b64_tr_b16 v[146:147], v67 offset:4352
    v_mfma_f32_16x16x32_bf16 v[84:87], v[152:155], a[8:11], v[84:87]
    ds_read_b64_tr_b16 v[148:149], v66 offset:36864
    v_mfma_f32_16x16x32_bf16 v[88:91], v[152:155], a[12:15], v[88:91]
    ds_read_b64_tr_b16 v[150:151], v66 offset:37120
    s_add_u32 s56, s53, 4096
    buffer_load_dwordx4 a[32:35], v5, s[44:47], s56 offen offset:0 sc1
    s_waitcnt lgkmcnt(10)
    v_mfma_f32_16x16x32_bf16 v[92:95], v[124:127], a[8:11], v[92:95]
    ds_read_b64_tr_b16 v[152:153], v67 offset:36864
    v_mfma_f32_16x16x32_bf16 v[96:99], v[124:127], a[12:15], v[96:99]
    ds_read_b64_tr_b16 v[154:155], v67 offset:37120
    s_add_u32 s57, s54, 4096
    buffer_load_dwordx4 a[36:39], v5, s[44:47], s57 offen offset:0 sc1
    v_mfma_f32_16x16x32_bf16 v[100:103], v[128:131], a[8:11], v[100:103]
    ds_read_b64_tr_b16 v[124:125], v68 offset:4096
    v_mfma_f32_16x16x32_bf16 v[104:107], v[128:131], a[12:15], v[104:107]
    ds_read_b64_tr_b16 v[126:127], v68 offset:4352
    s_waitcnt lgkmcnt(10)
    v_mfma_f32_16x16x32_bf16 v[108:111], a[8:11], v[132:135], v[108:111]
    ds_read_b64_tr_b16 v[128:129], v69 offset:4096
    v_mfma_f32_16x16x32_bf16 v[112:115], a[12:15], v[132:135], v[112:115]
    ds_read_b64_tr_b16 v[130:131], v69 offset:4352
    buffer_load_dwordx4 a[40:43], v5, s[44:47], s56 offen offset:1024 sc1
    v_mfma_f32_16x16x32_bf16 v[116:119], a[8:11], v[136:139], v[116:119]
    ds_read_b64_tr_b16 v[132:133], v66 offset:6144
    v_mfma_f32_16x16x32_bf16 v[120:123], a[12:15], v[136:139], v[120:123]
    ds_read_b64_tr_b16 v[134:135], v66 offset:6400
    buffer_load_dwordx4 a[44:47], v5, s[44:47], s57 offen offset:1024 sc1
    s_waitcnt vmcnt(6) lgkmcnt(10)
    v_mfma_f32_16x16x32_bf16 v[76:79], v[140:143], a[16:19], v[76:79]
    ds_read_b64_tr_b16 v[136:137], v67 offset:6144
    v_mfma_f32_16x16x32_bf16 v[80:83], v[140:143], a[20:23], v[80:83]
    ds_read_b64_tr_b16 v[138:139], v67 offset:6400
    v_mfma_f32_16x16x32_bf16 v[84:87], v[144:147], a[16:19], v[84:87]
    ds_read_b32 v64, v10 offset:368
    ds_read_b64_tr_b16 v[140:141], v66 offset:38912
    v_mfma_f32_16x16x32_bf16 v[88:91], v[144:147], a[20:23], v[88:91]
    ds_read_b64_tr_b16 v[142:143], v66 offset:39168
    buffer_load_dwordx4 a[48:51], v5, s[44:47], s56 offen offset:2048 sc1
    s_waitcnt lgkmcnt(11)
    v_mfma_f32_16x16x32_bf16 v[92:95], v[148:151], a[16:19], v[92:95]
    ds_read_b64_tr_b16 v[144:145], v67 offset:38912
    v_mfma_f32_16x16x32_bf16 v[96:99], v[148:151], a[20:23], v[96:99]
    ds_read_b64_tr_b16 v[146:147], v67 offset:39168
    buffer_load_dwordx4 a[52:55], v5, s[44:47], s57 offen offset:2048 sc1
    v_mfma_f32_16x16x32_bf16 v[100:103], v[152:155], a[16:19], v[100:103]
    ds_read_b64_tr_b16 v[148:149], v68 offset:6144
    v_mfma_f32_16x16x32_bf16 v[104:107], v[152:155], a[20:23], v[104:107]
    ds_read_b64_tr_b16 v[150:151], v68 offset:6400
    s_waitcnt lgkmcnt(11)
    v_mfma_f32_16x16x32_bf16 v[108:111], a[16:19], v[124:127], v[108:111]
    ds_read_b64_tr_b16 v[152:153], v69 offset:6144
    v_mfma_f32_16x16x32_bf16 v[112:115], a[20:23], v[124:127], v[112:115]
    ds_read_b64_tr_b16 v[154:155], v69 offset:6400
    buffer_load_dwordx4 a[56:59], v5, s[44:47], s56 offen offset:3072 sc1
    v_mfma_f32_16x16x32_bf16 v[116:119], a[16:19], v[128:131], v[116:119]
    s_waitcnt lgkmcnt(8)
    v_cmp_ne_u32 vcc, 1, v64
    s_cbranch_vccnz gt_136
gt_136_r:
    ds_read_b64_tr_b16 v[124:125], v66 offset:8192
    v_mfma_f32_16x16x32_bf16 v[120:123], a[20:23], v[128:131], v[120:123]
    ds_read_b64_tr_b16 v[126:127], v66 offset:8448
    buffer_load_dwordx4 a[60:63], v5, s[44:47], s57 offen offset:3072 sc1
    ds_write_b32 v11, v1 offset:0
    s_waitcnt vmcnt(8) lgkmcnt(12)
    v_mfma_f32_16x16x32_bf16 v[76:79], v[132:135], a[24:27], v[76:79]
    ds_read_b64_tr_b16 v[128:129], v67 offset:8192
    v_mfma_f32_16x16x32_bf16 v[80:83], v[132:135], a[28:31], v[80:83]
    ds_read_b64_tr_b16 v[130:131], v67 offset:8448
    v_mfma_f32_16x16x32_bf16 v[84:87], v[136:139], a[24:27], v[84:87]
    ds_read_b64_tr_b16 v[132:133], v66 offset:40960
    v_mfma_f32_16x16x32_bf16 v[88:91], v[136:139], a[28:31], v[88:91]
    ds_read_b64_tr_b16 v[134:135], v66 offset:41216
    s_add_u32 s56, s53, 8192
    buffer_load_dwordx4 a[64:67], v5, s[44:47], s56 offen offset:0 sc1
    s_waitcnt lgkmcnt(11)
    v_mfma_f32_16x16x32_bf16 v[92:95], v[140:143], a[24:27], v[92:95]
    ds_read_b64_tr_b16 v[136:137], v67 offset:40960
    v_mfma_f32_16x16x32_bf16 v[96:99], v[140:143], a[28:31], v[96:99]
    ds_read_b64_tr_b16 v[138:139], v67 offset:41216
    s_add_u32 s57, s54, 8192
    buffer_load_dwordx4 a[68:71], v5, s[44:47], s57 offen offset:0 sc1
    v_mfma_f32_16x16x32_bf16 v[100:103], v[144:147], a[24:27], v[100:103]
    ds_read_b64_tr_b16 v[140:141], v68 offset:8192
    v_mfma_f32_16x16x32_bf16 v[104:107], v[144:147], a[28:31], v[104:107]
    ds_read_b64_tr_b16 v[142:143], v68 offset:8448
    s_waitcnt lgkmcnt(11)
    v_mfma_f32_16x16x32_bf16 v[108:111], a[24:27], v[148:151], v[108:111]
    ds_read_b64_tr_b16 v[144:145], v69 offset:8192
    v_mfma_f32_16x16x32_bf16 v[112:115], a[28:31], v[148:151], v[112:115]
    ds_read_b64_tr_b16 v[146:147], v69 offset:8448
    buffer_load_dwordx4 a[72:75], v5, s[44:47], s56 offen offset:1024 sc1
    v_mfma_f32_16x16x32_bf16 v[116:119], a[24:27], v[152:155], v[116:119]
    ds_read_b64_tr_b16 v[148:149], v66 offset:10240
    v_mfma_f32_16x16x32_bf16 v[120:123], a[28:31], v[152:155], v[120:123]
    ds_read_b64_tr_b16 v[150:151], v66 offset:10496
    buffer_load_dwordx4 a[76:79], v5, s[44:47], s57 offen offset:1024 sc1
    s_waitcnt vmcnt(10) lgkmcnt(10)
    v_mfma_f32_16x16x32_bf16 v[76:79], v[124:127], a[32:35], v[76:79]
    ds_read_b64_tr_b16 v[152:153], v67 offset:10240
    v_mfma_f32_16x16x32_bf16 v[80:83], v[124:127], a[36:39], v[80:83]
    ds_read_b64_tr_b16 v[154:155], v67 offset:10496
    v_mfma_f32_16x16x32_bf16 v[84:87], v[128:131], a[32:35], v[84:87]
    ds_read_b64_tr_b16 v[124:125], v66 offset:43008
    v_mfma_f32_16x16x32_bf16 v[88:91], v[128:131], a[36:39], v[88:91]
    ds_read_b64_tr_b16 v[126:127], v66 offset:43264
    buffer_load_dwordx4 a[80:83], v5, s[44:47], s56 offen offset:2048 sc1
    s_waitcnt lgkmcnt(10)
    v_mfma_f32_16x16x32_bf16 v[92:95], v[132:135], a[32:35], v[92:95]
    ds_read_b64_tr_b16 v[128:129], v67 offset:43008
    v_mfma_f32_16x16x32_bf16 v[96:99], v[132:135], a[36:39], v[96:99]
    ds_read_b64_tr_b16 v[130:131], v67 offset:43264
    buffer_load_dwordx4 a[84:87], v5, s[44:47], s57 offen offset:2048 sc1
    v_mfma_f32_16x16x32_bf16 v[100:103], v[136:139], a[32:35], v[100:103]
    ds_read_b64_tr_b16 v[132:133], v68 offset:10240
    v_mfma_f32_16x16x32_bf16 v[104:107], v[136:139], a[36:39], v[104:107]
    ds_read_b64_tr_b16 v[134:135], v68 offset:10496
    s_waitcnt lgkmcnt(10)
    v_mfma_f32_16x16x32_bf16 v[108:111], a[32:35], v[140:143], v[108:111]
    ds_read_b64_tr_b16 v[136:137], v69 offset:10240
    v_mfma_f32_16x16x32_bf16 v[112:115], a[36:39], v[140:143], v[112:115]
    ds_read_b64_tr_b16 v[138:139], v69 offset:10496
    buffer_load_dwordx4 a[88:91], v5, s[44:47], s56 offen offset:3072 sc1
    v_mfma_f32_16x16x32_bf16 v[116:119], a[32:35], v[144:147], v[116:119]
    ds_read_b64_tr_b16 v[140:141], v66 offset:12288
    v_mfma_f32_16x16x32_bf16 v[120:123], a[36:39], v[144:147], v[120:123]
    ds_read_b64_tr_b16 v[142:143], v66 offset:12544
    buffer_load_dwordx4 a[92:95], v5, s[44:47], s57 offen offset:3072 sc1
    s_waitcnt vmcnt(12) lgkmcnt(10)
    v_mfma_f32_16x16x32_bf16 v[76:79], v[148:151], a[40:43], v[76:79]
    ds_read_b64_tr_b16 v[144:145], v67 offset:12288
    v_mfma_f32_16x16x32_bf16 v[80:83], v[148:151], a[44:47], v[80:83]
    ds_read_b64_tr_b16 v[146:147], v67 offset:12544
    v_mfma_f32_16x16x32_bf16 v[84:87], v[152:155], a[40:43], v[84:87]
    ds_read_b64_tr_b16 v[148:149], v66 offset:45056
    v_mfma_f32_16x16x32_bf16 v[88:91], v[152:155], a[44:47], v[88:91]
    ds_read_b64_tr_b16 v[150:151], v66 offset:45312
    s_add_u32 s56, s53, 12288
    buffer_load_dwordx4 v[12:15], v5, s[44:47], s56 offen offset:0 sc1
    s_waitcnt lgkmcnt(10)
    v_mfma_f32_16x16x32_bf16 v[92:95], v[124:127], a[40:43], v[92:95]
    ds_read_b64_tr_b16 v[152:153], v67 offset:45056
    v_mfma_f32_16x16x32_bf16 v[96:99], v[124:127], a[44:47], v[96:99]
    ds_read_b64_tr_b16 v[154:155], v67 offset:45312
    s_add_u32 s57, s54, 12288
    buffer_load_dwordx4 v[16:19], v5, s[44:47], s57 offen offset:0 sc1
    v_mfma_f32_16x16x32_bf16 v[100:103], v[128:131], a[40:43], v[100:103]
    ds_read_b64_tr_b16 v[124:125], v68 offset:12288
    v_mfma_f32_16x16x32_bf16 v[104:107], v[128:131], a[44:47], v[104:107]
    ds_read_b64_tr_b16 v[126:127], v68 offset:12544
    s_waitcnt lgkmcnt(10)
    v_mfma_f32_16x16x32_bf16 v[108:111], a[40:43], v[132:135], v[108:111]
    ds_read_b64_tr_b16 v[128:129], v69 offset:12288
    v_mfma_f32_16x16x32_bf16 v[112:115], a[44:47], v[132:135], v[112:115]
    ds_read_b64_tr_b16 v[130:131], v69 offset:12544
    buffer_load_dwordx4 v[20:23], v5, s[44:47], s56 offen offset:1024 sc1
    v_mfma_f32_16x16x32_bf16 v[116:119], a[40:43], v[136:139], v[116:119]
    ds_read_b64_tr_b16 v[132:133], v66 offset:14336
    v_mfma_f32_16x16x32_bf16 v[120:123], a[44:47], v[136:139], v[120:123]
    ds_read_b64_tr_b16 v[134:135], v66 offset:14592
    buffer_load_dwordx4 v[24:27], v5, s[44:47], s57 offen offset:1024 sc1
    s_waitcnt vmcnt(14) lgkmcnt(10)
    v_mfma_f32_16x16x32_bf16 v[76:79], v[140:143], a[48:51], v[76:79]
    ds_read_b64_tr_b16 v[136:137], v67 offset:14336
    v_mfma_f32_16x16x32_bf16 v[80:83], v[140:143], a[52:55], v[80:83]
    ds_read_b64_tr_b16 v[138:139], v67 offset:14592
    v_mfma_f32_16x16x32_bf16 v[84:87], v[144:147], a[48:51], v[84:87]
    ds_read_b32 v64, v10 offset:384
    ds_read_b64_tr_b16 v[140:141], v66 offset:47104
    v_mfma_f32_16x16x32_bf16 v[88:91], v[144:147], a[52:55], v[88:91]
    ds_read_b64_tr_b16 v[142:143], v66 offset:47360
    buffer_load_dwordx4 v[28:31], v5, s[44:47], s56 offen offset:2048 sc1
    s_waitcnt lgkmcnt(11)
    v_mfma_f32_16x16x32_bf16 v[92:95], v[148:151], a[48:51], v[92:95]
    ds_read_b64_tr_b16 v[144:145], v67 offset:47104
    v_mfma_f32_16x16x32_bf16 v[96:99], v[148:151], a[52:55], v[96:99]
    ds_read_b64_tr_b16 v[146:147], v67 offset:47360
    buffer_load_dwordx4 v[32:35], v5, s[44:47], s57 offen offset:2048 sc1
    v_mfma_f32_16x16x32_bf16 v[100:103], v[152:155], a[48:51], v[100:103]
    ds_read_b64_tr_b16 v[148:149], v68 offset:14336
    v_mfma_f32_16x16x32_bf16 v[104:107], v[152:155], a[52:55], v[104:107]
    ds_read_b64_tr_b16 v[150:151], v68 offset:14592
    s_waitcnt lgkmcnt(11)
    v_mfma_f32_16x16x32_bf16 v[108:111], a[48:51], v[124:127], v[108:111]
    ds_read_b64_tr_b16 v[152:153], v69 offset:14336
    v_mfma_f32_16x16x32_bf16 v[112:115], a[52:55], v[124:127], v[112:115]
    ds_read_b64_tr_b16 v[154:155], v69 offset:14592
    buffer_load_dwordx4 v[36:39], v5, s[44:47], s56 offen offset:3072 sc1
    v_mfma_f32_16x16x32_bf16 v[116:119], a[48:51], v[128:131], v[116:119]
    s_waitcnt lgkmcnt(8)
    v_cmp_ne_u32 vcc, 1, v64
    s_cbranch_vccnz gt_137
gt_137_r:
    ds_read_b64_tr_b16 v[124:125], v66 offset:16384
    v_mfma_f32_16x16x32_bf16 v[120:123], a[52:55], v[128:131], v[120:123]
    ds_read_b64_tr_b16 v[126:127], v66 offset:16640
    buffer_load_dwordx4 v[40:43], v5, s[44:47], s57 offen offset:3072 sc1
    s_waitcnt vmcnt(16) lgkmcnt(11)
    v_mfma_f32_16x16x32_bf16 v[76:79], v[132:135], a[56:59], v[76:79]
    ds_read_b64_tr_b16 v[128:129], v67 offset:16384
    v_mfma_f32_16x16x32_bf16 v[80:83], v[132:135], a[60:63], v[80:83]
    ds_read_b64_tr_b16 v[130:131], v67 offset:16640
    v_mfma_f32_16x16x32_bf16 v[84:87], v[136:139], a[56:59], v[84:87]
    ds_read_b64_tr_b16 v[132:133], v66 offset:49152
    v_mfma_f32_16x16x32_bf16 v[88:91], v[136:139], a[60:63], v[88:91]
    ds_read_b64_tr_b16 v[134:135], v66 offset:49408
    s_waitcnt lgkmcnt(10)
    v_mfma_f32_16x16x32_bf16 v[92:95], v[140:143], a[56:59], v[92:95]
    ds_read_b64_tr_b16 v[136:137], v67 offset:49152
    v_mfma_f32_16x16x32_bf16 v[96:99], v[140:143], a[60:63], v[96:99]
    ds_read_b64_tr_b16 v[138:139], v67 offset:49408
    v_mfma_f32_16x16x32_bf16 v[100:103], v[144:147], a[56:59], v[100:103]
    ds_read_b64_tr_b16 v[140:141], v68 offset:16384
    v_mfma_f32_16x16x32_bf16 v[104:107], v[144:147], a[60:63], v[104:107]
    ds_read_b64_tr_b16 v[142:143], v68 offset:16640
    s_waitcnt lgkmcnt(10)
    v_mfma_f32_16x16x32_bf16 v[108:111], a[56:59], v[148:151], v[108:111]
    ds_read_b64_tr_b16 v[144:145], v69 offset:16384
    v_mfma_f32_16x16x32_bf16 v[112:115], a[60:63], v[148:151], v[112:115]
    ds_read_b64_tr_b16 v[146:147], v69 offset:16640
    v_mfma_f32_16x16x32_bf16 v[116:119], a[56:59], v[152:155], v[116:119]
    ds_read_b64_tr_b16 v[148:149], v66 offset:18432
    v_mfma_f32_16x16x32_bf16 v[120:123], a[60:63], v[152:155], v[120:123]
    ds_read_b64_tr_b16 v[150:151], v66 offset:18688
    s_waitcnt vmcnt(14) lgkmcnt(10)
    v_mfma_f32_16x16x32_bf16 v[76:79], v[124:127], a[64:67], v[76:79]
    ds_read_b64_tr_b16 v[152:153], v67 offset:18432
    v_mfma_f32_16x16x32_bf16 v[80:83], v[124:127], a[68:71], v[80:83]
    ds_read_b64_tr_b16 v[154:155], v67 offset:18688
    v_mfma_f32_16x16x32_bf16 v[84:87], v[128:131], a[64:67], v[84:87]
    ds_read_b64_tr_b16 v[124:125], v66 offset:51200
    v_mfma_f32_16x16x32_bf16 v[88:91], v[128:131], a[68:71], v[88:91]
    ds_read_b64_tr_b16 v[126:127], v66 offset:51456
    s_waitcnt lgkmcnt(10)
    v_mfma_f32_16x16x32_bf16 v[92:95], v[132:135], a[64:67], v[92:95]
    ds_read_b64_tr_b16 v[128:129], v67 offset:51200
    v_mfma_f32_16x16x32_bf16 v[96:99], v[132:135], a[68:71], v[96:99]
    ds_read_b64_tr_b16 v[130:131], v67 offset:51456
    v_mfma_f32_16x16x32_bf16 v[100:103], v[136:139], a[64:67], v[100:103]
    ds_read_b64_tr_b16 v[132:133], v68 offset:18432
    v_mfma_f32_16x16x32_bf16 v[104:107], v[136:139], a[68:71], v[104:107]
    ds_read_b64_tr_b16 v[134:135], v68 offset:18688
    s_waitcnt lgkmcnt(10)
    v_mfma_f32_16x16x32_bf16 v[108:111], a[64:67], v[140:143], v[108:111]
    ds_read_b64_tr_b16 v[136:137], v69 offset:18432
    v_mfma_f32_16x16x32_bf16 v[112:115], a[68:71], v[140:143], v[112:115]
    ds_read_b64_tr_b16 v[138:139], v69 offset:18688
    v_mfma_f32_16x16x32_bf16 v[116:119], a[64:67], v[144:147], v[116:119]
    ds_read_b64_tr_b16 v[140:141], v66 offset:20480
    v_mfma_f32_16x16x32_bf16 v[120:123], a[68:71], v[144:147], v[120:123]
    ds_read_b64_tr_b16 v[142:143], v66 offset:20736
    s_waitcnt vmcnt(12) lgkmcnt(10)
    v_mfma_f32_16x16x32_bf16 v[76:79], v[148:151], a[72:75], v[76:79]
    ds_read_b64_tr_b16 v[144:145], v67 offset:20480
    v_mfma_f32_16x16x32_bf16 v[80:83], v[148:151], a[76:79], v[80:83]
    ds_read_b64_tr_b16 v[146:147], v67 offset:20736
    v_mfma_f32_16x16x32_bf16 v[84:87], v[152:155], a[72:75], v[84:87]
    ds_read_b64_tr_b16 v[148:149], v66 offset:53248
    v_mfma_f32_16x16x32_bf16 v[88:91], v[152:155], a[76:79], v[88:91]
    ds_read_b64_tr_b16 v[150:151], v66 offset:53504
    s_waitcnt lgkmcnt(10)
    v_mfma_f32_16x16x32_bf16 v[92:95], v[124:127], a[72:75], v[92:95]
    ds_read_b64_tr_b16 v[152:153], v67 offset:53248
    v_mfma_f32_16x16x32_bf16 v[96:99], v[124:127], a[76:79], v[96:99]
    ds_read_b64_tr_b16 v[154:155], v67 offset:53504
    v_mfma_f32_16x16x32_bf16 v[100:103], v[128:131], a[72:75], v[100:103]
    ds_read_b64_tr_b16 v[124:125], v68 offset:20480
    v_mfma_f32_16x16x32_bf16 v[104:107], v[128:131], a[76:79], v[104:107]
    ds_read_b64_tr_b16 v[126:127], v68 offset:20736
    s_waitcnt lgkmcnt(10)
    v_mfma_f32_16x16x32_bf16 v[108:111], a[72:75], v[132:135], v[108:111]
    ds_read_b64_tr_b16 v[128:129], v69 offset:20480
    v_mfma_f32_16x16x32_bf16 v[112:115], a[76:79], v[132:135], v[112:115]
    ds_read_b64_tr_b16 v[130:131], v69 offset:20736
    v_mfma_f32_16x16x32_bf16 v[116:119], a[72:75], v[136:139], v[116:119]
    ds_read_b64_tr_b16 v[132:133], v66 offset:22528
    v_mfma_f32_16x16x32_bf16 v[120:123], a[76:79], v[136:139], v[120:123]
    ds_read_b64_tr_b16 v[134:135], v66 offset:22784
    s_waitcnt vmcnt(10) lgkmcnt(10)
    v_mfma_f32_16x16x32_bf16 v[76:79], v[140:143], a[80:83], v[76:79]
    ds_read_b64_tr_b16 v[136:137], v67 offset:22528
    v_mfma_f32_16x16x32_bf16 v[80:83], v[140:143], a[84:87], v[80:83]
    ds_read_b64_tr_b16 v[138:139], v67 offset:22784
    v_mfma_f32_16x16x32_bf16 v[84:87], v[144:147], a[80:83], v[84:87]
    ds_read_b32 v64, v10 offset:400
    ds_read_b64_tr_b16 v[140:141], v66 offset:55296
    v_mfma_f32_16x16x32_bf16 v[88:91], v[144:147], a[84:87], v[88:91]
    ds_read_b64_tr_b16 v[142:143], v66 offset:55552
    s_waitcnt lgkmcnt(11)
    v_mfma_f32_16x16x32_bf16 v[92:95], v[148:151], a[80:83], v[92:95]
    ds_read_b64_tr_b16 v[144:145], v67 offset:55296
    v_mfma_f32_16x16x32_bf16 v[96:99], v[148:151], a[84:87], v[96:99]
    ds_read_b64_tr_b16 v[146:147], v67 offset:55552
    v_mfma_f32_16x16x32_bf16 v[100:103], v[152:155], a[80:83], v[100:103]
    ds_read_b64_tr_b16 v[148:149], v68 offset:22528
    v_mfma_f32_16x16x32_bf16 v[104:107], v[152:155], a[84:87], v[104:107]
    ds_read_b64_tr_b16 v[150:151], v68 offset:22784
    s_waitcnt lgkmcnt(11)
    v_mfma_f32_16x16x32_bf16 v[108:111], a[80:83], v[124:127], v[108:111]
    ds_read_b64_tr_b16 v[152:153], v69 offset:22528
    v_mfma_f32_16x16x32_bf16 v[112:115], a[84:87], v[124:127], v[112:115]
    ds_read_b64_tr_b16 v[154:155], v69 offset:22784
    v_mfma_f32_16x16x32_bf16 v[116:119], a[80:83], v[128:131], v[116:119]
    s_waitcnt lgkmcnt(8)
    v_cmp_ne_u32 vcc, 1, v64
    s_cbranch_vccnz gt_138
gt_138_r:
    ds_read_b64_tr_b16 v[124:125], v66 offset:24576
    v_mfma_f32_16x16x32_bf16 v[120:123], a[84:87], v[128:131], v[120:123]
    ds_read_b64_tr_b16 v[126:127], v66 offset:24832
    s_waitcnt vmcnt(8) lgkmcnt(11)
    v_mfma_f32_16x16x32_bf16 v[76:79], v[132:135], a[88:91], v[76:79]
    ds_read_b64_tr_b16 v[128:129], v67 offset:24576
    v_mfma_f32_16x16x32_bf16 v[80:83], v[132:135], a[92:95], v[80:83]
    ds_read_b64_tr_b16 v[130:131], v67 offset:24832
    v_mfma_f32_16x16x32_bf16 v[84:87], v[136:139], a[88:91], v[84:87]
    ds_read_b64_tr_b16 v[132:133], v66 offset:57344
    v_mfma_f32_16x16x32_bf16 v[88:91], v[136:139], a[92:95], v[88:91]
    ds_read_b64_tr_b16 v[134:135], v66 offset:57600
    s_waitcnt lgkmcnt(10)
    v_mfma_f32_16x16x32_bf16 v[92:95], v[140:143], a[88:91], v[92:95]
    ds_read_b64_tr_b16 v[136:137], v67 offset:57344
    v_mfma_f32_16x16x32_bf16 v[96:99], v[140:143], a[92:95], v[96:99]
    ds_read_b64_tr_b16 v[138:139], v67 offset:57600
    v_mfma_f32_16x16x32_bf16 v[100:103], v[144:147], a[88:91], v[100:103]
    ds_read_b64_tr_b16 v[140:141], v68 offset:24576
    v_mfma_f32_16x16x32_bf16 v[104:107], v[144:147], a[92:95], v[104:107]
    ds_read_b64_tr_b16 v[142:143], v68 offset:24832
    s_waitcnt lgkmcnt(10)
    v_mfma_f32_16x16x32_bf16 v[108:111], a[88:91], v[148:151], v[108:111]
    ds_read_b64_tr_b16 v[144:145], v69 offset:24576
    v_mfma_f32_16x16x32_bf16 v[112:115], a[92:95], v[148:151], v[112:115]
    ds_read_b64_tr_b16 v[146:147], v69 offset:24832
    v_mfma_f32_16x16x32_bf16 v[116:119], a[88:91], v[152:155], v[116:119]
    ds_read_b64_tr_b16 v[148:149], v66 offset:26624
    v_mfma_f32_16x16x32_bf16 v[120:123], a[92:95], v[152:155], v[120:123]
    ds_read_b64_tr_b16 v[150:151], v66 offset:26880
    s_waitcnt vmcnt(6) lgkmcnt(10)
    v_mfma_f32_16x16x32_bf16 v[76:79], v[124:127], v[12:15], v[76:79]
    ds_read_b64_tr_b16 v[152:153], v67 offset:26624
    v_mfma_f32_16x16x32_bf16 v[80:83], v[124:127], v[16:19], v[80:83]
    ds_read_b64_tr_b16 v[154:155], v67 offset:26880
    v_mfma_f32_16x16x32_bf16 v[84:87], v[128:131], v[12:15], v[84:87]
    ds_read_b64_tr_b16 v[124:125], v66 offset:59392
    v_mfma_f32_16x16x32_bf16 v[88:91], v[128:131], v[16:19], v[88:91]
    ds_read_b64_tr_b16 v[126:127], v66 offset:59648
    s_waitcnt lgkmcnt(10)
    v_mfma_f32_16x16x32_bf16 v[92:95], v[132:135], v[12:15], v[92:95]
    ds_read_b64_tr_b16 v[128:129], v67 offset:59392
    v_mfma_f32_16x16x32_bf16 v[96:99], v[132:135], v[16:19], v[96:99]
    ds_read_b64_tr_b16 v[130:131], v67 offset:59648
    v_mfma_f32_16x16x32_bf16 v[100:103], v[136:139], v[12:15], v[100:103]
    ds_read_b64_tr_b16 v[132:133], v68 offset:26624
    v_mfma_f32_16x16x32_bf16 v[104:107], v[136:139], v[16:19], v[104:107]
    ds_read_b64_tr_b16 v[134:135], v68 offset:26880
    s_waitcnt lgkmcnt(10)
    v_mfma_f32_16x16x32_bf16 v[108:111], v[12:15], v[140:143], v[108:111]
    ds_read_b64_tr_b16 v[136:137], v69 offset:26624
    v_mfma_f32_16x16x32_bf16 v[112:115], v[16:19], v[140:143], v[112:115]
    ds_read_b64_tr_b16 v[138:139], v69 offset:26880
    v_mfma_f32_16x16x32_bf16 v[116:119], v[12:15], v[144:147], v[116:119]
    ds_read_b64_tr_b16 v[140:141], v66 offset:28672
    v_mfma_f32_16x16x32_bf16 v[120:123], v[16:19], v[144:147], v[120:123]
    ds_read_b64_tr_b16 v[142:143], v66 offset:28928
    s_waitcnt vmcnt(4) lgkmcnt(10)
    v_mfma_f32_16x16x32_bf16 v[76:79], v[148:151], v[20:23], v[76:79]
    ds_read_b64_tr_b16 v[144:145], v67 offset:28672
    v_mfma_f32_16x16x32_bf16 v[80:83], v[148:151], v[24:27], v[80:83]
    ds_read_b64_tr_b16 v[146:147], v67 offset:28928
    v_mfma_f32_16x16x32_bf16 v[84:87], v[152:155], v[20:23], v[84:87]
    ds_read_b64_tr_b16 v[148:149], v66 offset:61440
    v_mfma_f32_16x16x32_bf16 v[88:91], v[152:155], v[24:27], v[88:91]
    ds_read_b64_tr_b16 v[150:151], v66 offset:61696
    s_waitcnt lgkmcnt(10)
    v_mfma_f32_16x16x32_bf16 v[92:95], v[124:127], v[20:23], v[92:95]
    ds_read_b64_tr_b16 v[152:153], v67 offset:61440
    v_mfma_f32_16x16x32_bf16 v[96:99], v[124:127], v[24:27], v[96:99]
    ds_read_b64_tr_b16 v[154:155], v67 offset:61696
    v_mfma_f32_16x16x32_bf16 v[100:103], v[128:131], v[20:23], v[100:103]
    ds_read_b64_tr_b16 v[124:125], v68 offset:28672
    v_mfma_f32_16x16x32_bf16 v[104:107], v[128:131], v[24:27], v[104:107]
    ds_read_b64_tr_b16 v[126:127], v68 offset:28928
    s_waitcnt lgkmcnt(10)
    v_mfma_f32_16x16x32_bf16 v[108:111], v[20:23], v[132:135], v[108:111]
    ds_read_b64_tr_b16 v[128:129], v69 offset:28672
    v_mfma_f32_16x16x32_bf16 v[112:115], v[24:27], v[132:135], v[112:115]
    ds_read_b64_tr_b16 v[130:131], v69 offset:28928
    v_mfma_f32_16x16x32_bf16 v[116:119], v[20:23], v[136:139], v[116:119]
    ds_read_b64_tr_b16 v[132:133], v66 offset:30720
    v_mfma_f32_16x16x32_bf16 v[120:123], v[24:27], v[136:139], v[120:123]
    ds_read_b64_tr_b16 v[134:135], v66 offset:30976
    s_waitcnt vmcnt(2) lgkmcnt(10)
    v_mfma_f32_16x16x32_bf16 v[76:79], v[140:143], v[28:31], v[76:79]
    ds_read_b64_tr_b16 v[136:137], v67 offset:30720
    v_mfma_f32_16x16x32_bf16 v[80:83], v[140:143], v[32:35], v[80:83]
    ds_read_b64_tr_b16 v[138:139], v67 offset:30976
    v_mfma_f32_16x16x32_bf16 v[84:87], v[144:147], v[28:31], v[84:87]
    ds_read_b64_tr_b16 v[140:141], v66 offset:63488
    v_mfma_f32_16x16x32_bf16 v[88:91], v[144:147], v[32:35], v[88:91]
    ds_read_b64_tr_b16 v[142:143], v66 offset:63744
    s_waitcnt lgkmcnt(10)
    v_mfma_f32_16x16x32_bf16 v[92:95], v[148:151], v[28:31], v[92:95]
    ds_read_b64_tr_b16 v[144:145], v67 offset:63488
    v_mfma_f32_16x16x32_bf16 v[96:99], v[148:151], v[32:35], v[96:99]
    ds_read_b64_tr_b16 v[146:147], v67 offset:63744
    v_mfma_f32_16x16x32_bf16 v[100:103], v[152:155], v[28:31], v[100:103]
    ds_read_b64_tr_b16 v[148:149], v68 offset:30720
    v_mfma_f32_16x16x32_bf16 v[104:107], v[152:155], v[32:35], v[104:107]
    ds_read_b64_tr_b16 v[150:151], v68 offset:30976
    s_waitcnt lgkmcnt(10)
    v_mfma_f32_16x16x32_bf16 v[108:111], v[28:31], v[124:127], v[108:111]
    ds_read_b64_tr_b16 v[152:153], v69 offset:30720
    v_mfma_f32_16x16x32_bf16 v[112:115], v[32:35], v[124:127], v[112:115]
    ds_read_b64_tr_b16 v[154:155], v69 offset:30976
    v_mfma_f32_16x16x32_bf16 v[116:119], v[28:31], v[128:131], v[116:119]
    v_mfma_f32_16x16x32_bf16 v[120:123], v[32:35], v[128:131], v[120:123]
    s_waitcnt vmcnt(0) lgkmcnt(8)
    v_mfma_f32_16x16x32_bf16 v[76:79], v[132:135], v[36:39], v[76:79]
    v_mfma_f32_16x16x32_bf16 v[80:83], v[132:135], v[40:43], v[80:83]
    v_mfma_f32_16x16x32_bf16 v[84:87], v[136:139], v[36:39], v[84:87]
    v_mfma_f32_16x16x32_bf16 v[88:91], v[136:139], v[40:43], v[88:91]
    s_waitcnt lgkmcnt(4)
    v_mfma_f32_16x16x32_bf16 v[92:95], v[140:143], v[36:39], v[92:95]
    v_mfma_f32_16x16x32_bf16 v[96:99], v[140:143], v[40:43], v[96:99]
    v_mfma_f32_16x16x32_bf16 v[100:103], v[144:147], v[36:39], v[100:103]
    v_mfma_f32_16x16x32_bf16 v[104:107], v[144:147], v[40:43], v[104:107]
    s_waitcnt lgkmcnt(0)
    v_mfma_f32_16x16x32_bf16 v[108:111], v[36:39], v[148:151], v[108:111]
    v_mfma_f32_16x16x32_bf16 v[112:115], v[40:43], v[148:151], v[112:115]
    v_mfma_f32_16x16x32_bf16 v[116:119], v[36:39], v[152:155], v[116:119]
    v_mfma_f32_16x16x32_bf16 v[120:123], v[40:43], v[152:155], v[120:123]
    s_lshl_b32 s10, s3, 11
    s_add_u32 s10, s10, 0x20000
    v_add_u32 v16, s10, v5
    v_and_b32 v9, 1, v2
    v_lshlrev_b32 v9, 4, v9
    v_add_u32 v9, 162128, v9
    v_subrev_u32 v17, 4, v11
    s_cmp_eq_u32 s3, 0
    s_cselect_b64 s[20:21], -1, 0
    v_cndmask_b32 v17, v17, v9, s[20:21]
    v_cvt_pk_bf16_f32 v132, v96, v97
    v_cvt_pk_bf16_f32 v133, v98, v99
    v_cvt_pk_bf16_f32 v134, v104, v105
    v_cvt_pk_bf16_f32 v135, v106, v107
    v_cvt_pk_bf16_f32 v20, v112, v113
    v_cvt_pk_bf16_f32 v21, v114, v115
    v_cvt_pk_bf16_f32 v22, v120, v121
    v_cvt_pk_bf16_f32 v23, v122, v123
    ds_write_b128 v16, v[132:135] offset:2048
    ds_write_b128 v16, v[20:23] offset:3072
    v_cvt_pk_bf16_f32 v128, v92, v93
    v_cvt_pk_bf16_f32 v129, v94, v95
    v_cvt_pk_bf16_f32 v130, v100, v101
    v_cvt_pk_bf16_f32 v131, v102, v103
    v_cvt_pk_bf16_f32 v148, v76, v77
    v_cvt_pk_bf16_f32 v149, v78, v79
    v_cvt_pk_bf16_f32 v150, v84, v85
    v_cvt_pk_bf16_f32 v151, v86, v87
    v_cvt_pk_bf16_f32 v152, v80, v81
    v_cvt_pk_bf16_f32 v153, v82, v83
    v_cvt_pk_bf16_f32 v154, v88, v89
    v_cvt_pk_bf16_f32 v155, v90, v91
    s_waitcnt lgkmcnt(0)
    ds_write_b32 v11, v1 offset:80
    v_cvt_pk_bf16_f32 v138, v108, v109
    v_cvt_pk_bf16_f32 v139, v110, v111
    v_mov_b32 v140, v20
    v_mov_b32 v141, v21
    v_cvt_pk_bf16_f32 v144, v116, v117
    v_cvt_pk_bf16_f32 v145, v118, v119
    v_mov_b32 v146, v22
    v_mov_b32 v147, v23
    v_mfma_f32_16x16x16_bf16 v[80:83], v[128:129], v[148:149], 0
    v_mfma_f32_16x16x16_bf16 v[88:91], v[130:131], v[150:151], 0
    v_mfma_f32_16x16x16_bf16 v[96:99], v[132:133], v[152:153], 0
    v_mfma_f32_16x16x16_bf16 v[104:107], v[134:135], v[154:155], 0
    v_mfma_f32_16x16x16_bf16 v[92:95], v[128:129], v[152:153], 0
    v_mfma_f32_16x16x16_bf16 v[100:103], v[130:131], v[154:155], 0
    v_and_b32 v19, 1, v4
    v_cmp_eq_u32 s[20:21], 1, v19
    v_lshl_add_u32 v9, v3, 2, v19
    v_cmp_le_u32 s[22:23], v9, v4
    v_add_u32 v9, 2, v9
    v_cmp_le_u32 s[24:25], v9, v4
    s_add_u32 s9, s4, s14
    s_cmp_eq_u32 s9, 0
    s_cselect_b64 s[26:27], -1, 0
    v_mov_b32 v19, 0xffff
    v_mov_b32 v9, 0xffff0000
    v_cndmask_b32 v19, v19, v9, s[20:21]
    v_mov_b32 v18, 0xcf6e6b28
    s_mov_b32 s28, 0x3eb8aa3b
    s_mov_b32 s15, 0
sp_139:
    ds_read_b32 v9, v17 offset:80
    s_add_u32 s15, s15, 1
    s_cmp_gt_u32 s15, 4000000
    s_cbranch_scc1 sp_139_x
    s_waitcnt lgkmcnt(0)
    v_cmp_ne_u32 vcc, 1, v9
    s_cbranch_vccnz sp_139
sp_139_x:
    s_waitcnt lgkmcnt(0)
    ds_read_b128 v[124:127], v16
    ds_read_b64 v[136:137], v16 offset:1024
    ds_read_b64 v[142:143], v16 offset:1032
    v_cndmask_b32 v12, v19, 0, s[22:23]
    v_cndmask_b32 v13, v19, 0, s[24:25]
    v_cndmask_b32 v14, 0, v19, s[22:23]
    v_cndmask_b32 v15, 0, v19, s[24:25]
    v_cndmask_b32 v30, v80, v81, s[20:21]
    v_cndmask_b32 v31, v82, v83, s[20:21]
    v_cndmask_b32 v34, v88, v89, s[20:21]
    v_cndmask_b32 v35, v90, v91, s[20:21]
    v_cndmask_b32 v38, v96, v97, s[20:21]
    v_cndmask_b32 v39, v98, v99, s[20:21]
    v_cndmask_b32 v42, v104, v105, s[20:21]
    v_cndmask_b32 v43, v106, v107, s[20:21]
    s_waitcnt lgkmcnt(2)
    v_mfma_f32_16x16x16_bf16 v[76:79], v[124:125], v[148:149], 0
    v_mfma_f32_16x16x16_bf16 v[84:87], v[126:127], v[150:151], 0
    v_cndmask_b32 v36, v92, v93, s[20:21]
    v_cndmask_b32 v37, v94, v95, s[20:21]
    v_cndmask_b32 v36, v36, v38, s[22:23]
    v_cndmask_b32 v37, v37, v39, s[24:25]
    v_max_f32 v38, v36, v37
    v_cndmask_b32 v40, v100, v101, s[20:21]
    v_cndmask_b32 v41, v102, v103, s[20:21]
    v_cndmask_b32 v40, v40, v42, s[22:23]
    v_cndmask_b32 v41, v41, v43, s[24:25]
    v_max_f32 v42, v40, v41
    s_mul_i32 s52, s14, 57344
    s_lshl_b32 s9, s13, 10
    s_add_u32 s52, s52, s9
    s_add_u32 s52, s52, 0x32000
    s_add_u32 s53, s52, 57344
    s_lshl_b32 s54, s14, 5
    s_lshl_b32 s9, s13, 2
    s_add_u32 s54, s54, s9
    s_add_u32 s54, s54, 0x500
    v_cndmask_b32 v28, v76, v77, s[20:21]
    v_cndmask_b32 v29, v78, v79, s[20:21]
    v_cndmask_b32 v28, v28, v18, s[26:27]
    v_cndmask_b32 v29, v29, v18, s[26:27]
    v_cndmask_b32 v28, v28, v30, s[22:23]
    v_cndmask_b32 v29, v29, v31, s[24:25]
    v_max_f32 v30, v28, v29
    v_cndmask_b32 v32, v84, v85, s[20:21]
    v_cndmask_b32 v33, v86, v87, s[20:21]
    v_cndmask_b32 v32, v32, v18, s[26:27]
    v_cndmask_b32 v33, v33, v18, s[26:27]
    v_cndmask_b32 v32, v32, v34, s[22:23]
    v_cndmask_b32 v33, v33, v35, s[24:25]
    v_max_f32 v34, v32, v33
    v_permlane32_swap_b32 v30, v38
    s_nop 0
    v_permlane32_swap_b32 v34, v42
    v_max_f32 v30, v30, v38
    v_max_f32 v34, v34, v42
    s_nop 1
    v_permlane16_swap_b32 v30, v34
    v_max_f32 v30, v30, v34
    v_mul_f32 v30, s28, v30
    v_mov_b32 v34, v30
    s_nop 1
    v_permlane16_swap_b32 v30, v34
    v_mov_b32 v38, v30
    v_mov_b32 v42, v34
    s_nop 0
    v_permlane32_swap_b32 v30, v38
    v_permlane32_swap_b32 v34, v42
    v_fma_f32 v28, v28, s28, -v30
    v_fma_f32 v29, v29, s28, -v30
    v_fma_f32 v32, v32, s28, -v34
    v_fma_f32 v33, v33, s28, -v34
    v_fma_f32 v36, v36, s28, -v38
    v_fma_f32 v37, v37, s28, -v38
    v_fma_f32 v40, v40, s28, -v42
    v_fma_f32 v41, v41, s28, -v42
    v_exp_f32 v28, v28
    v_exp_f32 v29, v29
    v_exp_f32 v32, v32
    v_exp_f32 v33, v33
    v_exp_f32 v36, v36
    v_exp_f32 v37, v37
    v_exp_f32 v40, v40
    v_exp_f32 v41, v41
    v_add_f32 v30, v28, v29
    v_add_f32 v34, v32, v33
    v_add_f32 v38, v36, v37
    v_add_f32 v42, v40, v41
    s_nop 0
    v_permlane32_swap_b32 v30, v38
    v_permlane32_swap_b32 v34, v42
    v_add_f32 v30, v30, v38
    v_add_f32 v34, v34, v42
    s_nop 1
    v_permlane16_swap_b32 v30, v34
    v_add_f32 v30, v30, v34
    v_rcp_f32 v30, v30
    s_nop 0
    v_mov_b32 v34, v30
    s_nop 1
    v_permlane16_swap_b32 v30, v34
    v_mov_b32 v38, v30
    v_mov_b32 v42, v34
    s_nop 0
    v_permlane32_swap_b32 v30, v38
    v_permlane32_swap_b32 v34, v42
    v_pk_mul_f32 v[28:29], v[28:29], v[30:31] op_sel_hi:[1,0]
    v_pk_mul_f32 v[32:33], v[32:33], v[34:35] op_sel_hi:[1,0]
    v_pk_mul_f32 v[36:37], v[36:37], v[38:39] op_sel_hi:[1,0]
    v_pk_mul_f32 v[40:41], v[40:41], v[42:43] op_sel_hi:[1,0]
    v_cvt_pk_bf16_f32 v28, v28, v28
    v_cvt_pk_bf16_f32 v29, v29, v29
    v_cvt_pk_bf16_f32 v32, v32, v32
    v_cvt_pk_bf16_f32 v33, v33, v33
    v_cvt_pk_bf16_f32 v36, v36, v36
    v_cvt_pk_bf16_f32 v37, v37, v37
    v_cvt_pk_bf16_f32 v40, v40, v40
    v_cvt_pk_bf16_f32 v41, v41, v41
    s_waitcnt lgkmcnt(0)
    v_and_b32 v80, v28, v12
    v_and_b32 v81, v29, v13
    v_and_b32 v82, v28, v14
    v_and_b32 v83, v29, v15
    v_and_b32 v88, v32, v12
    v_and_b32 v89, v33, v13
    v_and_b32 v90, v32, v14
    v_and_b32 v91, v33, v15
    v_and_b32 v96, v36, v12
    v_and_b32 v97, v37, v13
    v_and_b32 v98, v36, v14
    v_and_b32 v99, v37, v15
    v_and_b32 v104, v40, v12
    v_and_b32 v105, v41, v13
    v_and_b32 v106, v40, v14
    v_and_b32 v107, v41, v15
    v_mfma_f32_16x16x32_bf16 v[76:79], v[136:139], v[80:83], 0
    v_mfma_f32_16x16x32_bf16 v[84:87], v[142:145], v[88:91], 0
    v_mfma_f32_16x16x32_bf16 v[92:95], v[138:141], v[96:99], 0
    v_mfma_f32_16x16x32_bf16 v[100:103], v[144:147], v[104:107], 0
    s_nop 4
    v_cvt_pk_bf16_f32 v28, v76, v77
    v_cvt_pk_bf16_f32 v29, v78, v79
    v_cvt_pk_bf16_f32 v30, v84, v85
    v_cvt_pk_bf16_f32 v31, v86, v87
    v_cvt_pk_bf16_f32 v32, v92, v93
    v_cvt_pk_bf16_f32 v33, v94, v95
    v_cvt_pk_bf16_f32 v34, v100, v101
    v_cvt_pk_bf16_f32 v35, v102, v103
    s_cmp_lg_u32 s37, 1
    s_cbranch_scc1 ps_140
pd_141_f:
    buffer_store_dwordx4 v[28:31], v5, s[44:47], s52 offen
    buffer_store_dwordx4 v[32:35], v5, s[44:47], s53 offen
pd_141:
    v_lshrrev_b32 v66, 2, v2
    v_lshlrev_b32 v66, 7, v66
    v_and_b32 v65, 3, v2
    v_lshl_add_u32 v66, v65, 3, v66
    v_bfe_u32 v65, v2, 3, 2
    v_lshl_add_u32 v66, v65, 5, v66
    v_xor_b32 v67, 32, v66
    v_xor_b32 v68, 64, v66
    v_xor_b32 v69, 96, v66
    s_waitcnt vmcnt(0)
    s_mov_b64 exec, 1
    s_cmp_lg_u32 s37, 1
    s_cbranch_scc1 ps_142
pd_143_f:
    buffer_store_dword v8, v6, s[44:47], s54 offen
pd_143:
    s_mov_b64 exec, -1
    ds_write_b32 v11, v1 offset:240
    buffer_load_dwordx2 v[44:45], v63, s[48:51], s60 offen offset:0
    buffer_load_dwordx2 v[46:47], v63, s[48:51], s60 offen offset:32
    buffer_load_dwordx2 v[48:49], v63, s[48:51], s60 offen offset:64
    buffer_load_dwordx2 v[50:51], v63, s[48:51], s60 offen offset:96
    s_mov_b32 s53, s29
    s_cmp_eq_u32 s34, 0
    s_cselect_b32 s10, 0, 2
    s_cselect_b32 s59, 17, 0
    s_cselect_b32 s58, 2, 0
    s_mov_b32 s64, 0xc000c000
    s_cmov_b32 s64, 0x30003
    s_add_u32 s10, s10, s4
    s_add_u32 s9, s34, 1
    s_and_b32 s9, s9, 14
    s_cmp_lg_u32 s9, 0
    s_cmov_b32 s64, 0
    s_sub_u32 s9, s10, 1
    s_cmp_gt_u32 s9, 7
    s_cmov_b32 s64, 0
    s_and_b32 s9, s7, 2
    s_cmp_lg_u32 s9, s58
    s_cmov_b32 s64, 0
    s_lshl_b32 s65, s10, 21
    s_mul_i32 s9, s59, 57344
    s_add_u32 s65, s65, s9
    s_lshl_b32 s9, s7, 11
    s_add_u32 s65, s65, s9
    s_add_u32 s65, s65, 0x24000
    s_lshl_b32 s66, s10, 21
    s_lshl_b32 s9, s59, 5
    s_add_u32 s66, s66, s9
    s_lshl_b32 s9, s7, 2
    s_add_u32 s66, s66, s9
    s_add_u32 s66, s66, 0x1160
    s_mov_b32 s15, 0
sp_144:
    ds_read_b32 v64, v10 offset:448
    s_add_u32 s15, s15, 1
    s_cmp_gt_u32 s15, 4000000
    s_cbranch_scc1 sp_144_x
    s_waitcnt lgkmcnt(0)
    v_cmp_ne_u32 vcc, 1, v64
    s_cbranch_vccnz sp_144
sp_144_x:
    s_waitcnt lgkmcnt(0)
    v_add_u32 v66, 0x10000, v66
    v_add_u32 v67, 0x10000, v67
    v_add_u32 v68, 0x10000, v68
    v_add_u32 v69, 0x10000, v69
    ds_read_b64_tr_b16 a[32:33], v66 offset:32768
    ds_read_b64_tr_b16 a[34:35], v66 offset:34816
    ds_read_b64_tr_b16 a[36:37], v67 offset:32768
    ds_read_b64_tr_b16 a[38:39], v67 offset:34816
    ds_read_b64_tr_b16 a[40:41], v68 offset:32768
    ds_read_b64_tr_b16 a[42:43], v68 offset:34816
    ds_read_b64_tr_b16 a[44:45], v69 offset:32768
    ds_read_b64_tr_b16 a[46:47], v69 offset:34816
    ds_read_b64_tr_b16 a[48:49], v66 offset:36864
    ds_read_b64_tr_b16 a[50:51], v66 offset:38912
    ds_read_b64_tr_b16 a[52:53], v67 offset:36864
    ds_read_b64_tr_b16 a[54:55], v67 offset:38912
    ds_read_b64_tr_b16 a[56:57], v68 offset:36864
    ds_read_b64_tr_b16 a[58:59], v68 offset:38912
    ds_read_b64_tr_b16 a[60:61], v69 offset:36864
    ds_read_b64_tr_b16 a[62:63], v69 offset:38912
    ds_read_b64_tr_b16 a[64:65], v66 offset:40960
    ds_read_b64_tr_b16 a[66:67], v66 offset:43008
    ds_read_b64_tr_b16 a[68:69], v67 offset:40960
    ds_read_b64_tr_b16 a[70:71], v67 offset:43008
    ds_read_b64_tr_b16 a[72:73], v68 offset:40960
    ds_read_b64_tr_b16 a[74:75], v68 offset:43008
    ds_read_b64_tr_b16 a[76:77], v69 offset:40960
    ds_read_b64_tr_b16 a[78:79], v69 offset:43008
    ds_read_b64_tr_b16 a[80:81], v66 offset:45056
    ds_read_b64_tr_b16 a[82:83], v66 offset:47104
    ds_read_b64_tr_b16 a[84:85], v67 offset:45056
    ds_read_b64_tr_b16 a[86:87], v67 offset:47104
    ds_read_b64_tr_b16 a[88:89], v68 offset:45056
    ds_read_b64_tr_b16 a[90:91], v68 offset:47104
    ds_read_b64_tr_b16 a[92:93], v69 offset:45056
    ds_read_b64_tr_b16 a[94:95], v69 offset:47104
    s_mov_b32 s15, 0
sp_145:
    buffer_load_dword v9, v60, s[44:47], s80 offen sc1
    s_add_u32 s15, s15, 1
    s_cmp_gt_u32 s15, 100000
    s_cbranch_scc1 sp_145_x
    s_waitcnt vmcnt(0)
    v_cmp_ne_u32 vcc, s36, v9
    s_cbranch_vccnz sp_145
sp_145_x:
    s_waitcnt vmcnt(0)
    s_add_u32 s56, s53, 0
    buffer_load_dwordx4 a[0:3], v5, s[44:47], s56 offen offset:0 sc1
    buffer_load_dwordx4 a[4:7], v5, s[44:47], s56 offen offset:1024 sc1
    buffer_load_dwordx4 a[8:11], v5, s[44:47], s56 offen offset:2048 sc1
    buffer_load_dwordx4 a[12:15], v5, s[44:47], s56 offen offset:3072 sc1
    s_add_u32 s56, s53, 4096
    buffer_load_dwordx4 a[16:19], v5, s[44:47], s56 offen offset:0 sc1
    buffer_load_dwordx4 a[20:23], v5, s[44:47], s56 offen offset:1024 sc1
    buffer_load_dwordx4 a[24:27], v5, s[44:47], s56 offen offset:2048 sc1
    ds_read_b64_tr_b16 v[96:97], v66 offset:49152
    ds_read_b64_tr_b16 v[98:99], v66 offset:51200
    ds_read_b64_tr_b16 v[100:101], v67 offset:49152
    ds_read_b64_tr_b16 v[102:103], v67 offset:51200
    ds_read_b64_tr_b16 v[104:105], v68 offset:49152
    ds_read_b64_tr_b16 v[106:107], v68 offset:51200
    ds_read_b64_tr_b16 v[108:109], v69 offset:49152
    ds_read_b64_tr_b16 v[110:111], v69 offset:51200
    ds_read_b64_tr_b16 v[112:113], v66 offset:53248
    ds_read_b64_tr_b16 v[114:115], v66 offset:55296
    ds_read_b64_tr_b16 v[116:117], v67 offset:53248
    ds_read_b64_tr_b16 v[118:119], v67 offset:55296
    ds_read_b64_tr_b16 v[120:121], v68 offset:53248
    ds_read_b64_tr_b16 v[122:123], v68 offset:55296
    ds_read_b64_tr_b16 v[124:125], v69 offset:53248
    ds_read_b64_tr_b16 v[126:127], v69 offset:55296
    ds_read_b64_tr_b16 v[128:129], v66 offset:57344
    ds_read_b64_tr_b16 v[130:131], v66 offset:59392
    ds_read_b64_tr_b16 v[132:133], v67 offset:57344
    ds_read_b64_tr_b16 v[134:135], v67 offset:59392
    ds_read_b64_tr_b16 v[136:137], v68 offset:57344
    ds_read_b64_tr_b16 v[138:139], v68 offset:59392
    ds_read_b64_tr_b16 v[140:141], v69 offset:57344
    ds_read_b64_tr_b16 v[142:143], v69 offset:59392
    ds_read_b32 v64, v10 offset:464
    ds_read_b64_tr_b16 v[144:145], v66 offset:61440
    ds_read_b64_tr_b16 v[146:147], v66 offset:63488
    ds_read_b64_tr_b16 v[148:149], v67 offset:61440
    ds_read_b64_tr_b16 v[150:151], v67 offset:63488
    ds_read_b64_tr_b16 v[152:153], v68 offset:61440
    ds_read_b64_tr_b16 v[154:155], v68 offset:63488
    s_waitcnt vmcnt(6) lgkmcnt(14)
    v_mfma_f32_16x16x32_bf16 v[76:79], a[32:35], a[0:3], 0
    ds_read_b64_tr_b16 v[156:157], v69 offset:61440
    ds_read_b64_tr_b16 v[158:159], v69 offset:63488
    v_mfma_f32_16x16x32_bf16 v[80:83], a[36:39], a[0:3], 0
    s_waitcnt lgkmcnt(8)
    v_cmp_ne_u32 vcc, 1, v64
    s_cbranch_vccnz gt_147
gt_147_r:
    v_add_u32 v66, 0xffff0000, v66
    v_add_u32 v67, 0xffff0000, v67
    v_add_u32 v68, 0xffff0000, v68
    v_add_u32 v69, 0xffff0000, v69
    ds_read_b64_tr_b16 a[32:33], v66 offset:0
    ds_read_b64_tr_b16 a[34:35], v66 offset:2048
    buffer_load_dwordx4 a[28:31], v5, s[44:47], s56 offen offset:3072 sc1
    v_mfma_f32_16x16x32_bf16 v[84:87], a[40:43], a[0:3], 0
    ds_read_b64_tr_b16 a[36:37], v67 offset:0
    ds_read_b64_tr_b16 a[38:39], v67 offset:2048
    v_mfma_f32_16x16x32_bf16 v[88:91], a[44:47], a[0:3], 0
    ds_read_b64_tr_b16 a[40:41], v68 offset:0
    ds_read_b64_tr_b16 a[42:43], v68 offset:2048
    s_waitcnt vmcnt(6) lgkmcnt(14)
    v_mfma_f32_16x16x32_bf16 v[76:79], a[48:51], a[4:7], v[76:79]
    ds_read_b64_tr_b16 a[44:45], v69 offset:0
    ds_read_b64_tr_b16 a[46:47], v69 offset:2048
    v_mfma_f32_16x16x32_bf16 v[80:83], a[52:55], a[4:7], v[80:83]
    ds_read_b64_tr_b16 a[48:49], v66 offset:4096
    ds_read_b64_tr_b16 a[50:51], v66 offset:6144
    s_add_u32 s56, s53, 8192
    buffer_load_dwordx4 a[0:3], v5, s[44:47], s56 offen offset:0 sc1
    v_mfma_f32_16x16x32_bf16 v[84:87], a[56:59], a[4:7], v[84:87]
    ds_read_b64_tr_b16 a[52:53], v67 offset:4096
    ds_read_b64_tr_b16 a[54:55], v67 offset:6144
    v_mfma_f32_16x16x32_bf16 v[88:91], a[60:63], a[4:7], v[88:91]
    ds_read_b64_tr_b16 a[56:57], v68 offset:4096
    ds_read_b64_tr_b16 a[58:59], v68 offset:6144
    s_waitcnt vmcnt(6) lgkmcnt(14)
    v_mfma_f32_16x16x32_bf16 v[76:79], a[64:67], a[8:11], v[76:79]
    ds_read_b64_tr_b16 a[60:61], v69 offset:4096
    ds_read_b64_tr_b16 a[62:63], v69 offset:6144
    v_mfma_f32_16x16x32_bf16 v[80:83], a[68:71], a[8:11], v[80:83]
    ds_read_b64_tr_b16 a[64:65], v66 offset:8192
    ds_read_b64_tr_b16 a[66:67], v66 offset:10240
    buffer_load_dwordx4 a[4:7], v5, s[44:47], s56 offen offset:1024 sc1
    v_mfma_f32_16x16x32_bf16 v[84:87], a[72:75], a[8:11], v[84:87]
    ds_read_b64_tr_b16 a[68:69], v67 offset:8192
    ds_read_b64_tr_b16 a[70:71], v67 offset:10240
    v_mfma_f32_16x16x32_bf16 v[88:91], a[76:79], a[8:11], v[88:91]
    ds_read_b64_tr_b16 a[72:73], v68 offset:8192
    ds_read_b64_tr_b16 a[74:75], v68 offset:10240
    s_waitcnt vmcnt(6) lgkmcnt(14)
    v_mfma_f32_16x16x32_bf16 v[76:79], a[80:83], a[12:15], v[76:79]
    ds_read_b64_tr_b16 a[76:77], v69 offset:8192
    ds_read_b64_tr_b16 a[78:79], v69 offset:10240
    v_mfma_f32_16x16x32_bf16 v[80:83], a[84:87], a[12:15], v[80:83]
    ds_read_b64_tr_b16 a[80:81], v66 offset:12288
    ds_read_b64_tr_b16 a[82:83], v66 offset:14336
    buffer_load_dwordx4 a[8:11], v5, s[44:47], s56 offen offset:2048 sc1
    v_mfma_f32_16x16x32_bf16 v[84:87], a[88:91], a[12:15], v[84:87]
    ds_read_b64_tr_b16 a[84:85], v67 offset:12288
    ds_read_b64_tr_b16 a[86:87], v67 offset:14336
    v_mfma_f32_16x16x32_bf16 v[88:91], a[92:95], a[12:15], v[88:91]
    ds_read_b64_tr_b16 a[88:89], v68 offset:12288
    ds_read_b64_tr_b16 a[90:91], v68 offset:14336
    s_waitcnt vmcnt(6) lgkmcnt(14)
    v_mfma_f32_16x16x32_bf16 v[76:79], v[96:99], a[16:19], v[76:79]
    ds_read_b64_tr_b16 a[92:93], v69 offset:12288
    ds_read_b64_tr_b16 a[94:95], v69 offset:14336
    v_mfma_f32_16x16x32_bf16 v[80:83], v[100:103], a[16:19], v[80:83]
    ds_read_b64_tr_b16 v[96:97], v66 offset:16384
    ds_read_b64_tr_b16 v[98:99], v66 offset:18432
    buffer_load_dwordx4 a[12:15], v5, s[44:47], s56 offen offset:3072 sc1
    v_mfma_f32_16x16x32_bf16 v[84:87], v[104:107], a[16:19], v[84:87]
    ds_read_b64_tr_b16 v[100:101], v67 offset:16384
    ds_read_b64_tr_b16 v[102:103], v67 offset:18432
    v_mfma_f32_16x16x32_bf16 v[88:91], v[108:111], a[16:19], v[88:91]
    ds_read_b64_tr_b16 v[104:105], v68 offset:16384
    ds_read_b64_tr_b16 v[106:107], v68 offset:18432
    s_waitcnt vmcnt(6) lgkmcnt(14)
    v_mfma_f32_16x16x32_bf16 v[76:79], v[112:115], a[20:23], v[76:79]
    ds_read_b64_tr_b16 v[108:109], v69 offset:16384
    ds_read_b64_tr_b16 v[110:111], v69 offset:18432
    v_mfma_f32_16x16x32_bf16 v[80:83], v[116:119], a[20:23], v[80:83]
    ds_read_b64_tr_b16 v[112:113], v66 offset:20480
    ds_read_b64_tr_b16 v[114:115], v66 offset:22528
    s_add_u32 s56, s53, 12288
    buffer_load_dwordx4 a[16:19], v5, s[44:47], s56 offen offset:0 sc1
    v_mfma_f32_16x16x32_bf16 v[84:87], v[120:123], a[20:23], v[84:87]
    ds_read_b64_tr_b16 v[116:117], v67 offset:20480
    ds_read_b64_tr_b16 v[118:119], v67 offset:22528
    v_mfma_f32_16x16x32_bf16 v[88:91], v[124:127], a[20:23], v[88:91]
    ds_read_b64_tr_b16 v[120:121], v68 offset:20480
    ds_read_b64_tr_b16 v[122:123], v68 offset:22528
    s_waitcnt vmcnt(6) lgkmcnt(14)
    v_mfma_f32_16x16x32_bf16 v[76:79], v[128:131], a[24:27], v[76:79]
    ds_read_b64_tr_b16 v[124:125], v69 offset:20480
    ds_read_b64_tr_b16 v[126:127], v69 offset:22528
    v_mfma_f32_16x16x32_bf16 v[80:83], v[132:135], a[24:27], v[80:83]
    ds_read_b64_tr_b16 v[128:129], v66 offset:24576
    ds_read_b64_tr_b16 v[130:131], v66 offset:26624
    buffer_load_dwordx4 a[20:23], v5, s[44:47], s56 offen offset:1024 sc1
    v_mfma_f32_16x16x32_bf16 v[84:87], v[136:139], a[24:27], v[84:87]
    ds_read_b64_tr_b16 v[132:133], v67 offset:24576
    ds_read_b64_tr_b16 v[134:135], v67 offset:26624
    v_mfma_f32_16x16x32_bf16 v[88:91], v[140:143], a[24:27], v[88:91]
    ds_read_b64_tr_b16 v[136:137], v68 offset:24576
    ds_read_b64_tr_b16 v[138:139], v68 offset:26624
    s_waitcnt vmcnt(6) lgkmcnt(14)
    v_mfma_f32_16x16x32_bf16 v[76:79], v[144:147], a[28:31], v[76:79]
    ds_read_b64_tr_b16 v[140:141], v69 offset:24576
    ds_read_b64_tr_b16 v[142:143], v69 offset:26624
    v_mfma_f32_16x16x32_bf16 v[80:83], v[148:151], a[28:31], v[80:83]
    ds_read_b64_tr_b16 v[144:145], v66 offset:28672
    ds_read_b64_tr_b16 v[146:147], v66 offset:30720
    buffer_load_dwordx4 a[24:27], v5, s[44:47], s56 offen offset:2048 sc1
    v_mfma_f32_16x16x32_bf16 v[84:87], v[152:155], a[28:31], v[84:87]
    ds_read_b64_tr_b16 v[148:149], v67 offset:28672
    ds_read_b64_tr_b16 v[150:151], v67 offset:30720
    v_mfma_f32_16x16x32_bf16 v[88:91], v[156:159], a[28:31], v[88:91]
    ds_read_b64_tr_b16 v[152:153], v68 offset:28672
    ds_read_b64_tr_b16 v[154:155], v68 offset:30720
    s_waitcnt vmcnt(6) lgkmcnt(14)
    v_mfma_f32_16x16x32_bf16 v[76:79], a[32:35], a[0:3], v[76:79]
    ds_read_b64_tr_b16 v[156:157], v69 offset:28672
    ds_read_b64_tr_b16 v[158:159], v69 offset:30720
    v_lshlrev_b32 v12, 16, v44
    v_and_b32 v13, 0xffff0000, v44
    v_mfma_f32_16x16x32_bf16 v[80:83], a[36:39], a[0:3], v[80:83]
    v_lshlrev_b32 v14, 16, v45
    v_and_b32 v15, 0xffff0000, v45
    v_lshlrev_b32 v16, 16, v46
    buffer_load_dwordx4 a[28:31], v5, s[44:47], s56 offen offset:3072 sc1
    ds_write_b32 v11, v1 offset:16
    v_mfma_f32_16x16x32_bf16 v[84:87], a[40:43], a[0:3], v[84:87]
    v_and_b32 v17, 0xffff0000, v46
    v_lshlrev_b32 v18, 16, v47
    v_and_b32 v19, 0xffff0000, v47
    v_mfma_f32_16x16x32_bf16 v[88:91], a[44:47], a[0:3], v[88:91]
    v_lshlrev_b32 v20, 16, v48
    v_and_b32 v21, 0xffff0000, v48
    v_lshlrev_b32 v22, 16, v49
    s_waitcnt vmcnt(6) lgkmcnt(14)
    v_mfma_f32_16x16x32_bf16 v[76:79], a[48:51], a[4:7], v[76:79]
    v_and_b32 v23, 0xffff0000, v49
    v_lshlrev_b32 v24, 16, v50
    v_and_b32 v25, 0xffff0000, v50
    v_mfma_f32_16x16x32_bf16 v[80:83], a[52:55], a[4:7], v[80:83]
    v_lshlrev_b32 v26, 16, v51
    v_and_b32 v27, 0xffff0000, v51
    s_mov_b32 s15, 0
sp_146:
    ds_read_b32 v65, v10 offset:480
    s_add_u32 s15, s15, 1
    s_cmp_gt_u32 s15, 4000000
    s_cbranch_scc1 sp_146_x
    s_waitcnt lgkmcnt(0)
    v_cmp_ne_u32 vcc, 1, v65
    s_cbranch_vccnz sp_146
sp_146_x:
    s_waitcnt lgkmcnt(0)
    ds_read_b128 v[28:31], v58 offset:0
    ds_read_b128 v[32:35], v58 offset:64
    ds_read_b128 v[36:39], v58 offset:128
    ds_read_b128 v[40:43], v58 offset:192
    v_mfma_f32_16x16x32_bf16 v[84:87], a[56:59], a[4:7], v[84:87]
    v_mfma_f32_16x16x32_bf16 v[88:91], a[60:63], a[4:7], v[88:91]
    s_waitcnt vmcnt(5) lgkmcnt(0)
    ds_write_b32 v11, v1 offset:96
    v_mfma_f32_16x16x32_bf16 v[76:79], a[64:67], a[8:11], v[76:79]
    v_mfma_f32_16x16x32_bf16 v[80:83], a[68:71], a[8:11], v[80:83]
    v_mfma_f32_16x16x32_bf16 v[84:87], a[72:75], a[8:11], v[84:87]
    v_mfma_f32_16x16x32_bf16 v[88:91], a[76:79], a[8:11], v[88:91]
    s_waitcnt vmcnt(4)
    v_mfma_f32_16x16x32_bf16 v[76:79], a[80:83], a[12:15], v[76:79]
    v_mfma_f32_16x16x32_bf16 v[80:83], a[84:87], a[12:15], v[80:83]
    v_mfma_f32_16x16x32_bf16 v[84:87], a[88:91], a[12:15], v[84:87]
    v_mfma_f32_16x16x32_bf16 v[88:91], a[92:95], a[12:15], v[88:91]
    s_waitcnt vmcnt(3)
    v_mfma_f32_16x16x32_bf16 v[76:79], v[96:99], a[16:19], v[76:79]
    v_mfma_f32_16x16x32_bf16 v[80:83], v[100:103], a[16:19], v[80:83]
    v_mfma_f32_16x16x32_bf16 v[84:87], v[104:107], a[16:19], v[84:87]
    v_mfma_f32_16x16x32_bf16 v[88:91], v[108:111], a[16:19], v[88:91]
    s_waitcnt vmcnt(2)
    v_mfma_f32_16x16x32_bf16 v[76:79], v[112:115], a[20:23], v[76:79]
    v_mfma_f32_16x16x32_bf16 v[80:83], v[116:119], a[20:23], v[80:83]
    v_mfma_f32_16x16x32_bf16 v[84:87], v[120:123], a[20:23], v[84:87]
    v_mfma_f32_16x16x32_bf16 v[88:91], v[124:127], a[20:23], v[88:91]
    s_waitcnt vmcnt(1)
    v_mfma_f32_16x16x32_bf16 v[76:79], v[128:131], a[24:27], v[76:79]
    v_mfma_f32_16x16x32_bf16 v[80:83], v[132:135], a[24:27], v[80:83]
    v_mfma_f32_16x16x32_bf16 v[84:87], v[136:139], a[24:27], v[84:87]
    v_mfma_f32_16x16x32_bf16 v[88:91], v[140:143], a[24:27], v[88:91]
    s_waitcnt vmcnt(0)
    v_mfma_f32_16x16x32_bf16 v[76:79], v[144:147], a[28:31], v[76:79]
    v_mfma_f32_16x16x32_bf16 v[80:83], v[148:151], a[28:31], v[80:83]
    v_mfma_f32_16x16x32_bf16 v[84:87], v[152:155], a[28:31], v[84:87]
    v_mfma_f32_16x16x32_bf16 v[88:91], v[156:159], a[28:31], v[88:91]
    ds_read_b128 v[120:123], v58 offset:512
    ds_read_b128 v[124:127], v58 offset:576
    ds_read_b128 v[128:131], v58 offset:640
    ds_read_b128 v[132:135], v58 offset:704
    ds_read_b128 v[136:139], v58 offset:256
    ds_read_b128 v[140:143], v58 offset:320
    ds_read_b128 v[144:147], v58 offset:384
    ds_read_b128 v[148:151], v58 offset:448
    s_waitcnt lgkmcnt(8)
    v_pk_fma_f32 v[12:13], v[76:77], v[28:29], v[12:13]
    v_pk_fma_f32 v[14:15], v[78:79], v[30:31], v[14:15]
    v_pk_fma_f32 v[16:17], v[80:81], v[32:33], v[16:17]
    v_pk_fma_f32 v[18:19], v[82:83], v[34:35], v[18:19]
    v_pk_fma_f32 v[20:21], v[84:85], v[36:37], v[20:21]
    v_pk_fma_f32 v[22:23], v[86:87], v[38:39], v[22:23]
    v_pk_fma_f32 v[24:25], v[88:89], v[40:41], v[24:25]
    v_pk_fma_f32 v[26:27], v[90:91], v[42:43], v[26:27]
    s_waitcnt lgkmcnt(4)
    v_pk_mul_f32 v[28:29], v[12:13], v[120:121]
    v_pk_mul_f32 v[30:31], v[14:15], v[122:123]
    v_pk_mul_f32 v[32:33], v[16:17], v[124:125]
    v_pk_mul_f32 v[34:35], v[18:19], v[126:127]
    v_pk_mul_f32 v[36:37], v[20:21], v[128:129]
    v_pk_mul_f32 v[38:39], v[22:23], v[130:131]
    v_pk_mul_f32 v[40:41], v[24:25], v[132:133]
    v_pk_mul_f32 v[42:43], v[26:27], v[134:135]
    v_cvt_pk_bf16_f32 v96, v28, v29
    v_cvt_pk_bf16_f32 v97, v30, v31
    v_cvt_pk_bf16_f32 v98, v32, v33
    v_cvt_pk_bf16_f32 v99, v34, v35
    v_cvt_pk_bf16_f32 v100, v36, v37
    v_cvt_pk_bf16_f32 v101, v38, v39
    v_cvt_pk_bf16_f32 v102, v40, v41
    v_cvt_pk_bf16_f32 v103, v42, v43
    s_cmp_lg_u32 s37, 1
    s_cbranch_scc1 ps_148
pd_149_f:
    buffer_store_dwordx4 v[96:99], v5, s[44:47], s85 offen offset:0
    buffer_store_dwordx4 v[100:103], v5, s[44:47], s85 offen offset:1024
pd_149:
    v_pk_add_f32 v[104:105], v[12:13], v[14:15]
    v_pk_mul_f32 v[106:107], v[12:13], v[12:13]
    v_pk_fma_f32 v[106:107], v[14:15], v[14:15], v[106:107]
    v_pk_add_f32 v[104:105], v[104:105], v[16:17]
    v_pk_fma_f32 v[106:107], v[16:17], v[16:17], v[106:107]
    v_pk_add_f32 v[104:105], v[104:105], v[18:19]
    v_pk_fma_f32 v[106:107], v[18:19], v[18:19], v[106:107]
    v_pk_add_f32 v[104:105], v[104:105], v[20:21]
    v_pk_fma_f32 v[106:107], v[20:21], v[20:21], v[106:107]
    v_pk_add_f32 v[104:105], v[104:105], v[22:23]
    v_pk_fma_f32 v[106:107], v[22:23], v[22:23], v[106:107]
    v_pk_add_f32 v[104:105], v[104:105], v[24:25]
    v_pk_fma_f32 v[106:107], v[24:25], v[24:25], v[106:107]
    v_pk_add_f32 v[104:105], v[104:105], v[26:27]
    v_pk_fma_f32 v[106:107], v[26:27], v[26:27], v[106:107]
    v_add_f32 v104, v104, v105
    v_add_f32 v106, v106, v107
    s_nop 1
    v_permlane32_swap_b32 v104, v106
    v_add_f32 v104, v104, v106
    v_mov_b32 v65, v104
    s_nop 1
    v_permlane16_swap_b32 v104, v65
    v_add_f32 v104, v104, v65
    s_cmp_lg_u32 s37, 1
    s_cbranch_scc1 ps_150
pd_151_f:
    buffer_store_dword v104, v62, s[44:47], s81 offen
pd_151:
    s_mov_b32 s15, 0
sp_152:
    ds_read_b32 v64, v10 offset:496
    s_add_u32 s15, s15, 1
    s_cmp_gt_u32 s15, 4000000
    s_cbranch_scc1 sp_152_x
    s_waitcnt lgkmcnt(0)
    v_cmp_ne_u32 vcc, 1, v64
    s_cbranch_vccnz sp_152
sp_152_x:
    s_waitcnt lgkmcnt(0)
    ds_read_b64_tr_b16 a[32:33], v66 offset:32768
    ds_read_b64_tr_b16 a[34:35], v66 offset:34816
    ds_read_b64_tr_b16 a[36:37], v67 offset:32768
    ds_read_b64_tr_b16 a[38:39], v67 offset:34816
    ds_read_b64_tr_b16 a[40:41], v68 offset:32768
    ds_read_b64_tr_b16 a[42:43], v68 offset:34816
    ds_read_b64_tr_b16 a[44:45], v69 offset:32768
    ds_read_b64_tr_b16 a[46:47], v69 offset:34816
    ds_read_b64_tr_b16 a[48:49], v66 offset:36864
    ds_read_b64_tr_b16 a[50:51], v66 offset:38912
    ds_read_b64_tr_b16 a[52:53], v67 offset:36864
    ds_read_b64_tr_b16 a[54:55], v67 offset:38912
    ds_read_b64_tr_b16 a[56:57], v68 offset:36864
    ds_read_b64_tr_b16 a[58:59], v68 offset:38912
    ds_read_b64_tr_b16 a[60:61], v69 offset:36864
    ds_read_b64_tr_b16 a[62:63], v69 offset:38912
    ds_read_b64_tr_b16 a[64:65], v66 offset:40960
    ds_read_b64_tr_b16 a[66:67], v66 offset:43008
    ds_read_b64_tr_b16 a[68:69], v67 offset:40960
    ds_read_b64_tr_b16 a[70:71], v67 offset:43008
    ds_read_b64_tr_b16 a[72:73], v68 offset:40960
    ds_read_b64_tr_b16 a[74:75], v68 offset:43008
    ds_read_b64_tr_b16 a[76:77], v69 offset:40960
    ds_read_b64_tr_b16 a[78:79], v69 offset:43008
    ds_read_b64_tr_b16 a[80:81], v66 offset:45056
    ds_read_b64_tr_b16 a[82:83], v66 offset:47104
    ds_read_b64_tr_b16 a[84:85], v67 offset:45056
    ds_read_b64_tr_b16 a[86:87], v67 offset:47104
    ds_read_b64_tr_b16 a[88:89], v68 offset:45056
    ds_read_b64_tr_b16 a[90:91], v68 offset:47104
    ds_read_b64_tr_b16 a[92:93], v69 offset:45056
    ds_read_b64_tr_b16 a[94:95], v69 offset:47104
    s_waitcnt vmcnt(0)
    s_mov_b64 exec, 1
    s_cmp_lg_u32 s37, 1
    s_cbranch_scc1 ps_153
pd_154_f:
    buffer_store_dword v8, v6, s[44:47], s87 offen
pd_154:
    s_mov_b64 exec, -1
    ds_write_b32 v11, v1 offset:256
    s_add_u32 s53, s76, 0x11c000
    s_mov_b32 s15, 0
sp_155:
    buffer_load_dword v9, v59, s[44:47], s88 offen sc1
    s_add_u32 s15, s15, 1
    s_cmp_gt_u32 s15, 100000
    s_cbranch_scc1 sp_155_x
    s_waitcnt vmcnt(0)
    v_cmp_ne_u32 vcc, s36, v9
    s_cbranch_vccnz sp_155
sp_155_x:
    s_waitcnt vmcnt(0)
    buffer_load_dwordx4 v[92:95], v61, s[44:47], s84 offen offset:0 sc1
    s_add_u32 s56, s53, 0
    buffer_load_dwordx4 a[0:3], v5, s[44:47], s56 offen offset:0 sc1
    buffer_load_dwordx4 a[4:7], v5, s[44:47], s56 offen offset:1024 sc1
    buffer_load_dwordx4 a[8:11], v5, s[44:47], s56 offen offset:2048 sc1
    buffer_load_dwordx4 a[12:15], v5, s[44:47], s56 offen offset:3072 sc1
    s_add_u32 s56, s53, 4096
    buffer_load_dwordx4 a[16:19], v5, s[44:47], s56 offen offset:0 sc1
    buffer_load_dwordx4 a[20:23], v5, s[44:47], s56 offen offset:1024 sc1
    buffer_load_dwordx4 a[24:27], v5, s[44:47], s56 offen offset:2048 sc1
    v_pk_add_f32 v[152:153], v[28:29], v[30:31]
    v_pk_mul_f32 v[154:155], v[28:29], v[28:29]
    v_pk_mul_f32 v[156:157], v[28:29], v[120:121]
    v_pk_mul_f32 v[158:159], v[28:29], v[136:137]
    v_pk_fma_f32 v[154:155], v[30:31], v[30:31], v[154:155]
    v_pk_fma_f32 v[156:157], v[30:31], v[122:123], v[156:157]
    v_pk_fma_f32 v[158:159], v[30:31], v[138:139], v[158:159]
    v_pk_add_f32 v[152:153], v[152:153], v[32:33]
    v_pk_fma_f32 v[154:155], v[32:33], v[32:33], v[154:155]
    v_pk_fma_f32 v[156:157], v[32:33], v[124:125], v[156:157]
    v_pk_fma_f32 v[158:159], v[32:33], v[140:141], v[158:159]
    v_pk_add_f32 v[152:153], v[152:153], v[34:35]
    v_pk_fma_f32 v[154:155], v[34:35], v[34:35], v[154:155]
    v_pk_fma_f32 v[156:157], v[34:35], v[126:127], v[156:157]
    v_pk_fma_f32 v[158:159], v[34:35], v[142:143], v[158:159]
    v_pk_add_f32 v[152:153], v[152:153], v[36:37]
    v_pk_fma_f32 v[154:155], v[36:37], v[36:37], v[154:155]
    v_pk_fma_f32 v[156:157], v[36:37], v[128:129], v[156:157]
    v_pk_fma_f32 v[158:159], v[36:37], v[144:145], v[158:159]
    v_pk_add_f32 v[152:153], v[152:153], v[38:39]
    v_pk_fma_f32 v[154:155], v[38:39], v[38:39], v[154:155]
    v_pk_fma_f32 v[156:157], v[38:39], v[130:131], v[156:157]
    v_pk_fma_f32 v[158:159], v[38:39], v[146:147], v[158:159]
    v_pk_add_f32 v[152:153], v[152:153], v[40:41]
    v_pk_fma_f32 v[154:155], v[40:41], v[40:41], v[154:155]
    v_pk_fma_f32 v[156:157], v[40:41], v[132:133], v[156:157]
    v_pk_fma_f32 v[158:159], v[40:41], v[148:149], v[158:159]
    v_pk_add_f32 v[152:153], v[152:153], v[42:43]
    v_pk_fma_f32 v[154:155], v[42:43], v[42:43], v[154:155]
    v_pk_fma_f32 v[156:157], v[42:43], v[134:135], v[156:157]
    v_pk_fma_f32 v[158:159], v[42:43], v[150:151], v[158:159]
    v_add_f32 v152, v152, v153
    v_add_f32 v154, v154, v155
    v_add_f32 v156, v156, v157
    v_add_f32 v158, v158, v159
    v_lshlrev_b32 v65, 8, v4
    v_lshl_add_u32 v65, v3, 3, v65
    v_lshlrev_b32 v45, 2, v61
    v_permlane32_swap_b32 v152, v156
    v_permlane32_swap_b32 v154, v158
    v_add_f32 v152, v152, v156
    v_add_f32 v154, v154, v158
    s_nop 1
    v_permlane16_swap_b32 v152, v154
    v_add_f32 v152, v152, v154
    v_mov_b32 v153, v8
    s_cmp_lg_u32 s37, 1
    s_cbranch_scc1 ps_156
pd_157_f:
    buffer_store_dwordx2 v[152:153], v65, s[44:47], s86 offen
pd_157:
    ds_read_b32 v44, v10 offset:656
    ds_read_b64_tr_b16 v[96:97], v66 offset:49152
    ds_read_b64_tr_b16 v[98:99], v66 offset:51200
    ds_read_b64_tr_b16 v[100:101], v67 offset:49152
    ds_read_b64_tr_b16 v[102:103], v67 offset:51200
    ds_read_b64_tr_b16 v[104:105], v68 offset:49152
    ds_read_b64_tr_b16 v[106:107], v68 offset:51200
    ds_read_b64_tr_b16 v[108:109], v69 offset:49152
    ds_read_b64_tr_b16 v[110:111], v69 offset:51200
    ds_read_b64_tr_b16 v[112:113], v66 offset:53248
    ds_read_b64_tr_b16 v[114:115], v66 offset:55296
    s_waitcnt vmcnt(7) lgkmcnt(14)
    v_mfma_f32_16x16x32_bf16 v[76:79], a[32:35], a[0:3], 0
    ds_read_b64_tr_b16 v[116:117], v67 offset:53248
    ds_read_b64_tr_b16 v[118:119], v67 offset:55296
    v_mfma_f32_16x16x32_bf16 v[80:83], a[36:39], a[0:3], 0
    ds_read_b64_tr_b16 a[32:33], v68 offset:53248
    ds_read_b64_tr_b16 a[34:35], v68 offset:55296
    buffer_load_dwordx4 a[28:31], v5, s[44:47], s56 offen offset:3072 sc1
    v_mfma_f32_16x16x32_bf16 v[84:87], a[40:43], a[0:3], 0
    ds_read_b64_tr_b16 a[36:37], v69 offset:53248
    ds_read_b64_tr_b16 a[38:39], v69 offset:55296
    v_mfma_f32_16x16x32_bf16 v[88:91], a[44:47], a[0:3], 0
    ds_read_b64_tr_b16 a[40:41], v66 offset:57344
    ds_read_b64_tr_b16 a[42:43], v66 offset:59392
    s_waitcnt vmcnt(7) lgkmcnt(14)
    v_mfma_f32_16x16x32_bf16 v[76:79], a[48:51], a[4:7], v[76:79]
    ds_read_b64_tr_b16 a[44:45], v67 offset:57344
    ds_read_b64_tr_b16 a[46:47], v67 offset:59392
    v_pk_add_f32 v[92:93], v[92:93], v[94:95]
    s_nop 1
    v_permlane32_swap_b32 v92, v93
    v_mfma_f32_16x16x32_bf16 v[80:83], a[52:55], a[4:7], v[80:83]
    ds_read_b64_tr_b16 a[48:49], v68 offset:57344
    ds_read_b64_tr_b16 a[50:51], v68 offset:59392
    v_add_f32 v92, v92, v93
    v_mov_b32 v65, v92
    s_add_u32 s56, s53, 8192
    buffer_load_dwordx4 a[0:3], v5, s[44:47], s56 offen offset:0 sc1
    v_mfma_f32_16x16x32_bf16 v[84:87], a[56:59], a[4:7], v[84:87]
    ds_read_b64_tr_b16 a[52:53], v69 offset:57344
    ds_read_b64_tr_b16 a[54:55], v69 offset:59392
    v_permlane16_swap_b32 v92, v65
    v_add_f32 v92, v92, v65
    v_mfma_f32_16x16x32_bf16 v[88:91], a[60:63], a[4:7], v[88:91]
    ds_read_b64_tr_b16 a[56:57], v66 offset:61440
    ds_read_b64_tr_b16 a[58:59], v66 offset:63488
    v_mov_b32 v93, v92
    s_nop 1
    v_permlane32_swap_b32 v92, v93
    s_waitcnt vmcnt(7) lgkmcnt(14)
    v_mfma_f32_16x16x32_bf16 v[76:79], a[64:67], a[8:11], v[76:79]
    ds_read_b64_tr_b16 a[60:61], v67 offset:61440
    ds_read_b64_tr_b16 a[62:63], v67 offset:63488
    v_mul_f32 v92, 0x3b000000, v92
    v_mov_b32 v65, 0x3727c5ac
    v_mfma_f32_16x16x32_bf16 v[80:83], a[68:71], a[8:11], v[80:83]
    ds_read_b64_tr_b16 a[64:65], v68 offset:61440
    ds_read_b64_tr_b16 a[66:67], v68 offset:63488
    v_fmac_f32 v65, 0x3b000000, v93
    v_fma_f32 v65, -v92, v92, v65
    buffer_load_dwordx4 a[4:7], v5, s[44:47], s56 offen offset:1024 sc1
    v_mfma_f32_16x16x32_bf16 v[84:87], a[72:75], a[8:11], v[84:87]
    ds_read_b64_tr_b16 a[68:69], v69 offset:61440
    ds_read_b64_tr_b16 a[70:71], v69 offset:63488
    v_max_f32 v65, 0x3727c5ac, v65
    v_rsq_f32 v54, v65
    v_mfma_f32_16x16x32_bf16 v[88:91], a[76:79], a[8:11], v[88:91]
    v_add_u32 v66, 0x10000, v66
    v_add_u32 v67, 0x10000, v67
    v_add_u32 v68, 0x10000, v68
    v_add_u32 v69, 0x10000, v69
    ds_read_b64_tr_b16 a[72:73], v66 offset:0
    ds_read_b64_tr_b16 a[74:75], v66 offset:2048
    v_mul_f32 v55, -v92, v54
    s_waitcnt vmcnt(7) lgkmcnt(14)
    v_mfma_f32_16x16x32_bf16 v[76:79], a[80:83], a[12:15], v[76:79]
    ds_read_b64_tr_b16 a[76:77], v67 offset:0
    ds_read_b64_tr_b16 a[78:79], v67 offset:2048
    v_mfma_f32_16x16x32_bf16 v[80:83], a[84:87], a[12:15], v[80:83]
    ds_read_b64_tr_b16 a[80:81], v68 offset:0
    ds_read_b64_tr_b16 a[82:83], v68 offset:2048
    buffer_load_dwordx4 a[8:11], v5, s[44:47], s56 offen offset:2048 sc1
    v_mfma_f32_16x16x32_bf16 v[84:87], a[88:91], a[12:15], v[84:87]
    ds_read_b64_tr_b16 a[84:85], v69 offset:0
    ds_read_b64_tr_b16 a[86:87], v69 offset:2048
    v_mfma_f32_16x16x32_bf16 v[88:91], a[92:95], a[12:15], v[88:91]
    ds_read_b64_tr_b16 a[88:89], v66 offset:4096
    ds_read_b64_tr_b16 a[90:91], v66 offset:6144
    s_waitcnt vmcnt(7) lgkmcnt(14)
    v_mfma_f32_16x16x32_bf16 v[76:79], v[96:99], a[16:19], v[76:79]
    ds_read_b64_tr_b16 a[92:93], v67 offset:4096
    ds_read_b64_tr_b16 a[94:95], v67 offset:6144
    v_mfma_f32_16x16x32_bf16 v[80:83], v[100:103], a[16:19], v[80:83]
    ds_read_b64_tr_b16 v[96:97], v68 offset:4096
    ds_read_b64_tr_b16 v[98:99], v68 offset:6144
    buffer_load_dwordx4 a[12:15], v5, s[44:47], s56 offen offset:3072 sc1
    v_mfma_f32_16x16x32_bf16 v[84:87], v[104:107], a[16:19], v[84:87]
    ds_read_b64_tr_b16 v[100:101], v69 offset:4096
    ds_read_b64_tr_b16 v[102:103], v69 offset:6144
    v_mfma_f32_16x16x32_bf16 v[88:91], v[108:111], a[16:19], v[88:91]
    ds_read_b64_tr_b16 v[104:105], v66 offset:8192
    ds_read_b64_tr_b16 v[106:107], v66 offset:10240
    s_waitcnt vmcnt(7) lgkmcnt(14)
    v_mfma_f32_16x16x32_bf16 v[76:79], v[112:115], a[20:23], v[76:79]
    ds_read_b64_tr_b16 v[108:109], v67 offset:8192
    ds_read_b64_tr_b16 v[110:111], v67 offset:10240
    v_cmp_ne_u32 vcc, 1, v44
    s_cbranch_vccnz rc_158
rc_158_r:
    ds_read_b128 v[120:123], v58 offset:3584
    v_mfma_f32_16x16x32_bf16 v[80:83], v[116:119], a[20:23], v[80:83]
    ds_read_b64_tr_b16 v[112:113], v68 offset:8192
    ds_read_b64_tr_b16 v[114:115], v68 offset:10240
    ds_read_b128 v[124:127], v58 offset:3648
    ds_read_b128 v[128:131], v58 offset:3712
    s_add_u32 s56, s53, 12288
    buffer_load_dwordx4 a[16:19], v5, s[44:47], s56 offen offset:0 sc1
    v_mfma_f32_16x16x32_bf16 v[84:87], a[32:35], a[20:23], v[84:87]
    ds_read_b64_tr_b16 v[116:117], v69 offset:8192
    ds_read_b64_tr_b16 v[118:119], v69 offset:10240
    ds_read_b128 v[132:135], v58 offset:3776
    ds_read_b128 v[136:139], v58 offset:3840
    v_mfma_f32_16x16x32_bf16 v[88:91], a[36:39], a[20:23], v[88:91]
    ds_read_b64_tr_b16 a[32:33], v66 offset:12288
    ds_read_b64_tr_b16 a[34:35], v66 offset:14336
    ds_read_b128 v[140:143], v58 offset:3904
    ds_read_b128 v[144:147], v58 offset:3968
    s_waitcnt vmcnt(7) lgkmcnt(14)
    v_mfma_f32_16x16x32_bf16 v[76:79], a[40:43], a[24:27], v[76:79]
    ds_read_b64_tr_b16 a[36:37], v67 offset:12288
    ds_read_b64_tr_b16 a[38:39], v67 offset:14336
    ds_read_b128 v[148:151], v58 offset:4032
    v_mov_b32 v65, 161536
    v_mfma_f32_16x16x32_bf16 v[80:83], a[44:47], a[24:27], v[80:83]
    ds_read_b64_tr_b16 a[40:41], v68 offset:12288
    ds_read_b64_tr_b16 a[42:43], v68 offset:14336
    ds_read_b128 v[152:155], v65
    ds_read_b128 v[156:159], v65 offset:16
    buffer_load_dwordx4 a[20:23], v5, s[44:47], s56 offen offset:1024 sc1
    v_mfma_f32_16x16x32_bf16 v[84:87], a[48:51], a[24:27], v[84:87]
    ds_read_b64_tr_b16 a[44:45], v69 offset:12288
    ds_read_b64_tr_b16 a[46:47], v69 offset:14336
    v_mfma_f32_16x16x32_bf16 v[88:91], a[52:55], a[24:27], v[88:91]
    ds_read_b64_tr_b16 a[48:49], v66 offset:16384
    ds_read_b64_tr_b16 a[50:51], v66 offset:18432
    s_waitcnt vmcnt(6) lgkmcnt(14)
    v_mfma_f32_16x16x32_bf16 v[76:79], a[56:59], a[28:31], v[76:79]
    ds_read_b64_tr_b16 a[52:53], v67 offset:16384
    ds_read_b64_tr_b16 a[54:55], v67 offset:18432
    v_mfma_f32_16x16x32_bf16 v[80:83], a[60:63], a[28:31], v[80:83]
    ds_read_b64_tr_b16 a[56:57], v68 offset:16384
    ds_read_b64_tr_b16 a[58:59], v68 offset:18432
    buffer_load_dwordx4 a[24:27], v5, s[44:47], s56 offen offset:2048 sc1
    v_mfma_f32_16x16x32_bf16 v[84:87], a[64:67], a[28:31], v[84:87]
    ds_read_b64_tr_b16 a[60:61], v69 offset:16384
    ds_read_b64_tr_b16 a[62:63], v69 offset:18432
    v_mfma_f32_16x16x32_bf16 v[88:91], a[68:71], a[28:31], v[88:91]
    ds_read_b64_tr_b16 a[64:65], v66 offset:20480
    ds_read_b64_tr_b16 a[66:67], v66 offset:22528
    s_waitcnt vmcnt(6) lgkmcnt(14)
    v_mfma_f32_16x16x32_bf16 v[76:79], a[72:75], a[0:3], v[76:79]
    ds_read_b64_tr_b16 a[68:69], v67 offset:20480
    ds_read_b64_tr_b16 a[70:71], v67 offset:22528
    v_mfma_f32_16x16x32_bf16 v[80:83], a[76:79], a[0:3], v[80:83]
    ds_read_b64_tr_b16 a[72:73], v68 offset:20480
    ds_read_b64_tr_b16 a[74:75], v68 offset:22528
    buffer_load_dwordx4 a[28:31], v5, s[44:47], s56 offen offset:3072 sc1
    ds_write_b32 v11, v1 offset:32
    v_mfma_f32_16x16x32_bf16 v[84:87], a[80:83], a[0:3], v[84:87]
    ds_read_b64_tr_b16 a[76:77], v69 offset:20480
    ds_read_b64_tr_b16 a[78:79], v69 offset:22528
    v_mfma_f32_16x16x32_bf16 v[88:91], a[84:87], a[0:3], v[88:91]
    ds_read_b64_tr_b16 a[80:81], v66 offset:24576
    ds_read_b64_tr_b16 a[82:83], v66 offset:26624
    s_waitcnt vmcnt(6) lgkmcnt(14)
    v_mfma_f32_16x16x32_bf16 v[76:79], a[88:91], a[4:7], v[76:79]
    ds_read_b64_tr_b16 a[84:85], v67 offset:24576
    ds_read_b64_tr_b16 a[86:87], v67 offset:26624
    buffer_load_dwordx4 v[28:31], v45, s[44:47], s89 offen offset:0 sc1
    buffer_load_dwordx4 v[32:35], v45, s[44:47], s89 offen offset:16 sc1
    v_mfma_f32_16x16x32_bf16 v[80:83], a[92:95], a[4:7], v[80:83]
    ds_read_b64_tr_b16 a[88:89], v68 offset:24576
    ds_read_b64_tr_b16 a[90:91], v68 offset:26624
    buffer_load_dwordx4 v[36:39], v45, s[44:47], s89 offen offset:32 sc1
    buffer_load_dwordx4 v[40:43], v45, s[44:47], s89 offen offset:48 sc1
    v_mfma_f32_16x16x32_bf16 v[84:87], v[96:99], a[4:7], v[84:87]
    ds_read_b64_tr_b16 a[92:93], v69 offset:24576
    ds_read_b64_tr_b16 a[94:95], v69 offset:26624
    s_waitcnt lgkmcnt(0)
    v_pk_fma_f32 v[136:137], v[120:121], v[54:55], v[136:137] op_sel:[0,1,0] op_sel_hi:[1,1,1]
    v_mfma_f32_16x16x32_bf16 v[88:91], v[100:103], a[4:7], v[88:91]
    ds_read_b64_tr_b16 v[96:97], v66 offset:28672
    ds_read_b64_tr_b16 v[98:99], v66 offset:30720
    v_pk_fma_f32 v[138:139], v[122:123], v[54:55], v[138:139] op_sel:[0,1,0] op_sel_hi:[1,1,1]
    v_pk_fma_f32 v[140:141], v[124:125], v[54:55], v[140:141] op_sel:[0,1,0] op_sel_hi:[1,1,1]
    s_waitcnt vmcnt(9) lgkmcnt(14)
    v_mfma_f32_16x16x32_bf16 v[76:79], v[104:107], a[8:11], v[76:79]
    ds_read_b64_tr_b16 v[100:101], v67 offset:28672
    ds_read_b64_tr_b16 v[102:103], v67 offset:30720
    v_pk_fma_f32 v[142:143], v[126:127], v[54:55], v[142:143] op_sel:[0,1,0] op_sel_hi:[1,1,1]
    v_pk_fma_f32 v[144:145], v[128:129], v[54:55], v[144:145] op_sel:[0,1,0] op_sel_hi:[1,1,1]
    v_mfma_f32_16x16x32_bf16 v[80:83], v[108:111], a[8:11], v[80:83]
    ds_read_b64_tr_b16 v[104:105], v68 offset:28672
    ds_read_b64_tr_b16 v[106:107], v68 offset:30720
    v_pk_fma_f32 v[146:147], v[130:131], v[54:55], v[146:147] op_sel:[0,1,0] op_sel_hi:[1,1,1]
    v_pk_fma_f32 v[148:149], v[132:133], v[54:55], v[148:149] op_sel:[0,1,0] op_sel_hi:[1,1,1]
    v_mfma_f32_16x16x32_bf16 v[84:87], v[112:115], a[8:11], v[84:87]
    ds_read_b64_tr_b16 v[108:109], v69 offset:28672
    ds_read_b64_tr_b16 v[110:111], v69 offset:30720
    v_pk_fma_f32 v[150:151], v[134:135], v[54:55], v[150:151] op_sel:[0,1,0] op_sel_hi:[1,1,1]
    ds_read_b128 v[120:123], v58 offset:1024
    v_mfma_f32_16x16x32_bf16 v[88:91], v[116:119], a[8:11], v[88:91]
    ds_read_b128 v[124:127], v58 offset:1088
    ds_read_b128 v[128:131], v58 offset:1152
    ds_read_b128 v[132:135], v58 offset:1216
    s_waitcnt vmcnt(8) lgkmcnt(14)
    v_mfma_f32_16x16x32_bf16 v[76:79], a[32:35], a[12:15], v[76:79]
    v_add_f32 v154, v154, v157
    v_fmac_f32 v154, v55, v153
    v_fma_f32 v153, v55, v154, v158
    v_mfma_f32_16x16x32_bf16 v[80:83], a[36:39], a[12:15], v[80:83]
    v_fma_f32 v152, v55, v152, v156
    v_mfma_f32_16x16x32_bf16 v[84:87], a[40:43], a[12:15], v[84:87]
    v_mfma_f32_16x16x32_bf16 v[88:91], a[44:47], a[12:15], v[88:91]
    s_waitcnt vmcnt(7) lgkmcnt(0)
    ds_write_b32 v11, v1 offset:112
    v_mfma_f32_16x16x32_bf16 v[76:79], a[48:51], a[16:19], v[76:79]
    s_waitcnt vmcnt(0)
    v_xor_b32 v9, v8, v29
    v_xor_b32 v65, v8, v31
    v_xor_b32 v44, v8, v33
    v_or3_b32 v9, v9, v65, v44
    v_xor_b32 v65, v8, v35
    v_xor_b32 v44, v8, v37
    v_or3_b32 v9, v9, v65, v44
    v_xor_b32 v65, v8, v39
    v_xor_b32 v44, v8, v41
    v_or3_b32 v9, v9, v65, v44
    v_xor_b32 v65, v8, v43
    v_or_b32 v9, v9, v65
    v_cmp_ne_u32 vcc, 0, v9
    s_cbranch_vccnz hs_159
hs_159_r:
    v_add_f32 v28, v28, v36
    v_add_f32 v30, v30, v38
    v_mfma_f32_16x16x32_bf16 v[80:83], a[52:55], a[16:19], v[80:83]
    v_add_f32 v32, v32, v40
    v_add_f32 v34, v34, v42
    s_nop 0
    v_permlane32_swap_b32 v28, v32
    v_mfma_f32_16x16x32_bf16 v[84:87], a[56:59], a[16:19], v[84:87]
    v_permlane32_swap_b32 v30, v34
    v_add_f32 v28, v28, v32
    v_add_f32 v30, v30, v34
    v_mfma_f32_16x16x32_bf16 v[88:91], a[60:63], a[16:19], v[88:91]
    s_nop 0
    v_permlane16_swap_b32 v28, v30
    v_add_f32 v28, v28, v30
    v_mov_b32 v30, v28
    s_waitcnt vmcnt(6)
    v_mfma_f32_16x16x32_bf16 v[76:79], a[64:67], a[20:23], v[76:79]
    v_permlane16_swap_b32 v28, v30
    v_mov_b32 v32, v28
    v_mov_b32 v34, v30
    v_mfma_f32_16x16x32_bf16 v[80:83], a[68:71], a[20:23], v[80:83]
    v_permlane32_swap_b32 v28, v32
    v_permlane32_swap_b32 v30, v34
    v_fmac_f32 v152, v54, v28
    v_mfma_f32_16x16x32_bf16 v[84:87], a[72:75], a[20:23], v[84:87]
    v_fmac_f32 v34, v55, v32
    v_add_f32 v34, v34, v34
    v_fmac_f32 v34, v54, v30
    v_mfma_f32_16x16x32_bf16 v[88:91], a[76:79], a[20:23], v[88:91]
    v_fmac_f32 v153, v54, v34
    v_mul_f32 v95, 0xbb000000, v152
    v_mov_b32 v65, 0x3727c5ac
    s_waitcnt vmcnt(5)
    v_mfma_f32_16x16x32_bf16 v[76:79], a[80:83], a[24:27], v[76:79]
    v_fmac_f32 v65, 0x3b000000, v153
    v_fma_f32 v65, -v95, v95, v65
    v_max_f32 v65, 0x3727c5ac, v65
    v_mfma_f32_16x16x32_bf16 v[80:83], a[84:87], a[24:27], v[80:83]
    v_rsq_f32 v152, v65
    s_nop 0
    v_mul_f32 v94, v65, v152
    v_mul_f32 v93, 0xc0135761, v152
    v_mfma_f32_16x16x32_bf16 v[84:87], a[88:91], a[24:27], v[84:87]
    v_mul_f32 v65, v152, v152
    v_mul_f32 v65, 0x3d372713, v65
    v_mul_f32 v92, v65, v93
    v_mfma_f32_16x16x32_bf16 v[88:91], a[92:95], a[24:27], v[88:91]
    s_waitcnt lgkmcnt(0)
    v_pk_fma_f32 v[136:137], v[120:121], v[94:95], v[136:137] op_sel:[0,1,0] op_sel_hi:[1,1,1]
    v_pk_fma_f32 v[138:139], v[122:123], v[94:95], v[138:139] op_sel:[0,1,0] op_sel_hi:[1,1,1]
    s_waitcnt vmcnt(4)
    v_mfma_f32_16x16x32_bf16 v[76:79], v[96:99], a[28:31], v[76:79]
    v_pk_fma_f32 v[140:141], v[124:125], v[94:95], v[140:141] op_sel:[0,1,0] op_sel_hi:[1,1,1]
    v_pk_fma_f32 v[142:143], v[126:127], v[94:95], v[142:143] op_sel:[0,1,0] op_sel_hi:[1,1,1]
    v_pk_fma_f32 v[144:145], v[128:129], v[94:95], v[144:145] op_sel:[0,1,0] op_sel_hi:[1,1,1]
    v_mfma_f32_16x16x32_bf16 v[80:83], v[100:103], a[28:31], v[80:83]
    v_pk_fma_f32 v[146:147], v[130:131], v[94:95], v[146:147] op_sel:[0,1,0] op_sel_hi:[1,1,1]
    v_pk_fma_f32 v[148:149], v[132:133], v[94:95], v[148:149] op_sel:[0,1,0] op_sel_hi:[1,1,1]
    v_pk_fma_f32 v[150:151], v[134:135], v[94:95], v[150:151] op_sel:[0,1,0] op_sel_hi:[1,1,1]
    v_mfma_f32_16x16x32_bf16 v[84:87], v[104:107], a[28:31], v[84:87]
    v_mfma_f32_16x16x32_bf16 v[88:91], v[108:111], a[28:31], v[88:91]
    v_pk_fma_f32 v[136:137], v[76:77], v[54:55], v[136:137] op_sel_hi:[1,0,1]
    v_pk_fma_f32 v[138:139], v[78:79], v[54:55], v[138:139] op_sel_hi:[1,0,1]
    s_nop 0
    v_pk_fma_f32 v[140:141], v[80:81], v[54:55], v[140:141] op_sel_hi:[1,0,1]
    v_pk_fma_f32 v[142:143], v[82:83], v[54:55], v[142:143] op_sel_hi:[1,0,1]
    s_nop 1
    v_pk_fma_f32 v[144:145], v[84:85], v[54:55], v[144:145] op_sel_hi:[1,0,1]
    v_pk_fma_f32 v[146:147], v[86:87], v[54:55], v[146:147] op_sel_hi:[1,0,1]
    v_pk_fma_f32 v[148:149], v[88:89], v[54:55], v[148:149] op_sel_hi:[1,0,1]
    v_pk_fma_f32 v[150:151], v[90:91], v[54:55], v[150:151] op_sel_hi:[1,0,1]
    v_pk_mul_f32 v[120:121], v[136:137], v[136:137]
    v_pk_mul_f32 v[122:123], v[138:139], v[138:139]
    v_pk_mul_f32 v[124:125], v[140:141], v[140:141]
    v_pk_mul_f32 v[126:127], v[142:143], v[142:143]
    v_pk_mul_f32 v[128:129], v[144:145], v[144:145]
    v_pk_mul_f32 v[130:131], v[146:147], v[146:147]
    v_pk_mul_f32 v[132:133], v[148:149], v[148:149]
    v_pk_mul_f32 v[134:135], v[150:151], v[150:151]
    v_pk_fma_f32 v[120:121], v[120:121], v[92:93], v[92:93] op_sel:[0,0,1] op_sel_hi:[1,0,1]
    v_pk_fma_f32 v[122:123], v[122:123], v[92:93], v[92:93] op_sel:[0,0,1] op_sel_hi:[1,0,1]
    v_pk_fma_f32 v[124:125], v[124:125], v[92:93], v[92:93] op_sel:[0,0,1] op_sel_hi:[1,0,1]
    v_pk_fma_f32 v[126:127], v[126:127], v[92:93], v[92:93] op_sel:[0,0,1] op_sel_hi:[1,0,1]
    v_pk_fma_f32 v[128:129], v[128:129], v[92:93], v[92:93] op_sel:[0,0,1] op_sel_hi:[1,0,1]
    v_pk_fma_f32 v[130:131], v[130:131], v[92:93], v[92:93] op_sel:[0,0,1] op_sel_hi:[1,0,1]
    v_pk_fma_f32 v[132:133], v[132:133], v[92:93], v[92:93] op_sel:[0,0,1] op_sel_hi:[1,0,1]
    v_pk_fma_f32 v[134:135], v[134:135], v[92:93], v[92:93] op_sel:[0,0,1] op_sel_hi:[1,0,1]
    v_pk_mul_f32 v[120:121], v[120:121], v[136:137]
    v_pk_mul_f32 v[122:123], v[122:123], v[138:139]
    v_pk_mul_f32 v[124:125], v[124:125], v[140:141]
    v_pk_mul_f32 v[126:127], v[126:127], v[142:143]
    v_pk_mul_f32 v[128:129], v[128:129], v[144:145]
    v_pk_mul_f32 v[130:131], v[130:131], v[146:147]
    v_pk_mul_f32 v[132:133], v[132:133], v[148:149]
    v_pk_mul_f32 v[134:135], v[134:135], v[150:151]
    v_exp_f32 v120, v120
    v_exp_f32 v121, v121
    v_exp_f32 v122, v122
    v_exp_f32 v123, v123
    v_exp_f32 v124, v124
    v_exp_f32 v125, v125
    v_exp_f32 v126, v126
    v_exp_f32 v127, v127
    v_exp_f32 v128, v128
    v_exp_f32 v129, v129
    v_exp_f32 v130, v130
    v_exp_f32 v131, v131
    v_exp_f32 v132, v132
    v_exp_f32 v133, v133
    v_exp_f32 v134, v134
    v_exp_f32 v135, v135
    v_pk_fma_f32 v[120:121], v[120:121], v[94:95], v[94:95] op_sel_hi:[1,0,0]
    v_pk_fma_f32 v[122:123], v[122:123], v[94:95], v[94:95] op_sel_hi:[1,0,0]
    v_pk_fma_f32 v[124:125], v[124:125], v[94:95], v[94:95] op_sel_hi:[1,0,0]
    v_pk_fma_f32 v[126:127], v[126:127], v[94:95], v[94:95] op_sel_hi:[1,0,0]
    v_pk_fma_f32 v[128:129], v[128:129], v[94:95], v[94:95] op_sel_hi:[1,0,0]
    v_pk_fma_f32 v[130:131], v[130:131], v[94:95], v[94:95] op_sel_hi:[1,0,0]
    v_pk_fma_f32 v[132:133], v[132:133], v[94:95], v[94:95] op_sel_hi:[1,0,0]
    v_pk_fma_f32 v[134:135], v[134:135], v[94:95], v[94:95] op_sel_hi:[1,0,0]
    v_rcp_f32 v120, v120
    v_rcp_f32 v121, v121
    v_rcp_f32 v122, v122
    v_rcp_f32 v123, v123
    v_rcp_f32 v124, v124
    v_rcp_f32 v125, v125
    v_rcp_f32 v126, v126
    v_rcp_f32 v127, v127
    v_rcp_f32 v128, v128
    v_rcp_f32 v129, v129
    v_rcp_f32 v130, v130
    v_rcp_f32 v131, v131
    v_rcp_f32 v132, v132
    v_rcp_f32 v133, v133
    v_rcp_f32 v134, v134
    v_rcp_f32 v135, v135
    v_pk_mul_f32 v[136:137], v[136:137], v[120:121]
    v_pk_mul_f32 v[138:139], v[138:139], v[122:123]
    v_pk_mul_f32 v[140:141], v[140:141], v[124:125]
    v_pk_mul_f32 v[142:143], v[142:143], v[126:127]
    v_pk_mul_f32 v[144:145], v[144:145], v[128:129]
    v_pk_mul_f32 v[146:147], v[146:147], v[130:131]
    v_pk_mul_f32 v[148:149], v[148:149], v[132:133]
    v_pk_mul_f32 v[150:151], v[150:151], v[134:135]
    v_cvt_pk_bf16_f32 v152, v136, v137
    v_cvt_pk_bf16_f32 v153, v138, v139
    v_cvt_pk_bf16_f32 v154, v140, v141
    v_cvt_pk_bf16_f32 v155, v142, v143
    v_cvt_pk_bf16_f32 v156, v144, v145
    v_cvt_pk_bf16_f32 v157, v146, v147
    v_cvt_pk_bf16_f32 v158, v148, v149
    v_cvt_pk_bf16_f32 v159, v150, v151
    s_cmp_lg_u32 s37, 1
    s_cbranch_scc1 ps_160
pd_161_f:
    buffer_store_dwordx4 v[152:155], v5, s[44:47], s90 offen offset:0
    buffer_store_dwordx4 v[156:159], v5, s[44:47], s90 offen offset:1024
pd_161:
    s_cmp_lg_u32 s64, 0
    s_cbranch_scc1 h1h_162
h1h_162_r:
    s_mov_b32 s15, 0
sp_163:
    ds_read_b32 v64, v10 offset:512
    s_add_u32 s15, s15, 1
    s_cmp_gt_u32 s15, 4000000
    s_cbranch_scc1 sp_163_x
    s_waitcnt lgkmcnt(0)
    v_cmp_ne_u32 vcc, 1, v64
    s_cbranch_vccnz sp_163
sp_163_x:
    s_waitcnt lgkmcnt(0)
    ds_read_b64_tr_b16 a[32:33], v66 offset:32768
    ds_read_b64_tr_b16 a[34:35], v66 offset:34816
    ds_read_b64_tr_b16 a[36:37], v67 offset:32768
    ds_read_b64_tr_b16 a[38:39], v67 offset:34816
    ds_read_b64_tr_b16 a[40:41], v68 offset:32768
    ds_read_b64_tr_b16 a[42:43], v68 offset:34816
    ds_read_b64_tr_b16 a[44:45], v69 offset:32768
    ds_read_b64_tr_b16 a[46:47], v69 offset:34816
    ds_read_b64_tr_b16 a[48:49], v66 offset:36864
    ds_read_b64_tr_b16 a[50:51], v66 offset:38912
    ds_read_b64_tr_b16 a[52:53], v67 offset:36864
    ds_read_b64_tr_b16 a[54:55], v67 offset:38912
    ds_read_b64_tr_b16 a[56:57], v68 offset:36864
    ds_read_b64_tr_b16 a[58:59], v68 offset:38912
    ds_read_b64_tr_b16 a[60:61], v69 offset:36864
    ds_read_b64_tr_b16 a[62:63], v69 offset:38912
    ds_read_b64_tr_b16 a[64:65], v66 offset:40960
    ds_read_b64_tr_b16 a[66:67], v66 offset:43008
    ds_read_b64_tr_b16 a[68:69], v67 offset:40960
    ds_read_b64_tr_b16 a[70:71], v67 offset:43008
    ds_read_b64_tr_b16 a[72:73], v68 offset:40960
    ds_read_b64_tr_b16 a[74:75], v68 offset:43008
    ds_read_b64_tr_b16 a[76:77], v69 offset:40960
    ds_read_b64_tr_b16 a[78:79], v69 offset:43008
    ds_read_b64_tr_b16 a[80:81], v66 offset:45056
    ds_read_b64_tr_b16 a[82:83], v66 offset:47104
    ds_read_b64_tr_b16 a[84:85], v67 offset:45056
    ds_read_b64_tr_b16 a[86:87], v67 offset:47104
    ds_read_b64_tr_b16 a[88:89], v68 offset:45056
    ds_read_b64_tr_b16 a[90:91], v68 offset:47104
    ds_read_b64_tr_b16 a[92:93], v69 offset:45056
    ds_read_b64_tr_b16 a[94:95], v69 offset:47104
    s_cmp_lg_u32 s64, 0
    s_cbranch_scc1 h1h_162_f
    s_waitcnt vmcnt(0)
    s_mov_b64 exec, 1
    s_cmp_lg_u32 s37, 1
    s_cbranch_scc1 ps_164
pd_165_f:
    buffer_store_dword v8, v6, s[44:47], s91 offen
pd_165:
    s_mov_b64 exec, -1
h1h_162_fr:
    ds_write_b32 v11, v1 offset:272
    ds_read_b128 v[120:123], v58 offset:512
    ds_read_b128 v[124:127], v58 offset:576
    ds_read_b128 v[128:131], v58 offset:640
    ds_read_b128 v[132:135], v58 offset:704
    ds_read_b128 v[136:139], v58 offset:256
    ds_read_b128 v[140:143], v58 offset:320
    ds_read_b128 v[144:147], v58 offset:384
    ds_read_b128 v[148:151], v58 offset:448
    v_pk_fma_f32 v[28:29], v[12:13], v[54:55], v[54:55] op_sel:[0,0,1] op_sel_hi:[1,0,1]
    v_pk_fma_f32 v[30:31], v[14:15], v[54:55], v[54:55] op_sel:[0,0,1] op_sel_hi:[1,0,1]
    v_pk_fma_f32 v[32:33], v[16:17], v[54:55], v[54:55] op_sel:[0,0,1] op_sel_hi:[1,0,1]
    v_pk_fma_f32 v[34:35], v[18:19], v[54:55], v[54:55] op_sel:[0,0,1] op_sel_hi:[1,0,1]
    v_pk_fma_f32 v[36:37], v[20:21], v[54:55], v[54:55] op_sel:[0,0,1] op_sel_hi:[1,0,1]
    v_pk_fma_f32 v[38:39], v[22:23], v[54:55], v[54:55] op_sel:[0,0,1] op_sel_hi:[1,0,1]
    v_pk_fma_f32 v[40:41], v[24:25], v[54:55], v[54:55] op_sel:[0,0,1] op_sel_hi:[1,0,1]
    v_pk_fma_f32 v[42:43], v[26:27], v[54:55], v[54:55] op_sel:[0,0,1] op_sel_hi:[1,0,1]
    s_waitcnt lgkmcnt(0)
    v_pk_fma_f32 v[28:29], v[28:29], v[120:121], v[136:137]
    v_pk_fma_f32 v[30:31], v[30:31], v[122:123], v[138:139]
    v_pk_fma_f32 v[32:33], v[32:33], v[124:125], v[140:141]
    v_pk_fma_f32 v[34:35], v[34:35], v[126:127], v[142:143]
    v_pk_fma_f32 v[36:37], v[36:37], v[128:129], v[144:145]
    v_pk_fma_f32 v[38:39], v[38:39], v[130:131], v[146:147]
    v_pk_fma_f32 v[40:41], v[40:41], v[132:133], v[148:149]
    v_pk_fma_f32 v[42:43], v[42:43], v[134:135], v[150:151]
    s_mov_b32 s15, 0
sp_166:
    buffer_load_dword v9, v74, s[44:47], s92 offen sc1
    s_add_u32 s15, s15, 1
    s_cmp_gt_u32 s15, 100000
    s_cbranch_scc1 sp_166_x
    s_waitcnt vmcnt(0)
    v_cmp_ne_u32 vcc, s36, v9
    s_cbranch_vccnz sp_166
sp_166_x:
    s_waitcnt vmcnt(0)
    buffer_load_dwordx4 a[0:3], v70, s[44:47], 0 offen offset:0 sc1
    buffer_load_dwordx4 a[4:7], v70, s[44:47], 0 offen offset:1024 sc1
    buffer_load_dwordx4 a[8:11], v70, s[44:47], 0 offen offset:2048 sc1
    buffer_load_dwordx4 a[12:15], v70, s[44:47], 0 offen offset:3072 sc1
    buffer_load_dwordx4 a[16:19], v71, s[44:47], 0 offen offset:0 sc1
    buffer_load_dwordx4 a[20:23], v71, s[44:47], 0 offen offset:1024 sc1
    buffer_load_dwordx4 a[24:27], v71, s[44:47], 0 offen offset:2048 sc1
    ds_read_b64_tr_b16 v[96:97], v66 offset:49152
    ds_read_b64_tr_b16 v[98:99], v66 offset:51200
    ds_read_b64_tr_b16 v[100:101], v67 offset:49152
    ds_read_b64_tr_b16 v[102:103], v67 offset:51200
    ds_read_b64_tr_b16 v[104:105], v68 offset:49152
    ds_read_b64_tr_b16 v[106:107], v68 offset:51200
    ds_read_b64_tr_b16 v[108:109], v69 offset:49152
    ds_read_b64_tr_b16 v[110:111], v69 offset:51200
    ds_read_b64_tr_b16 v[112:113], v66 offset:53248
    ds_read_b64_tr_b16 v[114:115], v66 offset:55296
    ds_read_b64_tr_b16 v[116:117], v67 offset:53248
    ds_read_b64_tr_b16 v[118:119], v67 offset:55296
    ds_read_b64_tr_b16 v[120:121], v68 offset:53248
    ds_read_b64_tr_b16 v[122:123], v68 offset:55296
    ds_read_b64_tr_b16 v[124:125], v69 offset:53248
    ds_read_b64_tr_b16 v[126:127], v69 offset:55296
    ds_read_b64_tr_b16 v[128:129], v66 offset:57344
    ds_read_b64_tr_b16 v[130:131], v66 offset:59392
    ds_read_b64_tr_b16 v[132:133], v67 offset:57344
    ds_read_b64_tr_b16 v[134:135], v67 offset:59392
    ds_read_b64_tr_b16 v[136:137], v68 offset:57344
    ds_read_b64_tr_b16 v[138:139], v68 offset:59392
    ds_read_b64_tr_b16 v[140:141], v69 offset:57344
    ds_read_b64_tr_b16 v[142:143], v69 offset:59392
    ds_read_b64_tr_b16 v[144:145], v66 offset:61440
    ds_read_b64_tr_b16 v[146:147], v66 offset:63488
    ds_read_b64_tr_b16 v[148:149], v67 offset:61440
    ds_read_b64_tr_b16 v[150:151], v67 offset:63488
    ds_read_b64_tr_b16 v[152:153], v68 offset:61440
    ds_read_b64_tr_b16 v[154:155], v68 offset:63488
    s_waitcnt vmcnt(6) lgkmcnt(14)
    v_mfma_f32_16x16x32_bf16 v[76:79], a[32:35], a[0:3], 0
    ds_read_b64_tr_b16 v[156:157], v69 offset:61440
    ds_read_b64_tr_b16 v[158:159], v69 offset:63488
    v_mfma_f32_16x16x32_bf16 v[80:83], a[36:39], a[0:3], 0
    v_add_u32 v66, 0xffff0000, v66
    v_add_u32 v67, 0xffff0000, v67
    v_add_u32 v68, 0xffff0000, v68
    v_add_u32 v69, 0xffff0000, v69
    ds_read_b64_tr_b16 a[32:33], v66 offset:0
    ds_read_b64_tr_b16 a[34:35], v66 offset:2048
    buffer_load_dwordx4 a[28:31], v71, s[44:47], 0 offen offset:3072 sc1
    v_mfma_f32_16x16x32_bf16 v[84:87], a[40:43], a[0:3], 0
    ds_read_b64_tr_b16 a[36:37], v67 offset:0
    ds_read_b64_tr_b16 a[38:39], v67 offset:2048
    v_mfma_f32_16x16x32_bf16 v[88:91], a[44:47], a[0:3], 0
    ds_read_b64_tr_b16 a[40:41], v68 offset:0
    ds_read_b64_tr_b16 a[42:43], v68 offset:2048
    s_waitcnt vmcnt(6) lgkmcnt(14)
    v_mfma_f32_16x16x32_bf16 v[76:79], a[48:51], a[4:7], v[76:79]
    ds_read_b64_tr_b16 a[44:45], v69 offset:0
    ds_read_b64_tr_b16 a[46:47], v69 offset:2048
    v_mfma_f32_16x16x32_bf16 v[80:83], a[52:55], a[4:7], v[80:83]
    ds_read_b64_tr_b16 a[48:49], v66 offset:4096
    ds_read_b64_tr_b16 a[50:51], v66 offset:6144
    buffer_load_dwordx4 a[0:3], v72, s[44:47], 0 offen offset:0 sc1
    v_mfma_f32_16x16x32_bf16 v[84:87], a[56:59], a[4:7], v[84:87]
    ds_read_b64_tr_b16 a[52:53], v67 offset:4096
    ds_read_b64_tr_b16 a[54:55], v67 offset:6144
    v_mfma_f32_16x16x32_bf16 v[88:91], a[60:63], a[4:7], v[88:91]
    ds_read_b64_tr_b16 a[56:57], v68 offset:4096
    ds_read_b64_tr_b16 a[58:59], v68 offset:6144
    s_waitcnt vmcnt(6) lgkmcnt(14)
    v_mfma_f32_16x16x32_bf16 v[76:79], a[64:67], a[8:11], v[76:79]
    ds_read_b64_tr_b16 a[60:61], v69 offset:4096
    ds_read_b64_tr_b16 a[62:63], v69 offset:6144
    v_mfma_f32_16x16x32_bf16 v[80:83], a[68:71], a[8:11], v[80:83]
    ds_read_b64_tr_b16 a[64:65], v66 offset:8192
    ds_read_b64_tr_b16 a[66:67], v66 offset:10240
    buffer_load_dwordx4 a[4:7], v72, s[44:47], 0 offen offset:1024 sc1
    v_mfma_f32_16x16x32_bf16 v[84:87], a[72:75], a[8:11], v[84:87]
    ds_read_b64_tr_b16 a[68:69], v67 offset:8192
    ds_read_b64_tr_b16 a[70:71], v67 offset:10240
    v_mfma_f32_16x16x32_bf16 v[88:91], a[76:79], a[8:11], v[88:91]
    ds_read_b64_tr_b16 a[72:73], v68 offset:8192
    ds_read_b64_tr_b16 a[74:75], v68 offset:10240
    s_waitcnt vmcnt(6) lgkmcnt(14)
    v_mfma_f32_16x16x32_bf16 v[76:79], a[80:83], a[12:15], v[76:79]
    ds_read_b64_tr_b16 a[76:77], v69 offset:8192
    ds_read_b64_tr_b16 a[78:79], v69 offset:10240
    v_mfma_f32_16x16x32_bf16 v[80:83], a[84:87], a[12:15], v[80:83]
    ds_read_b64_tr_b16 a[80:81], v66 offset:12288
    ds_read_b64_tr_b16 a[82:83], v66 offset:14336
    buffer_load_dwordx4 a[8:11], v72, s[44:47], 0 offen offset:2048 sc1
    v_mfma_f32_16x16x32_bf16 v[84:87], a[88:91], a[12:15], v[84:87]
    ds_read_b64_tr_b16 a[84:85], v67 offset:12288
    ds_read_b64_tr_b16 a[86:87], v67 offset:14336
    v_mfma_f32_16x16x32_bf16 v[88:91], a[92:95], a[12:15], v[88:91]
    ds_read_b64_tr_b16 a[88:89], v68 offset:12288
    ds_read_b64_tr_b16 a[90:91], v68 offset:14336
    s_waitcnt vmcnt(6) lgkmcnt(14)
    v_mfma_f32_16x16x32_bf16 v[76:79], v[96:99], a[16:19], v[76:79]
    ds_read_b64_tr_b16 a[92:93], v69 offset:12288
    ds_read_b64_tr_b16 a[94:95], v69 offset:14336
    v_mfma_f32_16x16x32_bf16 v[80:83], v[100:103], a[16:19], v[80:83]
    ds_read_b64_tr_b16 v[96:97], v66 offset:16384
    ds_read_b64_tr_b16 v[98:99], v66 offset:18432
    buffer_load_dwordx4 a[12:15], v72, s[44:47], 0 offen offset:3072 sc1
    v_mfma_f32_16x16x32_bf16 v[84:87], v[104:107], a[16:19], v[84:87]
    ds_read_b64_tr_b16 v[100:101], v67 offset:16384
    ds_read_b64_tr_b16 v[102:103], v67 offset:18432
    v_mfma_f32_16x16x32_bf16 v[88:91], v[108:111], a[16:19], v[88:91]
    ds_read_b64_tr_b16 v[104:105], v68 offset:16384
    ds_read_b64_tr_b16 v[106:107], v68 offset:18432
    s_waitcnt vmcnt(6) lgkmcnt(14)
    v_mfma_f32_16x16x32_bf16 v[76:79], v[112:115], a[20:23], v[76:79]
    ds_read_b64_tr_b16 v[108:109], v69 offset:16384
    ds_read_b64_tr_b16 v[110:111], v69 offset:18432
    v_mfma_f32_16x16x32_bf16 v[80:83], v[116:119], a[20:23], v[80:83]
    ds_read_b64_tr_b16 v[112:113], v66 offset:20480
    ds_read_b64_tr_b16 v[114:115], v66 offset:22528
    buffer_load_dwordx4 a[16:19], v73, s[44:47], 0 offen offset:0 sc1
    v_mfma_f32_16x16x32_bf16 v[84:87], v[120:123], a[20:23], v[84:87]
    ds_read_b64_tr_b16 v[116:117], v67 offset:20480
    ds_read_b64_tr_b16 v[118:119], v67 offset:22528
    v_mfma_f32_16x16x32_bf16 v[88:91], v[124:127], a[20:23], v[88:91]
    ds_read_b64_tr_b16 v[120:121], v68 offset:20480
    ds_read_b64_tr_b16 v[122:123], v68 offset:22528
    s_waitcnt vmcnt(6) lgkmcnt(14)
    v_mfma_f32_16x16x32_bf16 v[76:79], v[128:131], a[24:27], v[76:79]
    ds_read_b64_tr_b16 v[124:125], v69 offset:20480
    ds_read_b64_tr_b16 v[126:127], v69 offset:22528
    v_mfma_f32_16x16x32_bf16 v[80:83], v[132:135], a[24:27], v[80:83]
    ds_read_b64_tr_b16 v[128:129], v66 offset:24576
    ds_read_b64_tr_b16 v[130:131], v66 offset:26624
    buffer_load_dwordx4 a[20:23], v73, s[44:47], 0 offen offset:1024 sc1
    v_mfma_f32_16x16x32_bf16 v[84:87], v[136:139], a[24:27], v[84:87]
    ds_read_b64_tr_b16 v[132:133], v67 offset:24576
    ds_read_b64_tr_b16 v[134:135], v67 offset:26624
    v_mfma_f32_16x16x32_bf16 v[88:91], v[140:143], a[24:27], v[88:91]
    ds_read_b64_tr_b16 v[136:137], v68 offset:24576
    ds_read_b64_tr_b16 v[138:139], v68 offset:26624
    s_waitcnt vmcnt(6) lgkmcnt(14)
    v_mfma_f32_16x16x32_bf16 v[76:79], v[144:147], a[28:31], v[76:79]
    ds_read_b64_tr_b16 v[140:141], v69 offset:24576
    ds_read_b64_tr_b16 v[142:143], v69 offset:26624
    v_mfma_f32_16x16x32_bf16 v[80:83], v[148:151], a[28:31], v[80:83]
    ds_read_b64_tr_b16 v[144:145], v66 offset:28672
    ds_read_b64_tr_b16 v[146:147], v66 offset:30720
    buffer_load_dwordx4 a[24:27], v73, s[44:47], 0 offen offset:2048 sc1
    v_mfma_f32_16x16x32_bf16 v[84:87], v[152:155], a[28:31], v[84:87]
    ds_read_b64_tr_b16 v[148:149], v67 offset:28672
    ds_read_b64_tr_b16 v[150:151], v67 offset:30720
    v_mfma_f32_16x16x32_bf16 v[88:91], v[156:159], a[28:31], v[88:91]
    ds_read_b64_tr_b16 v[152:153], v68 offset:28672
    ds_read_b64_tr_b16 v[154:155], v68 offset:30720
    s_waitcnt vmcnt(6) lgkmcnt(14)
    v_mfma_f32_16x16x32_bf16 v[76:79], a[32:35], a[0:3], v[76:79]
    ds_read_b64_tr_b16 v[156:157], v69 offset:28672
    ds_read_b64_tr_b16 v[158:159], v69 offset:30720
    v_mfma_f32_16x16x32_bf16 v[80:83], a[36:39], a[0:3], v[80:83]
    buffer_load_dwordx4 a[28:31], v73, s[44:47], 0 offen offset:3072 sc1
    ds_write_b32 v11, v1 offset:48
    v_mfma_f32_16x16x32_bf16 v[84:87], a[40:43], a[0:3], v[84:87]
    v_mfma_f32_16x16x32_bf16 v[88:91], a[44:47], a[0:3], v[88:91]
    s_waitcnt vmcnt(6) lgkmcnt(14)
    v_mfma_f32_16x16x32_bf16 v[76:79], a[48:51], a[4:7], v[76:79]
    v_mfma_f32_16x16x32_bf16 v[80:83], a[52:55], a[4:7], v[80:83]
    v_mfma_f32_16x16x32_bf16 v[84:87], a[56:59], a[4:7], v[84:87]
    v_mfma_f32_16x16x32_bf16 v[88:91], a[60:63], a[4:7], v[88:91]
    s_waitcnt vmcnt(5) lgkmcnt(0)
    ds_write_b32 v11, v1 offset:128
    v_mfma_f32_16x16x32_bf16 v[76:79], a[64:67], a[8:11], v[76:79]
    v_mfma_f32_16x16x32_bf16 v[80:83], a[68:71], a[8:11], v[80:83]
    v_mfma_f32_16x16x32_bf16 v[84:87], a[72:75], a[8:11], v[84:87]
    v_mfma_f32_16x16x32_bf16 v[88:91], a[76:79], a[8:11], v[88:91]
    s_waitcnt vmcnt(4)
    v_mfma_f32_16x16x32_bf16 v[76:79], a[80:83], a[12:15], v[76:79]
    v_mfma_f32_16x16x32_bf16 v[80:83], a[84:87], a[12:15], v[80:83]
    v_mfma_f32_16x16x32_bf16 v[84:87], a[88:91], a[12:15], v[84:87]
    v_mfma_f32_16x16x32_bf16 v[88:91], a[92:95], a[12:15], v[88:91]
    s_waitcnt vmcnt(3)
    v_mfma_f32_16x16x32_bf16 v[76:79], v[96:99], a[16:19], v[76:79]
    v_mfma_f32_16x16x32_bf16 v[80:83], v[100:103], a[16:19], v[80:83]
    v_mfma_f32_16x16x32_bf16 v[84:87], v[104:107], a[16:19], v[84:87]
    v_mfma_f32_16x16x32_bf16 v[88:91], v[108:111], a[16:19], v[88:91]
    s_waitcnt vmcnt(2)
    v_mfma_f32_16x16x32_bf16 v[76:79], v[112:115], a[20:23], v[76:79]
    v_mfma_f32_16x16x32_bf16 v[80:83], v[116:119], a[20:23], v[80:83]
    v_mfma_f32_16x16x32_bf16 v[84:87], v[120:123], a[20:23], v[84:87]
    v_mfma_f32_16x16x32_bf16 v[88:91], v[124:127], a[20:23], v[88:91]
    s_waitcnt vmcnt(1)
    v_mfma_f32_16x16x32_bf16 v[76:79], v[128:131], a[24:27], v[76:79]
    v_mfma_f32_16x16x32_bf16 v[80:83], v[132:135], a[24:27], v[80:83]
    v_mfma_f32_16x16x32_bf16 v[84:87], v[136:139], a[24:27], v[84:87]
    v_mfma_f32_16x16x32_bf16 v[88:91], v[140:143], a[24:27], v[88:91]
    s_waitcnt vmcnt(0)
    v_mfma_f32_16x16x32_bf16 v[76:79], v[144:147], a[28:31], v[76:79]
    v_mfma_f32_16x16x32_bf16 v[80:83], v[148:151], a[28:31], v[80:83]
    v_mfma_f32_16x16x32_bf16 v[84:87], v[152:155], a[28:31], v[84:87]
    v_mfma_f32_16x16x32_bf16 v[88:91], v[156:159], a[28:31], v[88:91]
    s_nop 4
    v_pk_add_f32 v[28:29], v[28:29], v[76:77]
    v_pk_add_f32 v[30:31], v[30:31], v[78:79]
    v_pk_add_f32 v[32:33], v[32:33], v[80:81]
    v_pk_add_f32 v[34:35], v[34:35], v[82:83]
    v_pk_add_f32 v[36:37], v[36:37], v[84:85]
    v_pk_add_f32 v[38:39], v[38:39], v[86:87]
    v_pk_add_f32 v[40:41], v[40:41], v[88:89]
    v_pk_add_f32 v[42:43], v[42:43], v[90:91]
    v_cvt_pk_bf16_f32 v148, v28, v29
    v_cvt_pk_bf16_f32 v149, v30, v31
    v_cvt_pk_bf16_f32 v150, v32, v33
    v_cvt_pk_bf16_f32 v151, v34, v35
    v_cvt_pk_bf16_f32 v152, v36, v37
    v_cvt_pk_bf16_f32 v153, v38, v39
    v_cvt_pk_bf16_f32 v154, v40, v41
    v_cvt_pk_bf16_f32 v155, v42, v43
    s_cmp_lg_u32 s37, 1
    s_cbranch_scc1 ps_167
pd_168_f:
    buffer_store_dwordx4 v[148:151], v5, s[44:47], s85 offen offset:0
    buffer_store_dwordx4 v[152:155], v5, s[44:47], s85 offen offset:1024
pd_168:
    ds_read_b128 v[116:119], v58 offset:768
    ds_read_b128 v[120:123], v58 offset:832
    ds_read_b128 v[124:127], v58 offset:896
    ds_read_b128 v[128:131], v58 offset:960
    v_pk_add_f32 v[156:157], v[28:29], v[30:31]
    v_pk_mul_f32 v[158:159], v[28:29], v[28:29]
    v_pk_fma_f32 v[158:159], v[30:31], v[30:31], v[158:159]
    v_pk_add_f32 v[156:157], v[156:157], v[32:33]
    v_pk_fma_f32 v[158:159], v[32:33], v[32:33], v[158:159]
    v_pk_add_f32 v[156:157], v[156:157], v[34:35]
    v_pk_fma_f32 v[158:159], v[34:35], v[34:35], v[158:159]
    v_pk_add_f32 v[156:157], v[156:157], v[36:37]
    v_pk_fma_f32 v[158:159], v[36:37], v[36:37], v[158:159]
    v_pk_add_f32 v[156:157], v[156:157], v[38:39]
    v_pk_fma_f32 v[158:159], v[38:39], v[38:39], v[158:159]
    v_pk_add_f32 v[156:157], v[156:157], v[40:41]
    v_pk_fma_f32 v[158:159], v[40:41], v[40:41], v[158:159]
    v_pk_add_f32 v[156:157], v[156:157], v[42:43]
    v_pk_fma_f32 v[158:159], v[42:43], v[42:43], v[158:159]
    v_add_f32 v156, v156, v157
    v_add_f32 v158, v158, v159
    s_nop 1
    v_permlane32_swap_b32 v156, v158
    v_add_f32 v156, v156, v158
    v_mov_b32 v65, v156
    s_nop 1
    v_permlane16_swap_b32 v156, v65
    v_add_f32 v156, v156, v65
    s_cmp_lg_u32 s37, 1
    s_cbranch_scc1 ps_169
pd_170_f:
    buffer_store_dword v156, v62, s[44:47], s93 offen
pd_170:
    s_waitcnt lgkmcnt(0)
    v_pk_fma_f32 v[12:13], v[28:29], v[116:117], v[12:13]
    v_pk_fma_f32 v[14:15], v[30:31], v[118:119], v[14:15]
    v_pk_fma_f32 v[16:17], v[32:33], v[120:121], v[16:17]
    v_pk_fma_f32 v[18:19], v[34:35], v[122:123], v[18:19]
    v_pk_fma_f32 v[20:21], v[36:37], v[124:125], v[20:21]
    v_pk_fma_f32 v[22:23], v[38:39], v[126:127], v[22:23]
    v_pk_fma_f32 v[24:25], v[40:41], v[128:129], v[24:25]
    v_pk_fma_f32 v[26:27], v[42:43], v[130:131], v[26:27]
    v_lshrrev_b32 v70, 2, v2
    v_mul_u32_u24 v70, 224, v70
    v_and_b32 v65, 3, v2
    v_lshl_add_u32 v70, v65, 3, v70
    s_lshl_b32 s52, s14, 5
    s_add_u32 s52, s52, 0x1600
    s_lshl_b32 s53, s14, 14
    s_add_u32 s53, s53, 0x11c000
    s_lshl_b32 s55, s14, 10
    s_add_u32 s55, s55, 0x8000
    s_add_u32 s54, s53, 16384
    s_waitcnt vmcnt(0)
    s_mov_b64 exec, 1
    s_cmp_lg_u32 s37, 1
    s_cbranch_scc1 ps_171
pd_172_f:
    buffer_store_dword v8, v6, s[44:47], s94 offen
pd_172:
    s_mov_b64 exec, -1
    ds_write_b32 v11, v1 offset:288
    s_mov_b32 s15, 0
sp_173:
    ds_read_b32 v64, v10 offset:528
    s_add_u32 s15, s15, 1
    s_cmp_gt_u32 s15, 4000000
    s_cbranch_scc1 sp_173_x
    s_waitcnt lgkmcnt(0)
    v_cmp_ne_u32 vcc, 1, v64
    s_cbranch_vccnz sp_173
sp_173_x:
    s_waitcnt lgkmcnt(0)
    ds_read_b64_tr_b16 v[132:133], v70 offset:32768
    ds_read_b64_tr_b16 v[134:135], v70 offset:36352
    ds_read_b64_tr_b16 v[136:137], v70 offset:32800
    ds_read_b64_tr_b16 v[138:139], v70 offset:36384
    ds_read_b64_tr_b16 v[140:141], v70 offset:32832
    ds_read_b64_tr_b16 v[142:143], v70 offset:36416
    ds_read_b64_tr_b16 v[144:145], v70 offset:32864
    ds_read_b64_tr_b16 v[146:147], v70 offset:36448
    ds_read_b64_tr_b16 v[148:149], v70 offset:32896
    ds_read_b64_tr_b16 v[150:151], v70 offset:36480
    ds_read_b64_tr_b16 v[152:153], v70 offset:32928
    ds_read_b64_tr_b16 v[154:155], v70 offset:36512
    s_mul_i32 s58, s14, 57344
    s_mul_i32 s9, s13, 3584
    s_add_u32 s58, s58, s9
    s_add_u32 s58, s58, 0x2e000
    s_and_b32 s9, s13, 1
    s_lshl_b32 s9, s9, 9
    s_sub_u32 s58, s58, s9
    s_add_u32 s59, s58, 57344
    s_lshl_b32 s79, s14, 5
    s_lshl_b32 s9, s13, 2
    s_add_u32 s79, s79, s9
    s_add_u32 s79, s79, 0x1a00
    s_max_u32 s9, s14, 1
    s_sub_u32 s9, s9, 1
    s_add_u32 s10, s14, 2
    s_min_u32 s10, s10, 15
    s_sub_u32 s10, s10, s9
    s_lshl_b32 s10, s10, 2
    s_lshl_b32 s64, s9, 5
    s_add_u32 s64, s64, 0x1600
    v_and_b32 v74, 8, v2
    v_mul_u32_u24 v74, s10, v74
    v_add_u32 v74, v74, v59
    s_and_b32 s35, s3, 1
    s_lshl_b32 s9, s35, 12
    v_add_u32 v66, s9, v66
    v_add_u32 v67, s9, v67
    v_add_u32 v68, s9, v68
    v_add_u32 v69, s9, v69
    s_mul_i32 s65, s34, 57344
    s_lshl_b32 s9, s35, 10
    s_add_u32 s65, s65, s9
    s_add_u32 s65, s65, 0x2e000
    s_xor_b32 s10, s34, 1
    s_mul_i32 s66, s10, 57344
    s_lshl_b32 s9, s35, 10
    s_add_u32 s66, s66, s9
    s_add_u32 s66, s66, 0x2e000
    s_mov_b32 s48, s32
    s_mov_b32 s49, s33
    s_mov_b32 s50, 0x200000
    s_mov_b32 s51, 0x20000
    s_lshl_b32 s10, s3, 12
    s_add_u32 s10, s10, 0x10000
    v_add_u32 v72, s10, v5
    v_xor_b32 v73, 4, v11
    s_mov_b32 s15, 0
sp_174:
    buffer_load_dword v9, v60, s[44:47], s52 offen sc1
    s_add_u32 s15, s15, 1
    s_cmp_gt_u32 s15, 100000
    s_cbranch_scc1 sp_174_x
    s_waitcnt vmcnt(0)
    v_cmp_ne_u32 vcc, s36, v9
    s_cbranch_vccnz sp_174
sp_174_x:
    s_waitcnt vmcnt(0)
    s_add_u32 s56, s53, 0
    buffer_load_dwordx4 a[0:3], v5, s[44:47], s56 offen offset:0 sc1
    s_add_u32 s57, s54, 0
    buffer_load_dwordx4 a[4:7], v5, s[44:47], s57 offen offset:0 sc1
    buffer_load_dwordx4 a[8:11], v5, s[44:47], s56 offen offset:1024 sc1
    buffer_load_dwordx4 a[12:15], v5, s[44:47], s57 offen offset:1024 sc1
    buffer_load_dwordx4 v[44:47], v61, s[44:47], s55 offen offset:0 sc1
    buffer_load_dwordx4 v[48:51], v61, s[44:47], s55 offen offset:1024 sc1
    s_waitcnt vmcnt(4) lgkmcnt(8)
    v_mfma_f32_16x16x32_bf16 v[76:79], v[132:135], a[0:3], 0
    ds_read_b64_tr_b16 v[156:157], v70 offset:32960
    v_mfma_f32_16x16x32_bf16 v[104:107], v[132:135], a[4:7], 0
    ds_read_b64_tr_b16 v[158:159], v70 offset:36544
    v_mfma_f32_16x16x32_bf16 v[80:83], v[136:139], a[0:3], 0
    ds_read_b64_tr_b16 v[132:133], v70 offset:39936
    v_mfma_f32_16x16x32_bf16 v[108:111], v[136:139], a[4:7], 0
    ds_read_b64_tr_b16 v[134:135], v70 offset:43520
    buffer_load_dwordx4 a[16:19], v5, s[44:47], s56 offen offset:2048 sc1
    s_waitcnt lgkmcnt(8)
    v_mfma_f32_16x16x32_bf16 v[84:87], v[140:143], a[0:3], 0
    ds_read_b64_tr_b16 v[136:137], v70 offset:39968
    v_mfma_f32_16x16x32_bf16 v[112:115], v[140:143], a[4:7], 0
    ds_read_b64_tr_b16 v[138:139], v70 offset:43552
    buffer_load_dwordx4 a[20:23], v5, s[44:47], s57 offen offset:2048 sc1
    v_mfma_f32_16x16x32_bf16 v[88:91], v[144:147], a[0:3], 0
    ds_read_b64_tr_b16 v[140:141], v70 offset:40000
    v_mfma_f32_16x16x32_bf16 v[116:119], v[144:147], a[4:7], 0
    ds_read_b64_tr_b16 v[142:143], v70 offset:43584
    s_waitcnt lgkmcnt(8)
    v_mfma_f32_16x16x32_bf16 v[92:95], v[148:151], a[0:3], 0
    ds_read_b64_tr_b16 v[144:145], v70 offset:40032
    v_mfma_f32_16x16x32_bf16 v[120:123], v[148:151], a[4:7], 0
    ds_read_b64_tr_b16 v[146:147], v70 offset:43616
    buffer_load_dwordx4 a[24:27], v5, s[44:47], s56 offen offset:3072 sc1
    v_mfma_f32_16x16x32_bf16 v[96:99], v[152:155], a[0:3], 0
    ds_read_b64_tr_b16 v[148:149], v70 offset:40064
    v_mfma_f32_16x16x32_bf16 v[124:127], v[152:155], a[4:7], 0
    ds_read_b64_tr_b16 v[150:151], v70 offset:43648
    buffer_load_dwordx4 a[28:31], v5, s[44:47], s57 offen offset:3072 sc1
    s_waitcnt lgkmcnt(8)
    v_mfma_f32_16x16x32_bf16 v[100:103], v[156:159], a[0:3], 0
    ds_read_b64_tr_b16 v[152:153], v70 offset:40096
    v_mfma_f32_16x16x32_bf16 v[128:131], v[156:159], a[4:7], 0
    ds_read_b64_tr_b16 v[154:155], v70 offset:43680
    s_waitcnt vmcnt(6)
    v_mfma_f32_16x16x32_bf16 v[76:79], v[132:135], a[8:11], v[76:79]
    ds_read_b64_tr_b16 v[156:157], v70 offset:40128
    v_mfma_f32_16x16x32_bf16 v[104:107], v[132:135], a[12:15], v[104:107]
    ds_read_b64_tr_b16 v[158:159], v70 offset:43712
    s_waitcnt lgkmcnt(8)
    v_mfma_f32_16x16x32_bf16 v[80:83], v[136:139], a[8:11], v[80:83]
    ds_read_b64_tr_b16 v[132:133], v70 offset:47104
    v_mfma_f32_16x16x32_bf16 v[108:111], v[136:139], a[12:15], v[108:111]
    ds_read_b64_tr_b16 v[134:135], v70 offset:50688
    s_add_u32 s56, s53, 4096
    buffer_load_dwordx4 a[32:35], v5, s[44:47], s56 offen offset:0 sc1
    v_mfma_f32_16x16x32_bf16 v[84:87], v[140:143], a[8:11], v[84:87]
    ds_read_b64_tr_b16 v[136:137], v70 offset:47136
    v_mfma_f32_16x16x32_bf16 v[112:115], v[140:143], a[12:15], v[112:115]
    ds_read_b64_tr_b16 v[138:139], v70 offset:50720
    s_add_u32 s57, s54, 4096
    buffer_load_dwordx4 a[36:39], v5, s[44:47], s57 offen offset:0 sc1
    s_waitcnt lgkmcnt(8)
    v_mfma_f32_16x16x32_bf16 v[88:91], v[144:147], a[8:11], v[88:91]
    ds_read_b64_tr_b16 v[140:141], v70 offset:47168
    v_mfma_f32_16x16x32_bf16 v[116:119], v[144:147], a[12:15], v[116:119]
    ds_read_b64_tr_b16 v[142:143], v70 offset:50752
    v_mfma_f32_16x16x32_bf16 v[92:95], v[148:151], a[8:11], v[92:95]
    ds_read_b64_tr_b16 v[144:145], v70 offset:47200
    v_mfma_f32_16x16x32_bf16 v[120:123], v[148:151], a[12:15], v[120:123]
    ds_read_b64_tr_b16 v[146:147], v70 offset:50784
    buffer_load_dwordx4 a[40:43], v5, s[44:47], s56 offen offset:1024 sc1
    s_waitcnt lgkmcnt(8)
    v_mfma_f32_16x16x32_bf16 v[96:99], v[152:155], a[8:11], v[96:99]
    ds_read_b64_tr_b16 v[148:149], v70 offset:47232
    v_mfma_f32_16x16x32_bf16 v[124:127], v[152:155], a[12:15], v[124:127]
    ds_read_b64_tr_b16 v[150:151], v70 offset:50816
    buffer_load_dwordx4 a[44:47], v5, s[44:47], s57 offen offset:1024 sc1
    v_mfma_f32_16x16x32_bf16 v[100:103], v[156:159], a[8:11], v[100:103]
    ds_read_b64_tr_b16 v[152:153], v70 offset:47264
    v_mfma_f32_16x16x32_bf16 v[128:131], v[156:159], a[12:15], v[128:131]
    ds_read_b64_tr_b16 v[154:155], v70 offset:50848
    s_waitcnt vmcnt(6) lgkmcnt(8)
    v_mfma_f32_16x16x32_bf16 v[76:79], v[132:135], a[16:19], v[76:79]
    ds_read_b64_tr_b16 v[156:157], v70 offset:47296
    v_mfma_f32_16x16x32_bf16 v[104:107], v[132:135], a[20:23], v[104:107]
    ds_read_b64_tr_b16 v[158:159], v70 offset:50880
    v_mfma_f32_16x16x32_bf16 v[80:83], v[136:139], a[16:19], v[80:83]
    ds_read_b64_tr_b16 v[132:133], v70 offset:54272
    v_mfma_f32_16x16x32_bf16 v[108:111], v[136:139], a[20:23], v[108:111]
    ds_read_b64_tr_b16 v[134:135], v70 offset:57856
    buffer_load_dwordx4 a[48:51], v5, s[44:47], s56 offen offset:2048 sc1
    s_waitcnt lgkmcnt(8)
    v_mfma_f32_16x16x32_bf16 v[84:87], v[140:143], a[16:19], v[84:87]
    ds_read_b64_tr_b16 v[136:137], v70 offset:54304
    v_mfma_f32_16x16x32_bf16 v[112:115], v[140:143], a[20:23], v[112:115]
    ds_read_b64_tr_b16 v[138:139], v70 offset:57888
    buffer_load_dwordx4 a[52:55], v5, s[44:47], s57 offen offset:2048 sc1
    v_mfma_f32_16x16x32_bf16 v[88:91], v[144:147], a[16:19], v[88:91]
    ds_read_b64_tr_b16 v[140:141], v70 offset:54336
    v_mfma_f32_16x16x32_bf16 v[116:119], v[144:147], a[20:23], v[116:119]
    ds_read_b64_tr_b16 v[142:143], v70 offset:57920
    s_waitcnt lgkmcnt(8)
    v_mfma_f32_16x16x32_bf16 v[92:95], v[148:151], a[16:19], v[92:95]
    ds_read_b64_tr_b16 v[144:145], v70 offset:54368
    v_mfma_f32_16x16x32_bf16 v[120:123], v[148:151], a[20:23], v[120:123]
    ds_read_b64_tr_b16 v[146:147], v70 offset:57952
    buffer_load_dwordx4 a[56:59], v5, s[44:47], s56 offen offset:3072 sc1
    v_mfma_f32_16x16x32_bf16 v[96:99], v[152:155], a[16:19], v[96:99]
    ds_read_b64_tr_b16 v[148:149], v70 offset:54400
    v_mfma_f32_16x16x32_bf16 v[124:127], v[152:155], a[20:23], v[124:127]
    ds_read_b64_tr_b16 v[150:151], v70 offset:57984
    buffer_load_dwordx4 a[60:63], v5, s[44:47], s57 offen offset:3072 sc1
    s_waitcnt lgkmcnt(8)
    v_mfma_f32_16x16x32_bf16 v[100:103], v[156:159], a[16:19], v[100:103]
    ds_read_b64_tr_b16 v[152:153], v70 offset:54432
    v_mfma_f32_16x16x32_bf16 v[128:131], v[156:159], a[20:23], v[128:131]
    ds_read_b64_tr_b16 v[154:155], v70 offset:58016
    s_waitcnt vmcnt(8)
    v_mfma_f32_16x16x32_bf16 v[76:79], v[132:135], a[24:27], v[76:79]
    ds_read_b64_tr_b16 v[156:157], v70 offset:54464
    v_mfma_f32_16x16x32_bf16 v[104:107], v[132:135], a[28:31], v[104:107]
    ds_read_b64_tr_b16 v[158:159], v70 offset:58048
    s_waitcnt lgkmcnt(8)
    v_mfma_f32_16x16x32_bf16 v[80:83], v[136:139], a[24:27], v[80:83]
    ds_read_b64_tr_b16 v[132:133], v70 offset:61440
    v_mfma_f32_16x16x32_bf16 v[108:111], v[136:139], a[28:31], v[108:111]
    ds_read_b64_tr_b16 v[134:135], v70 offset:65024
    s_add_u32 s56, s53, 8192
    buffer_load_dwordx4 a[64:67], v5, s[44:47], s56 offen offset:0 sc1
    v_mfma_f32_16x16x32_bf16 v[84:87], v[140:143], a[24:27], v[84:87]
    ds_read_b64_tr_b16 v[136:137], v70 offset:61472
    v_mfma_f32_16x16x32_bf16 v[112:115], v[140:143], a[28:31], v[112:115]
    ds_read_b64_tr_b16 v[138:139], v70 offset:65056
    s_add_u32 s57, s54, 8192
    buffer_load_dwordx4 a[68:71], v5, s[44:47], s57 offen offset:0 sc1
    s_waitcnt lgkmcnt(8)
    v_mfma_f32_16x16x32_bf16 v[88:91], v[144:147], a[24:27], v[88:91]
    ds_read_b64_tr_b16 v[140:141], v70 offset:61504
    v_mfma_f32_16x16x32_bf16 v[116:119], v[144:147], a[28:31], v[116:119]
    ds_read_b64_tr_b16 v[142:143], v70 offset:65088
    v_mfma_f32_16x16x32_bf16 v[92:95], v[148:151], a[24:27], v[92:95]
    ds_read_b64_tr_b16 v[144:145], v70 offset:61536
    v_mfma_f32_16x16x32_bf16 v[120:123], v[148:151], a[28:31], v[120:123]
    ds_read_b64_tr_b16 v[146:147], v70 offset:65120
    buffer_load_dwordx4 a[72:75], v5, s[44:47], s56 offen offset:1024 sc1
    s_waitcnt lgkmcnt(8)
    v_mfma_f32_16x16x32_bf16 v[96:99], v[152:155], a[24:27], v[96:99]
    ds_read_b64_tr_b16 v[148:149], v70 offset:61568
    v_mfma_f32_16x16x32_bf16 v[124:127], v[152:155], a[28:31], v[124:127]
    ds_read_b64_tr_b16 v[150:151], v70 offset:65152
    buffer_load_dwordx4 a[76:79], v5, s[44:47], s57 offen offset:1024 sc1
    v_mfma_f32_16x16x32_bf16 v[100:103], v[156:159], a[24:27], v[100:103]
    ds_read_b64_tr_b16 v[152:153], v70 offset:61600
    v_mfma_f32_16x16x32_bf16 v[128:131], v[156:159], a[28:31], v[128:131]
    ds_read_b64_tr_b16 v[154:155], v70 offset:65184
    s_waitcnt vmcnt(10) lgkmcnt(8)
    v_mfma_f32_16x16x32_bf16 v[76:79], v[132:135], a[32:35], v[76:79]
    ds_read_b64_tr_b16 v[156:157], v70 offset:61632
    v_mfma_f32_16x16x32_bf16 v[104:107], v[132:135], a[36:39], v[104:107]
    ds_read_b64_tr_b16 v[158:159], v70 offset:65216
    v_mfma_f32_16x16x32_bf16 v[80:83], v[136:139], a[32:35], v[80:83]
    v_add_u32 v70, 0x10000, v70
    ds_read_b64_tr_b16 v[132:133], v70 offset:3072
    v_mfma_f32_16x16x32_bf16 v[108:111], v[136:139], a[36:39], v[108:111]
    ds_read_b64_tr_b16 v[134:135], v70 offset:6656
    buffer_load_dwordx4 a[80:83], v5, s[44:47], s56 offen offset:2048 sc1
    s_waitcnt lgkmcnt(8)
    v_mfma_f32_16x16x32_bf16 v[84:87], v[140:143], a[32:35], v[84:87]
    ds_read_b64_tr_b16 v[136:137], v70 offset:3104
    v_mfma_f32_16x16x32_bf16 v[112:115], v[140:143], a[36:39], v[112:115]
    ds_read_b64_tr_b16 v[138:139], v70 offset:6688
    buffer_load_dwordx4 a[84:87], v5, s[44:47], s57 offen offset:2048 sc1
    v_mfma_f32_16x16x32_bf16 v[88:91], v[144:147], a[32:35], v[88:91]
    ds_read_b64_tr_b16 v[140:141], v70 offset:3136
    v_mfma_f32_16x16x32_bf16 v[116:119], v[144:147], a[36:39], v[116:119]
    ds_read_b64_tr_b16 v[142:143], v70 offset:6720
    s_waitcnt lgkmcnt(8)
    v_mfma_f32_16x16x32_bf16 v[92:95], v[148:151], a[32:35], v[92:95]
    ds_read_b64_tr_b16 v[144:145], v70 offset:3168
    v_mfma_f32_16x16x32_bf16 v[120:123], v[148:151], a[36:39], v[120:123]
    ds_read_b64_tr_b16 v[146:147], v70 offset:6752
    buffer_load_dwordx4 a[88:91], v5, s[44:47], s56 offen offset:3072 sc1
    v_mfma_f32_16x16x32_bf16 v[96:99], v[152:155], a[32:35], v[96:99]
    ds_read_b64_tr_b16 v[148:149], v70 offset:3200
    v_mfma_f32_16x16x32_bf16 v[124:127], v[152:155], a[36:39], v[124:127]
    ds_read_b64_tr_b16 v[150:151], v70 offset:6784
    buffer_load_dwordx4 a[92:95], v5, s[44:47], s57 offen offset:3072 sc1
    s_waitcnt lgkmcnt(8)
    v_mfma_f32_16x16x32_bf16 v[100:103], v[156:159], a[32:35], v[100:103]
    ds_read_b64_tr_b16 v[152:153], v70 offset:3232
    v_mfma_f32_16x16x32_bf16 v[128:131], v[156:159], a[36:39], v[128:131]
    ds_read_b64_tr_b16 v[154:155], v70 offset:6816
    s_waitcnt vmcnt(12)
    v_mfma_f32_16x16x32_bf16 v[76:79], v[132:135], a[40:43], v[76:79]
    ds_read_b64_tr_b16 v[156:157], v70 offset:3264
    v_mfma_f32_16x16x32_bf16 v[104:107], v[132:135], a[44:47], v[104:107]
    ds_read_b64_tr_b16 v[158:159], v70 offset:6848
    s_waitcnt lgkmcnt(8)
    v_mfma_f32_16x16x32_bf16 v[80:83], v[136:139], a[40:43], v[80:83]
    ds_read_b64_tr_b16 v[132:133], v70 offset:10240
    v_mfma_f32_16x16x32_bf16 v[108:111], v[136:139], a[44:47], v[108:111]
    ds_read_b64_tr_b16 v[134:135], v70 offset:13824
    s_add_u32 s56, s53, 12288
    buffer_load_dwordx4 a[0:3], v5, s[44:47], s56 offen offset:0 sc1
    v_mfma_f32_16x16x32_bf16 v[84:87], v[140:143], a[40:43], v[84:87]
    ds_read_b64_tr_b16 v[136:137], v70 offset:10272
    v_mfma_f32_16x16x32_bf16 v[112:115], v[140:143], a[44:47], v[112:115]
    ds_read_b64_tr_b16 v[138:139], v70 offset:13856
    s_add_u32 s57, s54, 12288
    buffer_load_dwordx4 a[4:7], v5, s[44:47], s57 offen offset:0 sc1
    s_waitcnt lgkmcnt(8)
    v_mfma_f32_16x16x32_bf16 v[88:91], v[144:147], a[40:43], v[88:91]
    ds_read_b64_tr_b16 v[140:141], v70 offset:10304
    v_mfma_f32_16x16x32_bf16 v[116:119], v[144:147], a[44:47], v[116:119]
    ds_read_b64_tr_b16 v[142:143], v70 offset:13888
    v_mfma_f32_16x16x32_bf16 v[92:95], v[148:151], a[40:43], v[92:95]
    ds_read_b64_tr_b16 v[144:145], v70 offset:10336
    v_mfma_f32_16x16x32_bf16 v[120:123], v[148:151], a[44:47], v[120:123]
    ds_read_b64_tr_b16 v[146:147], v70 offset:13920
    buffer_load_dwordx4 a[8:11], v5, s[44:47], s56 offen offset:1024 sc1
    s_waitcnt lgkmcnt(8)
    v_mfma_f32_16x16x32_bf16 v[96:99], v[152:155], a[40:43], v[96:99]
    ds_read_b64_tr_b16 v[148:149], v70 offset:10368
    v_mfma_f32_16x16x32_bf16 v[124:127], v[152:155], a[44:47], v[124:127]
    ds_read_b64_tr_b16 v[150:151], v70 offset:13952
    buffer_load_dwordx4 a[12:15], v5, s[44:47], s57 offen offset:1024 sc1
    v_mfma_f32_16x16x32_bf16 v[100:103], v[156:159], a[40:43], v[100:103]
    ds_read_b64_tr_b16 v[152:153], v70 offset:10400
    v_mfma_f32_16x16x32_bf16 v[128:131], v[156:159], a[44:47], v[128:131]
    ds_read_b64_tr_b16 v[154:155], v70 offset:13984
    s_waitcnt vmcnt(14) lgkmcnt(8)
    v_mfma_f32_16x16x32_bf16 v[76:79], v[132:135], a[48:51], v[76:79]
    ds_read_b64_tr_b16 v[156:157], v70 offset:10432
    v_mfma_f32_16x16x32_bf16 v[104:107], v[132:135], a[52:55], v[104:107]
    ds_read_b64_tr_b16 v[158:159], v70 offset:14016
    v_mfma_f32_16x16x32_bf16 v[80:83], v[136:139], a[48:51], v[80:83]
    ds_read_b64_tr_b16 v[132:133], v70 offset:17408
    v_mfma_f32_16x16x32_bf16 v[108:111], v[136:139], a[52:55], v[108:111]
    ds_read_b64_tr_b16 v[134:135], v70 offset:20992
    buffer_load_dwordx4 a[16:19], v5, s[44:47], s56 offen offset:2048 sc1
    s_waitcnt lgkmcnt(8)
    v_mfma_f32_16x16x32_bf16 v[84:87], v[140:143], a[48:51], v[84:87]
    ds_read_b64_tr_b16 v[136:137], v70 offset:17440
    v_mfma_f32_16x16x32_bf16 v[112:115], v[140:143], a[52:55], v[112:115]
    ds_read_b64_tr_b16 v[138:139], v70 offset:21024
    buffer_load_dwordx4 a[20:23], v5, s[44:47], s57 offen offset:2048 sc1
    v_mfma_f32_16x16x32_bf16 v[88:91], v[144:147], a[48:51], v[88:91]
    ds_read_b64_tr_b16 v[140:141], v70 offset:17472
    v_mfma_f32_16x16x32_bf16 v[116:119], v[144:147], a[52:55], v[116:119]
    ds_read_b64_tr_b16 v[142:143], v70 offset:21056
    s_waitcnt lgkmcnt(8)
    v_mfma_f32_16x16x32_bf16 v[92:95], v[148:151], a[48:51], v[92:95]
    ds_read_b64_tr_b16 v[144:145], v70 offset:17504
    v_mfma_f32_16x16x32_bf16 v[120:123], v[148:151], a[52:55], v[120:123]
    ds_read_b64_tr_b16 v[146:147], v70 offset:21088
    buffer_load_dwordx4 a[24:27], v5, s[44:47], s56 offen offset:3072 sc1
    v_mfma_f32_16x16x32_bf16 v[96:99], v[152:155], a[48:51], v[96:99]
    ds_read_b64_tr_b16 v[148:149], v70 offset:17536
    v_mfma_f32_16x16x32_bf16 v[124:127], v[152:155], a[52:55], v[124:127]
    ds_read_b64_tr_b16 v[150:151], v70 offset:21120
    buffer_load_dwordx4 a[28:31], v5, s[44:47], s57 offen offset:3072 sc1
    ds_write_b32 v11, v1 offset:64
    s_waitcnt lgkmcnt(9)
    v_mfma_f32_16x16x32_bf16 v[100:103], v[156:159], a[48:51], v[100:103]
    ds_read_b64_tr_b16 v[152:153], v70 offset:17568
    v_mfma_f32_16x16x32_bf16 v[128:131], v[156:159], a[52:55], v[128:131]
    ds_read_b64_tr_b16 v[154:155], v70 offset:21152
    s_waitcnt vmcnt(16)
    v_mfma_f32_16x16x32_bf16 v[76:79], v[132:135], a[56:59], v[76:79]
    ds_read_b64_tr_b16 v[156:157], v70 offset:17600
    v_mfma_f32_16x16x32_bf16 v[104:107], v[132:135], a[60:63], v[104:107]
    ds_read_b64_tr_b16 v[158:159], v70 offset:21184
    s_waitcnt lgkmcnt(9)
    v_mfma_f32_16x16x32_bf16 v[80:83], v[136:139], a[56:59], v[80:83]
    ds_read_b64_tr_b16 v[132:133], v70 offset:24576
    v_mfma_f32_16x16x32_bf16 v[108:111], v[136:139], a[60:63], v[108:111]
    ds_read_b64_tr_b16 v[134:135], v70 offset:28160
    v_mfma_f32_16x16x32_bf16 v[84:87], v[140:143], a[56:59], v[84:87]
    ds_read_b64_tr_b16 v[136:137], v70 offset:24608
    v_mfma_f32_16x16x32_bf16 v[112:115], v[140:143], a[60:63], v[112:115]
    ds_read_b64_tr_b16 v[138:139], v70 offset:28192
    s_waitcnt lgkmcnt(9)
    v_mfma_f32_16x16x32_bf16 v[88:91], v[144:147], a[56:59], v[88:91]
    ds_read_b64_tr_b16 v[140:141], v70 offset:24640
    v_mfma_f32_16x16x32_bf16 v[116:119], v[144:147], a[60:63], v[116:119]
    ds_read_b64_tr_b16 v[142:143], v70 offset:28224
    v_mfma_f32_16x16x32_bf16 v[92:95], v[148:151], a[56:59], v[92:95]
    ds_read_b32 v64, v10 offset:544
    ds_read_b64_tr_b16 v[144:145], v70 offset:24672
    v_mfma_f32_16x16x32_bf16 v[120:123], v[148:151], a[60:63], v[120:123]
    ds_read_b64_tr_b16 v[146:147], v70 offset:28256
    s_waitcnt lgkmcnt(9)
    v_mfma_f32_16x16x32_bf16 v[96:99], v[152:155], a[56:59], v[96:99]
    ds_read_b64_tr_b16 v[148:149], v70 offset:24704
    v_mfma_f32_16x16x32_bf16 v[124:127], v[152:155], a[60:63], v[124:127]
    ds_read_b64_tr_b16 v[150:151], v70 offset:28288
    v_mfma_f32_16x16x32_bf16 v[100:103], v[156:159], a[56:59], v[100:103]
    ds_read_b64_tr_b16 v[152:153], v70 offset:24736
    v_mfma_f32_16x16x32_bf16 v[128:131], v[156:159], a[60:63], v[128:131]
    ds_read_b64_tr_b16 v[154:155], v70 offset:28320
    s_waitcnt vmcnt(14) lgkmcnt(9)
    v_mfma_f32_16x16x32_bf16 v[76:79], v[132:135], a[64:67], v[76:79]
    ds_read_b64_tr_b16 v[156:157], v70 offset:24768
    v_mfma_f32_16x16x32_bf16 v[104:107], v[132:135], a[68:71], v[104:107]
    ds_read_b64_tr_b16 v[158:159], v70 offset:28352
    v_mfma_f32_16x16x32_bf16 v[80:83], v[136:139], a[64:67], v[80:83]
    s_waitcnt lgkmcnt(8)
    v_cmp_ne_u32 vcc, 1, v64
    s_cbranch_vccnz gt_175
gt_175_r:
    v_add_u32 v70, 0x10000, v70
    ds_read_b64_tr_b16 v[132:133], v70 offset:0
    v_mfma_f32_16x16x32_bf16 v[108:111], v[136:139], a[68:71], v[108:111]
    ds_read_b64_tr_b16 v[134:135], v70 offset:3584
    s_waitcnt lgkmcnt(8)
    v_mfma_f32_16x16x32_bf16 v[84:87], v[140:143], a[64:67], v[84:87]
    ds_read_b64_tr_b16 v[136:137], v70 offset:32
    v_mfma_f32_16x16x32_bf16 v[112:115], v[140:143], a[68:71], v[112:115]
    ds_read_b64_tr_b16 v[138:139], v70 offset:3616
    v_mfma_f32_16x16x32_bf16 v[88:91], v[144:147], a[64:67], v[88:91]
    ds_read_b64_tr_b16 v[140:141], v70 offset:64
    v_mfma_f32_16x16x32_bf16 v[116:119], v[144:147], a[68:71], v[116:119]
    ds_read_b64_tr_b16 v[142:143], v70 offset:3648
    s_waitcnt lgkmcnt(8)
    v_mfma_f32_16x16x32_bf16 v[92:95], v[148:151], a[64:67], v[92:95]
    ds_read_b64_tr_b16 v[144:145], v70 offset:96
    v_mfma_f32_16x16x32_bf16 v[120:123], v[148:151], a[68:71], v[120:123]
    ds_read_b64_tr_b16 v[146:147], v70 offset:3680
    v_mfma_f32_16x16x32_bf16 v[96:99], v[152:155], a[64:67], v[96:99]
    ds_read_b64_tr_b16 v[148:149], v70 offset:128
    v_mfma_f32_16x16x32_bf16 v[124:127], v[152:155], a[68:71], v[124:127]
    ds_read_b64_tr_b16 v[150:151], v70 offset:3712
    s_waitcnt lgkmcnt(8)
    ds_write_b32 v11, v1 offset:208
    v_mfma_f32_16x16x32_bf16 v[100:103], v[156:159], a[64:67], v[100:103]
    ds_read_b64_tr_b16 v[152:153], v70 offset:160
    v_mfma_f32_16x16x32_bf16 v[128:131], v[156:159], a[68:71], v[128:131]
    ds_read_b64_tr_b16 v[154:155], v70 offset:3744
    s_waitcnt vmcnt(12)
    v_mfma_f32_16x16x32_bf16 v[76:79], v[132:135], a[72:75], v[76:79]
    ds_read_b64_tr_b16 v[156:157], v70 offset:192
    v_mfma_f32_16x16x32_bf16 v[104:107], v[132:135], a[76:79], v[104:107]
    ds_read_b64_tr_b16 v[158:159], v70 offset:3776
    s_waitcnt lgkmcnt(9)
    v_mfma_f32_16x16x32_bf16 v[80:83], v[136:139], a[72:75], v[80:83]
    ds_read_b64_tr_b16 v[132:133], v70 offset:7168
    v_mfma_f32_16x16x32_bf16 v[108:111], v[136:139], a[76:79], v[108:111]
    ds_read_b64_tr_b16 v[134:135], v70 offset:10752
    v_mfma_f32_16x16x32_bf16 v[84:87], v[140:143], a[72:75], v[84:87]
    ds_read_b64_tr_b16 v[136:137], v70 offset:7200
    v_mfma_f32_16x16x32_bf16 v[112:115], v[140:143], a[76:79], v[112:115]
    ds_read_b64_tr_b16 v[138:139], v70 offset:10784
    s_waitcnt lgkmcnt(9)
    v_mfma_f32_16x16x32_bf16 v[88:91], v[144:147], a[72:75], v[88:91]
    ds_read_b64_tr_b16 v[140:141], v70 offset:7232
    v_mfma_f32_16x16x32_bf16 v[116:119], v[144:147], a[76:79], v[116:119]
    ds_read_b64_tr_b16 v[142:143], v70 offset:10816
    v_mfma_f32_16x16x32_bf16 v[92:95], v[148:151], a[72:75], v[92:95]
    ds_read_b64_tr_b16 v[144:145], v70 offset:7264
    v_mfma_f32_16x16x32_bf16 v[120:123], v[148:151], a[76:79], v[120:123]
    ds_read_b64_tr_b16 v[146:147], v70 offset:10848
    s_waitcnt lgkmcnt(8)
    v_mfma_f32_16x16x32_bf16 v[96:99], v[152:155], a[72:75], v[96:99]
    ds_read_b64_tr_b16 v[148:149], v70 offset:7296
    v_mfma_f32_16x16x32_bf16 v[124:127], v[152:155], a[76:79], v[124:127]
    ds_read_b64_tr_b16 v[150:151], v70 offset:10880
    v_mfma_f32_16x16x32_bf16 v[100:103], v[156:159], a[72:75], v[100:103]
    ds_read_b64_tr_b16 v[152:153], v70 offset:7328
    v_mfma_f32_16x16x32_bf16 v[128:131], v[156:159], a[76:79], v[128:131]
    ds_read_b64_tr_b16 v[154:155], v70 offset:10912
    s_waitcnt vmcnt(10) lgkmcnt(8)
    v_mfma_f32_16x16x32_bf16 v[76:79], v[132:135], a[80:83], v[76:79]
    ds_read_b64_tr_b16 v[156:157], v70 offset:7360
    v_mfma_f32_16x16x32_bf16 v[104:107], v[132:135], a[84:87], v[104:107]
    ds_read_b64_tr_b16 v[158:159], v70 offset:10944
    v_mfma_f32_16x16x32_bf16 v[80:83], v[136:139], a[80:83], v[80:83]
    ds_read_b64_tr_b16 v[132:133], v70 offset:14336
    v_mfma_f32_16x16x32_bf16 v[108:111], v[136:139], a[84:87], v[108:111]
    ds_read_b64_tr_b16 v[134:135], v70 offset:17920
    s_waitcnt lgkmcnt(8)
    v_mfma_f32_16x16x32_bf16 v[84:87], v[140:143], a[80:83], v[84:87]
    ds_read_b64_tr_b16 v[136:137], v70 offset:14368
    v_mfma_f32_16x16x32_bf16 v[112:115], v[140:143], a[84:87], v[112:115]
    ds_read_b64_tr_b16 v[138:139], v70 offset:17952
    v_mfma_f32_16x16x32_bf16 v[88:91], v[144:147], a[80:83], v[88:91]
    ds_read_b64_tr_b16 v[140:141], v70 offset:14400
    v_mfma_f32_16x16x32_bf16 v[116:119], v[144:147], a[84:87], v[116:119]
    ds_read_b64_tr_b16 v[142:143], v70 offset:17984
    s_waitcnt lgkmcnt(8)
    v_mfma_f32_16x16x32_bf16 v[92:95], v[148:151], a[80:83], v[92:95]
    ds_read_b64_tr_b16 v[144:145], v70 offset:14432
    v_mfma_f32_16x16x32_bf16 v[120:123], v[148:151], a[84:87], v[120:123]
    ds_read_b64_tr_b16 v[146:147], v70 offset:18016
    v_mfma_f32_16x16x32_bf16 v[96:99], v[152:155], a[80:83], v[96:99]
    ds_read_b64_tr_b16 v[148:149], v70 offset:14464
    v_mfma_f32_16x16x32_bf16 v[124:127], v[152:155], a[84:87], v[124:127]
    ds_read_b64_tr_b16 v[150:151], v70 offset:18048
    s_waitcnt lgkmcnt(8)
    v_mfma_f32_16x16x32_bf16 v[100:103], v[156:159], a[80:83], v[100:103]
    ds_read_b64_tr_b16 v[152:153], v70 offset:14496
    v_mfma_f32_16x16x32_bf16 v[128:131], v[156:159], a[84:87], v[128:131]
    ds_read_b64_tr_b16 v[154:155], v70 offset:18080
    s_waitcnt vmcnt(8)
    v_mfma_f32_16x16x32_bf16 v[76:79], v[132:135], a[88:91], v[76:79]
    ds_read_b64_tr_b16 v[156:157], v70 offset:14528
    v_mfma_f32_16x16x32_bf16 v[104:107], v[132:135], a[92:95], v[104:107]
    ds_read_b64_tr_b16 v[158:159], v70 offset:18112
    s_waitcnt lgkmcnt(8)
    v_mfma_f32_16x16x32_bf16 v[80:83], v[136:139], a[88:91], v[80:83]
    ds_read_b64_tr_b16 v[132:133], v70 offset:21504
    v_mfma_f32_16x16x32_bf16 v[108:111], v[136:139], a[92:95], v[108:111]
    ds_read_b64_tr_b16 v[134:135], v70 offset:25088
    v_mfma_f32_16x16x32_bf16 v[84:87], v[140:143], a[88:91], v[84:87]
    ds_read_b64_tr_b16 v[136:137], v70 offset:21536
    v_mfma_f32_16x16x32_bf16 v[112:115], v[140:143], a[92:95], v[112:115]
    ds_read_b64_tr_b16 v[138:139], v70 offset:25120
    s_waitcnt lgkmcnt(8)
    v_mfma_f32_16x16x32_bf16 v[88:91], v[144:147], a[88:91], v[88:91]
    ds_read_b64_tr_b16 v[140:141], v70 offset:21568
    v_mfma_f32_16x16x32_bf16 v[116:119], v[144:147], a[92:95], v[116:119]
    ds_read_b64_tr_b16 v[142:143], v70 offset:25152
    v_mfma_f32_16x16x32_bf16 v[92:95], v[148:151], a[88:91], v[92:95]
    ds_read_b32 v64, v10 offset:560
    ds_read_b64_tr_b16 v[144:145], v70 offset:21600
    v_mfma_f32_16x16x32_bf16 v[120:123], v[148:151], a[92:95], v[120:123]
    ds_read_b64_tr_b16 v[146:147], v70 offset:25184
    s_waitcnt lgkmcnt(9)
    v_mfma_f32_16x16x32_bf16 v[96:99], v[152:155], a[88:91], v[96:99]
    ds_read_b64_tr_b16 v[148:149], v70 offset:21632
    v_mfma_f32_16x16x32_bf16 v[124:127], v[152:155], a[92:95], v[124:127]
    ds_read_b64_tr_b16 v[150:151], v70 offset:25216
    v_mfma_f32_16x16x32_bf16 v[100:103], v[156:159], a[88:91], v[100:103]
    ds_read_b64_tr_b16 v[152:153], v70 offset:21664
    v_mfma_f32_16x16x32_bf16 v[128:131], v[156:159], a[92:95], v[128:131]
    ds_read_b64_tr_b16 v[154:155], v70 offset:25248
    s_waitcnt vmcnt(6) lgkmcnt(9)
    v_mfma_f32_16x16x32_bf16 v[76:79], v[132:135], a[0:3], v[76:79]
    ds_read_b64_tr_b16 v[156:157], v70 offset:21696
    v_pk_add_f32 v[44:45], v[44:45], v[46:47]
    v_mfma_f32_16x16x32_bf16 v[104:107], v[132:135], a[4:7], v[104:107]
    ds_read_b64_tr_b16 v[158:159], v70 offset:25280
    v_permlane32_swap_b32 v44, v45
    v_mfma_f32_16x16x32_bf16 v[80:83], v[136:139], a[0:3], v[80:83]
    s_waitcnt lgkmcnt(8)
    v_cmp_ne_u32 vcc, 1, v64
    s_cbranch_vccnz gt_176
gt_176_r:
    v_add_u32 v70, 0xffff0000, v70
    ds_read_b64_tr_b16 v[132:133], v70 offset:32768
    v_add_f32 v44, v44, v45
    v_mfma_f32_16x16x32_bf16 v[108:111], v[136:139], a[4:7], v[108:111]
    ds_read_b64_tr_b16 v[134:135], v70 offset:36352
    v_mov_b32 v65, v44
    s_waitcnt lgkmcnt(8)
    v_mfma_f32_16x16x32_bf16 v[84:87], v[140:143], a[0:3], v[84:87]
    ds_read_b64_tr_b16 v[136:137], v70 offset:32800
    v_permlane16_swap_b32 v44, v65
    v_mfma_f32_16x16x32_bf16 v[112:115], v[140:143], a[4:7], v[112:115]
    ds_read_b64_tr_b16 v[138:139], v70 offset:36384
    v_add_f32 v44, v44, v65
    v_mfma_f32_16x16x32_bf16 v[88:91], v[144:147], a[0:3], v[88:91]
    ds_read_b64_tr_b16 v[140:141], v70 offset:32832
    v_mov_b32 v45, v44
    v_mfma_f32_16x16x32_bf16 v[116:119], v[144:147], a[4:7], v[116:119]
    ds_read_b64_tr_b16 v[142:143], v70 offset:36416
    v_permlane32_swap_b32 v44, v45
    s_waitcnt lgkmcnt(8)
    v_mfma_f32_16x16x32_bf16 v[92:95], v[148:151], a[0:3], v[92:95]
    ds_read_b64_tr_b16 v[144:145], v70 offset:32864
    v_mul_f32 v57, 0xbb000000, v44
    v_mfma_f32_16x16x32_bf16 v[120:123], v[148:151], a[4:7], v[120:123]
    ds_read_b64_tr_b16 v[146:147], v70 offset:36448
    v_mov_b32 v65, 0x3727c5ac
    v_mfma_f32_16x16x32_bf16 v[96:99], v[152:155], a[0:3], v[96:99]
    ds_read_b64_tr_b16 v[148:149], v70 offset:32896
    v_fmac_f32 v65, 0x3b000000, v45
    v_mfma_f32_16x16x32_bf16 v[124:127], v[152:155], a[4:7], v[124:127]
    ds_read_b64_tr_b16 v[150:151], v70 offset:36480
    v_fma_f32 v65, -v57, v57, v65
    s_waitcnt lgkmcnt(8)
    v_mfma_f32_16x16x32_bf16 v[100:103], v[156:159], a[0:3], v[100:103]
    ds_read_b64_tr_b16 v[152:153], v70 offset:32928
    v_max_f32 v65, 0x3727c5ac, v65
    v_mfma_f32_16x16x32_bf16 v[128:131], v[156:159], a[4:7], v[128:131]
    ds_read_b64_tr_b16 v[154:155], v70 offset:36512
    v_rsq_f32 v44, v65
    s_waitcnt vmcnt(4)
    v_mfma_f32_16x16x32_bf16 v[76:79], v[132:135], a[8:11], v[76:79]
    ds_read_b64_tr_b16 v[156:157], v70 offset:32960
    v_mul_f32 v56, v65, v44
    v_mfma_f32_16x16x32_bf16 v[104:107], v[132:135], a[12:15], v[104:107]
    ds_read_b64_tr_b16 v[158:159], v70 offset:36544
    v_mul_f32 v55, 0xc0135761, v44
    s_waitcnt lgkmcnt(8)
    v_mfma_f32_16x16x32_bf16 v[80:83], v[136:139], a[8:11], v[80:83]
    ds_read_b64_tr_b16 v[132:133], v70 offset:39936
    v_mul_f32 v65, v44, v44
    v_mfma_f32_16x16x32_bf16 v[108:111], v[136:139], a[12:15], v[108:111]
    ds_read_b64_tr_b16 v[134:135], v70 offset:43520
    v_mul_f32 v65, 0x3d372713, v65
    v_mfma_f32_16x16x32_bf16 v[84:87], v[140:143], a[8:11], v[84:87]
    ds_read_b64_tr_b16 v[136:137], v70 offset:39968
    v_mul_f32 v54, v65, v55
    v_mfma_f32_16x16x32_bf16 v[112:115], v[140:143], a[12:15], v[112:115]
    ds_read_b64_tr_b16 v[138:139], v70 offset:43552
    v_pk_add_f32 v[48:49], v[48:49], v[50:51]
    s_waitcnt lgkmcnt(8)
    v_mfma_f32_16x16x32_bf16 v[88:91], v[144:147], a[8:11], v[88:91]
    ds_read_b64_tr_b16 v[140:141], v70 offset:40000
    v_permlane32_swap_b32 v48, v49
    v_mfma_f32_16x16x32_bf16 v[116:119], v[144:147], a[12:15], v[116:119]
    ds_read_b64_tr_b16 v[142:143], v70 offset:43584
    v_add_f32 v48, v48, v49
    v_mfma_f32_16x16x32_bf16 v[92:95], v[148:151], a[8:11], v[92:95]
    ds_read_b64_tr_b16 v[144:145], v70 offset:40032
    v_mov_b32 v65, v48
    v_mfma_f32_16x16x32_bf16 v[120:123], v[148:151], a[12:15], v[120:123]
    ds_read_b64_tr_b16 v[146:147], v70 offset:43616
    v_permlane16_swap_b32 v48, v65
    s_waitcnt lgkmcnt(8)
    v_mfma_f32_16x16x32_bf16 v[96:99], v[152:155], a[8:11], v[96:99]
    ds_read_b64_tr_b16 v[148:149], v70 offset:40064
    v_add_f32 v48, v48, v65
    v_mfma_f32_16x16x32_bf16 v[124:127], v[152:155], a[12:15], v[124:127]
    ds_read_b64_tr_b16 v[150:151], v70 offset:43648
    v_mov_b32 v49, v48
    v_mfma_f32_16x16x32_bf16 v[100:103], v[156:159], a[8:11], v[100:103]
    ds_read_b64_tr_b16 v[152:153], v70 offset:40096
    v_permlane32_swap_b32 v48, v49
    v_mfma_f32_16x16x32_bf16 v[128:131], v[156:159], a[12:15], v[128:131]
    ds_read_b64_tr_b16 v[154:155], v70 offset:43680
    v_mul_f32 v31, 0xbb000000, v48
    s_waitcnt vmcnt(2) lgkmcnt(8)
    v_mfma_f32_16x16x32_bf16 v[76:79], v[132:135], a[16:19], v[76:79]
    ds_read_b64_tr_b16 v[156:157], v70 offset:40128
    v_mov_b32 v65, 0x3727c5ac
    v_mfma_f32_16x16x32_bf16 v[104:107], v[132:135], a[20:23], v[104:107]
    ds_read_b64_tr_b16 v[158:159], v70 offset:43712
    v_fmac_f32 v65, 0x3b000000, v49
    v_mfma_f32_16x16x32_bf16 v[80:83], v[136:139], a[16:19], v[80:83]
    ds_read_b64_tr_b16 v[132:133], v70 offset:47104
    v_fma_f32 v65, -v31, v31, v65
    v_mfma_f32_16x16x32_bf16 v[108:111], v[136:139], a[20:23], v[108:111]
    ds_read_b64_tr_b16 v[134:135], v70 offset:50688
    v_max_f32 v65, 0x3727c5ac, v65
    s_waitcnt lgkmcnt(8)
    v_mfma_f32_16x16x32_bf16 v[84:87], v[140:143], a[16:19], v[84:87]
    ds_read_b64_tr_b16 v[136:137], v70 offset:47136
    v_rsq_f32 v48, v65
    v_mfma_f32_16x16x32_bf16 v[112:115], v[140:143], a[20:23], v[112:115]
    ds_read_b64_tr_b16 v[138:139], v70 offset:50720
    v_mul_f32 v30, v65, v48
    v_mfma_f32_16x16x32_bf16 v[88:91], v[144:147], a[16:19], v[88:91]
    ds_read_b64_tr_b16 v[140:141], v70 offset:47168
    v_mul_f32 v29, 0xc0135761, v48
    v_mfma_f32_16x16x32_bf16 v[116:119], v[144:147], a[20:23], v[116:119]
    ds_read_b64_tr_b16 v[142:143], v70 offset:50752
    v_mul_f32 v65, v48, v48
    s_waitcnt lgkmcnt(8)
    v_mfma_f32_16x16x32_bf16 v[92:95], v[148:151], a[16:19], v[92:95]
    ds_read_b64_tr_b16 v[144:145], v70 offset:47200
    v_mul_f32 v65, 0x3d372713, v65
    v_mfma_f32_16x16x32_bf16 v[120:123], v[148:151], a[20:23], v[120:123]
    ds_read_b64_tr_b16 v[146:147], v70 offset:50784
    v_mul_f32 v28, v65, v29
    v_mfma_f32_16x16x32_bf16 v[96:99], v[152:155], a[16:19], v[96:99]
    ds_read_b64_tr_b16 v[148:149], v70 offset:47232
    buffer_load_dword v71, v74, s[44:47], s64 offen sc1
    v_mfma_f32_16x16x32_bf16 v[124:127], v[152:155], a[20:23], v[124:127]
    ds_read_b64_tr_b16 v[150:151], v70 offset:50816
    ds_read_b32 v65, v10 offset:672
    s_waitcnt lgkmcnt(8)
    v_mfma_f32_16x16x32_bf16 v[100:103], v[156:159], a[16:19], v[100:103]
    ds_read_b64_tr_b16 v[152:153], v70 offset:47264
    v_mfma_f32_16x16x32_bf16 v[128:131], v[156:159], a[20:23], v[128:131]
    ds_read_b64_tr_b16 v[154:155], v70 offset:50848
    s_waitcnt vmcnt(1)
    v_mfma_f32_16x16x32_bf16 v[76:79], v[132:135], a[24:27], v[76:79]
    ds_read_b64_tr_b16 v[156:157], v70 offset:47296
    v_mfma_f32_16x16x32_bf16 v[104:107], v[132:135], a[28:31], v[104:107]
    ds_read_b64_tr_b16 v[158:159], v70 offset:50880
    s_waitcnt lgkmcnt(8)
    v_mfma_f32_16x16x32_bf16 v[80:83], v[136:139], a[24:27], v[80:83]
    v_mfma_f32_16x16x32_bf16 v[108:111], v[136:139], a[28:31], v[108:111]
    v_mfma_f32_16x16x32_bf16 v[84:87], v[140:143], a[24:27], v[84:87]
    v_mfma_f32_16x16x32_bf16 v[112:115], v[140:143], a[28:31], v[112:115]
    s_waitcnt lgkmcnt(4)
    v_mfma_f32_16x16x32_bf16 v[88:91], v[144:147], a[24:27], v[88:91]
    v_mfma_f32_16x16x32_bf16 v[116:119], v[144:147], a[28:31], v[116:119]
    v_mfma_f32_16x16x32_bf16 v[92:95], v[148:151], a[24:27], v[92:95]
    v_mfma_f32_16x16x32_bf16 v[120:123], v[148:151], a[28:31], v[120:123]
    s_waitcnt lgkmcnt(0)
    ds_write_b32 v11, v1 offset:144
    v_mfma_f32_16x16x32_bf16 v[96:99], v[152:155], a[24:27], v[96:99]
    v_mfma_f32_16x16x32_bf16 v[124:127], v[152:155], a[28:31], v[124:127]
    v_mfma_f32_16x16x32_bf16 v[100:103], v[156:159], a[24:27], v[100:103]
    v_mfma_f32_16x16x32_bf16 v[128:131], v[156:159], a[28:31], v[128:131]
    s_waitcnt lgkmcnt(0)
    v_cmp_ne_u32 vcc, 1, v65
    s_cbranch_vccz rc_177
    s_mov_b32 s15, 0
sp_178:
    ds_read_b32 v64, v10 offset:672
    s_add_u32 s15, s15, 1
    s_cmp_gt_u32 s15, 4000000
    s_cbranch_scc1 sp_178_x
    s_waitcnt lgkmcnt(0)
    v_cmp_ne_u32 vcc, 1, v64
    s_cbranch_vccnz sp_178
sp_178_x:
    s_waitcnt lgkmcnt(0)
rc_177:
    ds_read_b128 v[132:135], v58 offset:1280
    ds_read_b128 v[136:139], v58 offset:1344
    ds_read_b128 v[140:143], v58 offset:1408
    ds_read_b128 v[144:147], v58 offset:1472
    ds_read_b128 v[148:151], v58 offset:1536
    ds_read_b128 v[152:155], v58 offset:1600
    ds_read_b128 v[156:159], v58 offset:1664
    s_waitcnt lgkmcnt(6)
    v_pk_fma_f32 v[76:77], v[132:133], v[56:57], v[76:77] op_sel:[0,1,0] op_sel_hi:[1,1,1]
    v_pk_fma_f32 v[78:79], v[134:135], v[56:57], v[78:79] op_sel:[0,1,0] op_sel_hi:[1,1,1]
    v_pk_fma_f32 v[104:105], v[132:133], v[30:31], v[104:105] op_sel:[0,1,0] op_sel_hi:[1,1,1]
    v_pk_fma_f32 v[106:107], v[134:135], v[30:31], v[106:107] op_sel:[0,1,0] op_sel_hi:[1,1,1]
    s_waitcnt lgkmcnt(5)
    v_pk_fma_f32 v[80:81], v[136:137], v[56:57], v[80:81] op_sel:[0,1,0] op_sel_hi:[1,1,1]
    v_pk_fma_f32 v[82:83], v[138:139], v[56:57], v[82:83] op_sel:[0,1,0] op_sel_hi:[1,1,1]
    v_pk_fma_f32 v[108:109], v[136:137], v[30:31], v[108:109] op_sel:[0,1,0] op_sel_hi:[1,1,1]
    v_pk_fma_f32 v[110:111], v[138:139], v[30:31], v[110:111] op_sel:[0,1,0] op_sel_hi:[1,1,1]
    s_waitcnt lgkmcnt(4)
    v_pk_fma_f32 v[84:85], v[140:141], v[56:57], v[84:85] op_sel:[0,1,0] op_sel_hi:[1,1,1]
    v_pk_fma_f32 v[86:87], v[142:143], v[56:57], v[86:87] op_sel:[0,1,0] op_sel_hi:[1,1,1]
    v_pk_fma_f32 v[112:113], v[140:141], v[30:31], v[112:113] op_sel:[0,1,0] op_sel_hi:[1,1,1]
    v_pk_fma_f32 v[114:115], v[142:143], v[30:31], v[114:115] op_sel:[0,1,0] op_sel_hi:[1,1,1]
    s_waitcnt lgkmcnt(3)
    v_pk_fma_f32 v[88:89], v[144:145], v[56:57], v[88:89] op_sel:[0,1,0] op_sel_hi:[1,1,1]
    v_pk_fma_f32 v[90:91], v[146:147], v[56:57], v[90:91] op_sel:[0,1,0] op_sel_hi:[1,1,1]
    v_pk_fma_f32 v[116:117], v[144:145], v[30:31], v[116:117] op_sel:[0,1,0] op_sel_hi:[1,1,1]
    v_pk_fma_f32 v[118:119], v[146:147], v[30:31], v[118:119] op_sel:[0,1,0] op_sel_hi:[1,1,1]
    s_waitcnt lgkmcnt(2)
    v_pk_fma_f32 v[92:93], v[148:149], v[56:57], v[92:93] op_sel:[0,1,0] op_sel_hi:[1,1,1]
    v_pk_fma_f32 v[94:95], v[150:151], v[56:57], v[94:95] op_sel:[0,1,0] op_sel_hi:[1,1,1]
    v_pk_fma_f32 v[120:121], v[148:149], v[30:31], v[120:121] op_sel:[0,1,0] op_sel_hi:[1,1,1]
    v_pk_fma_f32 v[122:123], v[150:151], v[30:31], v[122:123] op_sel:[0,1,0] op_sel_hi:[1,1,1]
    s_waitcnt lgkmcnt(1)
    v_pk_fma_f32 v[96:97], v[152:153], v[56:57], v[96:97] op_sel:[0,1,0] op_sel_hi:[1,1,1]
    v_pk_fma_f32 v[98:99], v[154:155], v[56:57], v[98:99] op_sel:[0,1,0] op_sel_hi:[1,1,1]
    v_pk_fma_f32 v[124:125], v[152:153], v[30:31], v[124:125] op_sel:[0,1,0] op_sel_hi:[1,1,1]
    v_pk_fma_f32 v[126:127], v[154:155], v[30:31], v[126:127] op_sel:[0,1,0] op_sel_hi:[1,1,1]
    s_waitcnt lgkmcnt(0)
    v_pk_fma_f32 v[100:101], v[156:157], v[56:57], v[100:101] op_sel:[0,1,0] op_sel_hi:[1,1,1]
    v_pk_fma_f32 v[102:103], v[158:159], v[56:57], v[102:103] op_sel:[0,1,0] op_sel_hi:[1,1,1]
    v_pk_fma_f32 v[128:129], v[156:157], v[30:31], v[128:129] op_sel:[0,1,0] op_sel_hi:[1,1,1]
    v_pk_fma_f32 v[130:131], v[158:159], v[30:31], v[130:131] op_sel:[0,1,0] op_sel_hi:[1,1,1]
    v_pk_mul_f32 v[132:133], v[76:77], v[76:77]
    v_pk_mul_f32 v[134:135], v[78:79], v[78:79]
    v_pk_mul_f32 v[136:137], v[80:81], v[80:81]
    v_pk_mul_f32 v[138:139], v[82:83], v[82:83]
    v_pk_mul_f32 v[140:141], v[84:85], v[84:85]
    v_pk_mul_f32 v[142:143], v[86:87], v[86:87]
    v_pk_mul_f32 v[144:145], v[88:89], v[88:89]
    v_pk_mul_f32 v[146:147], v[90:91], v[90:91]
    v_pk_mul_f32 v[148:149], v[92:93], v[92:93]
    v_pk_mul_f32 v[150:151], v[94:95], v[94:95]
    v_pk_mul_f32 v[152:153], v[96:97], v[96:97]
    v_pk_mul_f32 v[154:155], v[98:99], v[98:99]
    v_pk_mul_f32 v[156:157], v[100:101], v[100:101]
    v_pk_mul_f32 v[158:159], v[102:103], v[102:103]
    v_pk_fma_f32 v[132:133], v[132:133], v[54:55], v[54:55] op_sel:[0,0,1] op_sel_hi:[1,0,1]
    v_pk_fma_f32 v[134:135], v[134:135], v[54:55], v[54:55] op_sel:[0,0,1] op_sel_hi:[1,0,1]
    v_pk_fma_f32 v[136:137], v[136:137], v[54:55], v[54:55] op_sel:[0,0,1] op_sel_hi:[1,0,1]
    v_pk_fma_f32 v[138:139], v[138:139], v[54:55], v[54:55] op_sel:[0,0,1] op_sel_hi:[1,0,1]
    v_pk_fma_f32 v[140:141], v[140:141], v[54:55], v[54:55] op_sel:[0,0,1] op_sel_hi:[1,0,1]
    v_pk_fma_f32 v[142:143], v[142:143], v[54:55], v[54:55] op_sel:[0,0,1] op_sel_hi:[1,0,1]
    v_pk_fma_f32 v[144:145], v[144:145], v[54:55], v[54:55] op_sel:[0,0,1] op_sel_hi:[1,0,1]
    v_pk_fma_f32 v[146:147], v[146:147], v[54:55], v[54:55] op_sel:[0,0,1] op_sel_hi:[1,0,1]
    v_pk_fma_f32 v[148:149], v[148:149], v[54:55], v[54:55] op_sel:[0,0,1] op_sel_hi:[1,0,1]
    v_pk_fma_f32 v[150:151], v[150:151], v[54:55], v[54:55] op_sel:[0,0,1] op_sel_hi:[1,0,1]
    v_pk_fma_f32 v[152:153], v[152:153], v[54:55], v[54:55] op_sel:[0,0,1] op_sel_hi:[1,0,1]
    v_pk_fma_f32 v[154:155], v[154:155], v[54:55], v[54:55] op_sel:[0,0,1] op_sel_hi:[1,0,1]
    v_pk_fma_f32 v[156:157], v[156:157], v[54:55], v[54:55] op_sel:[0,0,1] op_sel_hi:[1,0,1]
    v_pk_fma_f32 v[158:159], v[158:159], v[54:55], v[54:55] op_sel:[0,0,1] op_sel_hi:[1,0,1]
    v_pk_mul_f32 v[132:133], v[132:133], v[76:77]
    v_pk_mul_f32 v[134:135], v[134:135], v[78:79]
    v_pk_mul_f32 v[136:137], v[136:137], v[80:81]
    v_pk_mul_f32 v[138:139], v[138:139], v[82:83]
    v_pk_mul_f32 v[140:141], v[140:141], v[84:85]
    v_pk_mul_f32 v[142:143], v[142:143], v[86:87]
    v_pk_mul_f32 v[144:145], v[144:145], v[88:89]
    v_pk_mul_f32 v[146:147], v[146:147], v[90:91]
    v_pk_mul_f32 v[148:149], v[148:149], v[92:93]
    v_pk_mul_f32 v[150:151], v[150:151], v[94:95]
    v_pk_mul_f32 v[152:153], v[152:153], v[96:97]
    v_pk_mul_f32 v[154:155], v[154:155], v[98:99]
    v_pk_mul_f32 v[156:157], v[156:157], v[100:101]
    v_pk_mul_f32 v[158:159], v[158:159], v[102:103]
    v_exp_f32 v132, v132
    v_exp_f32 v133, v133
    v_exp_f32 v134, v134
    v_exp_f32 v135, v135
    v_exp_f32 v136, v136
    v_exp_f32 v137, v137
    v_exp_f32 v138, v138
    v_exp_f32 v139, v139
    v_exp_f32 v140, v140
    v_exp_f32 v141, v141
    v_exp_f32 v142, v142
    v_exp_f32 v143, v143
    v_exp_f32 v144, v144
    v_exp_f32 v145, v145
    v_exp_f32 v146, v146
    v_exp_f32 v147, v147
    v_exp_f32 v148, v148
    v_exp_f32 v149, v149
    v_exp_f32 v150, v150
    v_exp_f32 v151, v151
    v_exp_f32 v152, v152
    v_exp_f32 v153, v153
    v_exp_f32 v154, v154
    v_exp_f32 v155, v155
    v_exp_f32 v156, v156
    v_exp_f32 v157, v157
    v_exp_f32 v158, v158
    v_exp_f32 v159, v159
    v_pk_fma_f32 v[132:133], v[132:133], v[56:57], v[56:57] op_sel_hi:[1,0,0]
    v_pk_fma_f32 v[134:135], v[134:135], v[56:57], v[56:57] op_sel_hi:[1,0,0]
    v_pk_fma_f32 v[136:137], v[136:137], v[56:57], v[56:57] op_sel_hi:[1,0,0]
    v_pk_fma_f32 v[138:139], v[138:139], v[56:57], v[56:57] op_sel_hi:[1,0,0]
    v_pk_fma_f32 v[140:141], v[140:141], v[56:57], v[56:57] op_sel_hi:[1,0,0]
    v_pk_fma_f32 v[142:143], v[142:143], v[56:57], v[56:57] op_sel_hi:[1,0,0]
    v_pk_fma_f32 v[144:145], v[144:145], v[56:57], v[56:57] op_sel_hi:[1,0,0]
    v_pk_fma_f32 v[146:147], v[146:147], v[56:57], v[56:57] op_sel_hi:[1,0,0]
    v_pk_fma_f32 v[148:149], v[148:149], v[56:57], v[56:57] op_sel_hi:[1,0,0]
    v_pk_fma_f32 v[150:151], v[150:151], v[56:57], v[56:57] op_sel_hi:[1,0,0]
    v_pk_fma_f32 v[152:153], v[152:153], v[56:57], v[56:57] op_sel_hi:[1,0,0]
    v_pk_fma_f32 v[154:155], v[154:155], v[56:57], v[56:57] op_sel_hi:[1,0,0]
    v_pk_fma_f32 v[156:157], v[156:157], v[56:57], v[56:57] op_sel_hi:[1,0,0]
    v_pk_fma_f32 v[158:159], v[158:159], v[56:57], v[56:57] op_sel_hi:[1,0,0]
    v_rcp_f32 v132, v132
    v_rcp_f32 v133, v133
    v_rcp_f32 v134, v134
    v_rcp_f32 v135, v135
    v_rcp_f32 v136, v136
    v_rcp_f32 v137, v137
    v_rcp_f32 v138, v138
    v_rcp_f32 v139, v139
    v_rcp_f32 v140, v140
    v_rcp_f32 v141, v141
    v_rcp_f32 v142, v142
    v_rcp_f32 v143, v143
    v_rcp_f32 v144, v144
    v_rcp_f32 v145, v145
    v_rcp_f32 v146, v146
    v_rcp_f32 v147, v147
    v_rcp_f32 v148, v148
    v_rcp_f32 v149, v149
    v_rcp_f32 v150, v150
    v_rcp_f32 v151, v151
    v_rcp_f32 v152, v152
    v_rcp_f32 v153, v153
    v_rcp_f32 v154, v154
    v_rcp_f32 v155, v155
    v_rcp_f32 v156, v156
    v_rcp_f32 v157, v157
    v_rcp_f32 v158, v158
    v_rcp_f32 v159, v159
    v_pk_mul_f32 v[76:77], v[76:77], v[132:133]
    v_pk_mul_f32 v[78:79], v[78:79], v[134:135]
    v_pk_mul_f32 v[80:81], v[80:81], v[136:137]
    v_pk_mul_f32 v[82:83], v[82:83], v[138:139]
    v_pk_mul_f32 v[84:85], v[84:85], v[140:141]
    v_pk_mul_f32 v[86:87], v[86:87], v[142:143]
    v_pk_mul_f32 v[88:89], v[88:89], v[144:145]
    v_pk_mul_f32 v[90:91], v[90:91], v[146:147]
    v_pk_mul_f32 v[92:93], v[92:93], v[148:149]
    v_pk_mul_f32 v[94:95], v[94:95], v[150:151]
    v_pk_mul_f32 v[96:97], v[96:97], v[152:153]
    v_pk_mul_f32 v[98:99], v[98:99], v[154:155]
    v_pk_mul_f32 v[100:101], v[100:101], v[156:157]
    v_pk_mul_f32 v[102:103], v[102:103], v[158:159]
    v_cvt_pk_bf16_f32 v76, v76, v77
    v_cvt_pk_bf16_f32 v77, v78, v79
    v_cvt_pk_bf16_f32 v78, v80, v81
    v_cvt_pk_bf16_f32 v79, v82, v83
    v_cvt_pk_bf16_f32 v80, v84, v85
    v_cvt_pk_bf16_f32 v81, v86, v87
    v_cvt_pk_bf16_f32 v82, v88, v89
    v_cvt_pk_bf16_f32 v83, v90, v91
    v_cvt_pk_bf16_f32 v84, v92, v93
    v_cvt_pk_bf16_f32 v85, v94, v95
    v_cvt_pk_bf16_f32 v86, v96, v97
    v_cvt_pk_bf16_f32 v87, v98, v99
    v_cvt_pk_bf16_f32 v88, v100, v101
    v_cvt_pk_bf16_f32 v89, v102, v103
    s_waitcnt vmcnt(0)
    v_cmp_ne_u32 vcc, s36, v71
    s_cbranch_vccz nb_179
    s_mov_b32 s15, 0
sp_180:
    buffer_load_dword v9, v74, s[44:47], s64 offen sc1
    s_add_u32 s15, s15, 1
    s_cmp_gt_u32 s15, 100000
    s_cbranch_scc1 sp_180_x
    s_waitcnt vmcnt(0)
    v_cmp_ne_u32 vcc, s36, v9
    s_cbranch_vccnz sp_180
sp_180_x:
    s_waitcnt vmcnt(0)
nb_179:
    s_bitcmp1_b32 s13, 0
    s_cbranch_scc1 odd_181
    s_cmp_lg_u32 s37, 1
    s_cbranch_scc1 ps_183
pd_184_f:
    buffer_store_dwordx4 v[76:79], v5, s[44:47], s58 offen offset:0
    buffer_store_dwordx4 v[80:83], v5, s[44:47], s58 offen offset:1024
    buffer_store_dwordx4 v[84:87], v5, s[44:47], s58 offen offset:2048
    buffer_store_dwordx2 v[88:89], v5, s[44:47], s58 offen offset:3072
pd_184:
    s_branch oe_182
odd_181:
    s_cmp_lg_u32 s37, 1
    s_cbranch_scc1 ps_185
pd_186_f:
    buffer_store_dwordx2 v[76:77], v5, s[44:47], s58 offen offset:8
    buffer_store_dwordx4 v[78:81], v5, s[44:47], s58 offen offset:1024
    buffer_store_dwordx4 v[82:85], v5, s[44:47], s58 offen offset:2048
    buffer_store_dwordx4 v[86:89], v5, s[44:47], s58 offen offset:3072
pd_186:
oe_182:
    s_mov_b32 s15, 0
sp_187:
    ds_read_b32 v64, v10 offset:576
    s_add_u32 s15, s15, 1
    s_cmp_gt_u32 s15, 4000000
    s_cbranch_scc1 sp_187_x
    s_waitcnt lgkmcnt(0)
    v_cmp_ne_u32 vcc, 1, v64
    s_cbranch_vccnz sp_187
sp_187_x:
    s_waitcnt lgkmcnt(0)
    v_pk_mul_f32 v[132:133], v[104:105], v[104:105]
    ds_read_b64_tr_b16 a[0:1], v66 offset:0
    v_pk_mul_f32 v[134:135], v[106:107], v[106:107]
    v_pk_mul_f32 v[136:137], v[108:109], v[108:109]
    ds_read_b64_tr_b16 a[2:3], v66 offset:2048
    v_pk_mul_f32 v[138:139], v[110:111], v[110:111]
    v_pk_mul_f32 v[140:141], v[112:113], v[112:113]
    ds_read_b64_tr_b16 a[4:5], v67 offset:0
    v_pk_mul_f32 v[142:143], v[114:115], v[114:115]
    v_pk_mul_f32 v[144:145], v[116:117], v[116:117]
    ds_read_b64_tr_b16 a[6:7], v67 offset:2048
    v_pk_mul_f32 v[146:147], v[118:119], v[118:119]
    v_pk_mul_f32 v[148:149], v[120:121], v[120:121]
    ds_read_b64_tr_b16 a[8:9], v68 offset:0
    v_pk_mul_f32 v[150:151], v[122:123], v[122:123]
    v_pk_mul_f32 v[152:153], v[124:125], v[124:125]
    ds_read_b64_tr_b16 a[10:11], v68 offset:2048
    v_pk_mul_f32 v[154:155], v[126:127], v[126:127]
    v_pk_mul_f32 v[156:157], v[128:129], v[128:129]
    ds_read_b64_tr_b16 a[12:13], v69 offset:0
    v_pk_mul_f32 v[158:159], v[130:131], v[130:131]
    v_pk_fma_f32 v[132:133], v[132:133], v[28:29], v[28:29] op_sel:[0,0,1] op_sel_hi:[1,0,1]
    ds_read_b64_tr_b16 a[14:15], v69 offset:2048
    v_pk_fma_f32 v[134:135], v[134:135], v[28:29], v[28:29] op_sel:[0,0,1] op_sel_hi:[1,0,1]
    v_pk_fma_f32 v[136:137], v[136:137], v[28:29], v[28:29] op_sel:[0,0,1] op_sel_hi:[1,0,1]
    ds_read_b64_tr_b16 a[16:17], v66 offset:8192
    v_pk_fma_f32 v[138:139], v[138:139], v[28:29], v[28:29] op_sel:[0,0,1] op_sel_hi:[1,0,1]
    v_pk_fma_f32 v[140:141], v[140:141], v[28:29], v[28:29] op_sel:[0,0,1] op_sel_hi:[1,0,1]
    ds_read_b64_tr_b16 a[18:19], v66 offset:10240
    v_pk_fma_f32 v[142:143], v[142:143], v[28:29], v[28:29] op_sel:[0,0,1] op_sel_hi:[1,0,1]
    v_pk_fma_f32 v[144:145], v[144:145], v[28:29], v[28:29] op_sel:[0,0,1] op_sel_hi:[1,0,1]
    ds_read_b64_tr_b16 a[20:21], v67 offset:8192
    v_pk_fma_f32 v[146:147], v[146:147], v[28:29], v[28:29] op_sel:[0,0,1] op_sel_hi:[1,0,1]
    v_pk_fma_f32 v[148:149], v[148:149], v[28:29], v[28:29] op_sel:[0,0,1] op_sel_hi:[1,0,1]
    ds_read_b64_tr_b16 a[22:23], v67 offset:10240
    v_pk_fma_f32 v[150:151], v[150:151], v[28:29], v[28:29] op_sel:[0,0,1] op_sel_hi:[1,0,1]
    v_pk_fma_f32 v[152:153], v[152:153], v[28:29], v[28:29] op_sel:[0,0,1] op_sel_hi:[1,0,1]
    ds_read_b64_tr_b16 a[24:25], v68 offset:8192
    v_pk_fma_f32 v[154:155], v[154:155], v[28:29], v[28:29] op_sel:[0,0,1] op_sel_hi:[1,0,1]
    v_pk_fma_f32 v[156:157], v[156:157], v[28:29], v[28:29] op_sel:[0,0,1] op_sel_hi:[1,0,1]
    ds_read_b64_tr_b16 a[26:27], v68 offset:10240
    v_pk_fma_f32 v[158:159], v[158:159], v[28:29], v[28:29] op_sel:[0,0,1] op_sel_hi:[1,0,1]
    v_pk_mul_f32 v[132:133], v[132:133], v[104:105]
    ds_read_b64_tr_b16 a[28:29], v69 offset:8192
    v_pk_mul_f32 v[134:135], v[134:135], v[106:107]
    v_pk_mul_f32 v[136:137], v[136:137], v[108:109]
    ds_read_b64_tr_b16 a[30:31], v69 offset:10240
    v_pk_mul_f32 v[138:139], v[138:139], v[110:111]
    v_pk_mul_f32 v[140:141], v[140:141], v[112:113]
    ds_read_b64_tr_b16 a[32:33], v66 offset:16384
    v_pk_mul_f32 v[142:143], v[142:143], v[114:115]
    v_pk_mul_f32 v[144:145], v[144:145], v[116:117]
    ds_read_b64_tr_b16 a[34:35], v66 offset:18432
    v_pk_mul_f32 v[146:147], v[146:147], v[118:119]
    v_pk_mul_f32 v[148:149], v[148:149], v[120:121]
    ds_read_b64_tr_b16 a[36:37], v67 offset:16384
    v_pk_mul_f32 v[150:151], v[150:151], v[122:123]
    v_pk_mul_f32 v[152:153], v[152:153], v[124:125]
    ds_read_b64_tr_b16 a[38:39], v67 offset:18432
    v_pk_mul_f32 v[154:155], v[154:155], v[126:127]
    v_pk_mul_f32 v[156:157], v[156:157], v[128:129]
    ds_read_b64_tr_b16 a[40:41], v68 offset:16384
    v_pk_mul_f32 v[158:159], v[158:159], v[130:131]
    v_exp_f32 v132, v132
    ds_read_b64_tr_b16 a[42:43], v68 offset:18432
    v_exp_f32 v133, v133
    v_exp_f32 v134, v134
    ds_read_b64_tr_b16 a[44:45], v69 offset:16384
    v_exp_f32 v135, v135
    v_exp_f32 v136, v136
    ds_read_b64_tr_b16 a[46:47], v69 offset:18432
    v_exp_f32 v137, v137
    v_exp_f32 v138, v138
    ds_read_b64_tr_b16 a[48:49], v66 offset:24576
    v_exp_f32 v139, v139
    v_exp_f32 v140, v140
    ds_read_b64_tr_b16 a[50:51], v66 offset:26624
    v_exp_f32 v141, v141
    v_exp_f32 v142, v142
    ds_read_b64_tr_b16 a[52:53], v67 offset:24576
    v_exp_f32 v143, v143
    v_exp_f32 v144, v144
    ds_read_b64_tr_b16 a[54:55], v67 offset:26624
    v_exp_f32 v145, v145
    v_exp_f32 v146, v146
    ds_read_b64_tr_b16 a[56:57], v68 offset:24576
    v_exp_f32 v147, v147
    v_exp_f32 v148, v148
    ds_read_b64_tr_b16 a[58:59], v68 offset:26624
    v_exp_f32 v149, v149
    v_exp_f32 v150, v150
    ds_read_b64_tr_b16 a[60:61], v69 offset:24576
    v_exp_f32 v151, v151
    v_exp_f32 v152, v152
    ds_read_b64_tr_b16 a[62:63], v69 offset:26624
    v_exp_f32 v153, v153
    v_exp_f32 v154, v154
    ds_read_b32 v64, v10 offset:592
    v_exp_f32 v155, v155
    v_exp_f32 v156, v156
    v_add_u32 v66, 0x10000, v66
    v_exp_f32 v157, v157
    v_exp_f32 v158, v158
    v_add_u32 v67, 0x10000, v67
    v_exp_f32 v159, v159
    v_pk_fma_f32 v[132:133], v[132:133], v[30:31], v[30:31] op_sel_hi:[1,0,0]
    v_add_u32 v68, 0x10000, v68
    v_pk_fma_f32 v[134:135], v[134:135], v[30:31], v[30:31] op_sel_hi:[1,0,0]
    v_pk_fma_f32 v[136:137], v[136:137], v[30:31], v[30:31] op_sel_hi:[1,0,0]
    v_add_u32 v69, 0x10000, v69
    v_pk_fma_f32 v[138:139], v[138:139], v[30:31], v[30:31] op_sel_hi:[1,0,0]
    v_pk_fma_f32 v[140:141], v[140:141], v[30:31], v[30:31] op_sel_hi:[1,0,0]
    ds_read_b64_tr_b16 a[64:65], v66 offset:57344
    v_pk_fma_f32 v[142:143], v[142:143], v[30:31], v[30:31] op_sel_hi:[1,0,0]
    v_pk_fma_f32 v[144:145], v[144:145], v[30:31], v[30:31] op_sel_hi:[1,0,0]
    ds_read_b64_tr_b16 a[66:67], v66 offset:59392
    v_pk_fma_f32 v[146:147], v[146:147], v[30:31], v[30:31] op_sel_hi:[1,0,0]
    v_pk_fma_f32 v[148:149], v[148:149], v[30:31], v[30:31] op_sel_hi:[1,0,0]
    ds_read_b64_tr_b16 a[68:69], v67 offset:57344
    v_pk_fma_f32 v[150:151], v[150:151], v[30:31], v[30:31] op_sel_hi:[1,0,0]
    v_pk_fma_f32 v[152:153], v[152:153], v[30:31], v[30:31] op_sel_hi:[1,0,0]
    ds_read_b64_tr_b16 a[70:71], v67 offset:59392
    v_pk_fma_f32 v[154:155], v[154:155], v[30:31], v[30:31] op_sel_hi:[1,0,0]
    v_pk_fma_f32 v[156:157], v[156:157], v[30:31], v[30:31] op_sel_hi:[1,0,0]
    ds_read_b64_tr_b16 a[72:73], v68 offset:57344
    v_pk_fma_f32 v[158:159], v[158:159], v[30:31], v[30:31] op_sel_hi:[1,0,0]
    v_rcp_f32 v132, v132
    ds_read_b64_tr_b16 a[74:75], v68 offset:59392
    v_rcp_f32 v133, v133
    v_rcp_f32 v134, v134
    ds_read_b64_tr_b16 a[76:77], v69 offset:57344
    v_rcp_f32 v135, v135
    v_rcp_f32 v136, v136
    ds_read_b64_tr_b16 a[78:79], v69 offset:59392
    v_rcp_f32 v137, v137
    v_rcp_f32 v138, v138
    v_rcp_f32 v139, v139
    v_rcp_f32 v140, v140
    v_rcp_f32 v141, v141
    v_rcp_f32 v142, v142
    v_rcp_f32 v143, v143
    v_rcp_f32 v144, v144
    v_rcp_f32 v145, v145
    v_rcp_f32 v146, v146
    v_rcp_f32 v147, v147
    v_rcp_f32 v148, v148
    v_rcp_f32 v149, v149
    v_rcp_f32 v150, v150
    v_rcp_f32 v151, v151
    v_rcp_f32 v152, v152
    v_rcp_f32 v153, v153
    v_rcp_f32 v154, v154
    v_rcp_f32 v155, v155
    v_rcp_f32 v156, v156
    v_rcp_f32 v157, v157
    v_rcp_f32 v158, v158
    v_rcp_f32 v159, v159
    v_pk_mul_f32 v[104:105], v[104:105], v[132:133]
    v_pk_mul_f32 v[106:107], v[106:107], v[134:135]
    v_pk_mul_f32 v[108:109], v[108:109], v[136:137]
    v_pk_mul_f32 v[110:111], v[110:111], v[138:139]
    v_pk_mul_f32 v[112:113], v[112:113], v[140:141]
    v_pk_mul_f32 v[114:115], v[114:115], v[142:143]
    v_pk_mul_f32 v[116:117], v[116:117], v[144:145]
    v_pk_mul_f32 v[118:119], v[118:119], v[146:147]
    v_pk_mul_f32 v[120:121], v[120:121], v[148:149]
    v_pk_mul_f32 v[122:123], v[122:123], v[150:151]
    v_pk_mul_f32 v[124:125], v[124:125], v[152:153]
    v_pk_mul_f32 v[126:127], v[126:127], v[154:155]
    v_pk_mul_f32 v[128:129], v[128:129], v[156:157]
    v_pk_mul_f32 v[130:131], v[130:131], v[158:159]
    v_cvt_pk_bf16_f32 v104, v104, v105
    v_cvt_pk_bf16_f32 v105, v106, v107
    v_cvt_pk_bf16_f32 v106, v108, v109
    v_cvt_pk_bf16_f32 v107, v110, v111
    v_cvt_pk_bf16_f32 v108, v112, v113
    v_cvt_pk_bf16_f32 v109, v114, v115
    v_cvt_pk_bf16_f32 v110, v116, v117
    v_cvt_pk_bf16_f32 v111, v118, v119
    v_cvt_pk_bf16_f32 v112, v120, v121
    v_cvt_pk_bf16_f32 v113, v122, v123
    v_cvt_pk_bf16_f32 v114, v124, v125
    v_cvt_pk_bf16_f32 v115, v126, v127
    v_cvt_pk_bf16_f32 v116, v128, v129
    v_cvt_pk_bf16_f32 v117, v130, v131
    s_waitcnt lgkmcnt(0)
    ds_write_b32 v11, v1 offset:160
    s_bitcmp1_b32 s13, 0
    s_cbranch_scc1 odd_188
    s_cmp_lg_u32 s37, 1
    s_cbranch_scc1 ps_190
pd_191_f:
    buffer_store_dwordx4 v[104:107], v5, s[44:47], s59 offen offset:0
    buffer_store_dwordx4 v[108:111], v5, s[44:47], s59 offen offset:1024
    buffer_store_dwordx4 v[112:115], v5, s[44:47], s59 offen offset:2048
    buffer_store_dwordx2 v[116:117], v5, s[44:47], s59 offen offset:3072
pd_191:
    s_branch oe_189
odd_188:
    s_cmp_lg_u32 s37, 1
    s_cbranch_scc1 ps_192
pd_193_f:
    buffer_store_dwordx2 v[104:105], v5, s[44:47], s59 offen offset:8
    buffer_store_dwordx4 v[106:109], v5, s[44:47], s59 offen offset:1024
    buffer_store_dwordx4 v[110:113], v5, s[44:47], s59 offen offset:2048
    buffer_store_dwordx4 v[114:117], v5, s[44:47], s59 offen offset:3072
pd_193:
oe_189:
    ds_read_b128 v[28:31], v58 offset:768
    ds_read_b128 v[32:35], v58 offset:832
    ds_read_b128 v[36:39], v58 offset:896
    ds_read_b128 v[40:43], v58 offset:960
    v_mov_b32 v70, v72
    v_xor_b32 v71, 0x1000, v72
    v_mov_b32 v72, v73
    s_waitcnt vmcnt(0)
    s_mov_b64 exec, 1
    s_cmp_lg_u32 s37, 1
    s_cbranch_scc1 ps_194
pd_195_f:
    buffer_store_dword v8, v6, s[44:47], s79 offen
pd_195:
    s_mov_b64 exec, -1
    ds_write_b32 v11, v1 offset:304
    s_mov_b32 s15, 0
sp_196:
    buffer_load_dword v9, v60, s[44:47], s95 offen sc1
    s_add_u32 s15, s15, 1
    s_cmp_gt_u32 s15, 100000
    s_cbranch_scc1 sp_196_x
    s_waitcnt vmcnt(0)
    v_cmp_ne_u32 vcc, s36, v9
    s_cbranch_vccnz sp_196
sp_196_x:
    s_waitcnt vmcnt(0)
    s_add_u32 s56, s65, 0
    buffer_load_dwordx4 v[108:111], v5, s[44:47], s56 offen offset:0 sc1
    s_add_u32 s57, s66, 0
    buffer_load_dwordx4 v[112:115], v5, s[44:47], s57 offen offset:0 sc1
    buffer_load_dwordx4 v[116:119], v5, s[44:47], s56 offen offset:2048 sc1
    buffer_load_dwordx4 v[120:123], v5, s[44:47], s57 offen offset:2048 sc1
    s_add_u32 s56, s65, 4096
    buffer_load_dwordx4 v[124:127], v5, s[44:47], s56 offen offset:0 sc1
    s_add_u32 s57, s66, 4096
    buffer_load_dwordx4 v[128:131], v5, s[44:47], s57 offen offset:0 sc1
    buffer_load_dwordx4 v[132:135], v5, s[44:47], s56 offen offset:2048 sc1
    buffer_load_dwordx4 v[136:139], v5, s[44:47], s57 offen offset:2048 sc1
    s_mov_b32 s15, 0
sp_197:
    ds_read_b32 v64, v10 offset:592
    s_add_u32 s15, s15, 1
    s_cmp_gt_u32 s15, 4000000
    s_cbranch_scc1 sp_197_x
    s_waitcnt lgkmcnt(0)
    v_cmp_ne_u32 vcc, 1, v64
    s_cbranch_vccnz sp_197
sp_197_x:
    s_waitcnt lgkmcnt(0)
    v_add_u32 v66, 0xffff0000, v66
    v_add_u32 v67, 0xffff0000, v67
    v_add_u32 v68, 0xffff0000, v68
    v_add_u32 v69, 0xffff0000, v69
    ds_read_b64_tr_b16 a[80:81], v66 offset:32768
    ds_read_b64_tr_b16 a[82:83], v66 offset:34816
    ds_read_b64_tr_b16 a[84:85], v67 offset:32768
    ds_read_b64_tr_b16 a[86:87], v67 offset:34816
    ds_read_b64_tr_b16 a[88:89], v68 offset:32768
    ds_read_b64_tr_b16 a[90:91], v68 offset:34816
    s_waitcnt vmcnt(6) lgkmcnt(14)
    v_mfma_f32_16x16x32_bf16 v[76:79], a[0:3], v[108:111], 0
    ds_read_b64_tr_b16 a[92:93], v69 offset:32768
    v_mfma_f32_16x16x32_bf16 v[92:95], a[0:3], v[112:115], 0
    ds_read_b64_tr_b16 a[94:95], v69 offset:34816
    v_mfma_f32_16x16x32_bf16 v[80:83], a[4:7], v[108:111], 0
    ds_read_b64_tr_b16 a[0:1], v66 offset:40960
    v_mfma_f32_16x16x32_bf16 v[96:99], a[4:7], v[112:115], 0
    ds_read_b64_tr_b16 a[2:3], v66 offset:43008
    s_add_u32 s56, s65, 8192
    buffer_load_dwordx4 v[140:143], v5, s[44:47], s56 offen offset:0 sc1
    s_waitcnt lgkmcnt(14)
    v_mfma_f32_16x16x32_bf16 v[84:87], a[8:11], v[108:111], 0
    ds_read_b64_tr_b16 a[4:5], v67 offset:40960
    v_mfma_f32_16x16x32_bf16 v[100:103], a[8:11], v[112:115], 0
    ds_read_b64_tr_b16 a[6:7], v67 offset:43008
    s_add_u32 s57, s66, 8192
    buffer_load_dwordx4 v[144:147], v5, s[44:47], s57 offen offset:0 sc1
    v_mfma_f32_16x16x32_bf16 v[88:91], a[12:15], v[108:111], 0
    ds_read_b64_tr_b16 a[8:9], v68 offset:40960
    v_mfma_f32_16x16x32_bf16 v[104:107], a[12:15], v[112:115], 0
    ds_read_b64_tr_b16 a[10:11], v68 offset:43008
    s_waitcnt vmcnt(6) lgkmcnt(14)
    v_mfma_f32_16x16x32_bf16 v[76:79], a[16:19], v[116:119], v[76:79]
    ds_read_b64_tr_b16 a[12:13], v69 offset:40960
    v_mfma_f32_16x16x32_bf16 v[92:95], a[16:19], v[120:123], v[92:95]
    ds_read_b64_tr_b16 a[14:15], v69 offset:43008
    v_mfma_f32_16x16x32_bf16 v[80:83], a[20:23], v[116:119], v[80:83]
    ds_read_b64_tr_b16 a[16:17], v66 offset:49152
    v_mfma_f32_16x16x32_bf16 v[96:99], a[20:23], v[120:123], v[96:99]
    ds_read_b64_tr_b16 a[18:19], v66 offset:51200
    buffer_load_dwordx4 v[148:151], v5, s[44:47], s56 offen offset:2048 sc1
    s_waitcnt lgkmcnt(14)
    v_mfma_f32_16x16x32_bf16 v[84:87], a[24:27], v[116:119], v[84:87]
    ds_read_b64_tr_b16 a[20:21], v67 offset:49152
    v_mfma_f32_16x16x32_bf16 v[100:103], a[24:27], v[120:123], v[100:103]
    ds_read_b64_tr_b16 a[22:23], v67 offset:51200
    buffer_load_dwordx4 v[152:155], v5, s[44:47], s57 offen offset:2048 sc1
    v_mfma_f32_16x16x32_bf16 v[88:91], a[28:31], v[116:119], v[88:91]
    ds_read_b64_tr_b16 a[24:25], v68 offset:49152
    v_mfma_f32_16x16x32_bf16 v[104:107], a[28:31], v[120:123], v[104:107]
    ds_read_b64_tr_b16 a[26:27], v68 offset:51200
    s_waitcnt vmcnt(6) lgkmcnt(14)
    v_mfma_f32_16x16x32_bf16 v[76:79], a[32:35], v[124:127], v[76:79]
    ds_read_b64_tr_b16 a[28:29], v69 offset:49152
    v_mfma_f32_16x16x32_bf16 v[92:95], a[32:35], v[128:131], v[92:95]
    ds_read_b64_tr_b16 a[30:31], v69 offset:51200
    v_mfma_f32_16x16x32_bf16 v[80:83], a[36:39], v[124:127], v[80:83]
    ds_read_b64_tr_b16 a[32:33], v66 offset:57344
    v_mfma_f32_16x16x32_bf16 v[96:99], a[36:39], v[128:131], v[96:99]
    ds_read_b64_tr_b16 a[34:35], v66 offset:59392
    s_add_u32 s56, s65, 12288
    buffer_load_dwordx4 v[108:111], v5, s[44:47], s56 offen offset:0 sc1
    s_waitcnt lgkmcnt(14)
    v_mfma_f32_16x16x32_bf16 v[84:87], a[40:43], v[124:127], v[84:87]
    ds_read_b64_tr_b16 a[36:37], v67 offset:57344
    v_mfma_f32_16x16x32_bf16 v[100:103], a[40:43], v[128:131], v[100:103]
    ds_read_b64_tr_b16 a[38:39], v67 offset:59392
    s_add_u32 s57, s66, 12288
    buffer_load_dwordx4 v[112:115], v5, s[44:47], s57 offen offset:0 sc1
    v_mfma_f32_16x16x32_bf16 v[88:91], a[44:47], v[124:127], v[88:91]
    ds_read_b64_tr_b16 a[40:41], v68 offset:57344
    v_mfma_f32_16x16x32_bf16 v[104:107], a[44:47], v[128:131], v[104:107]
    ds_read_b64_tr_b16 a[42:43], v68 offset:59392
    s_waitcnt vmcnt(6) lgkmcnt(14)
    v_mfma_f32_16x16x32_bf16 v[76:79], a[48:51], v[132:135], v[76:79]
    ds_read_b64_tr_b16 a[44:45], v69 offset:57344
    v_mfma_f32_16x16x32_bf16 v[92:95], a[48:51], v[136:139], v[92:95]
    ds_read_b64_tr_b16 a[46:47], v69 offset:59392
    v_mfma_f32_16x16x32_bf16 v[80:83], a[52:55], v[132:135], v[80:83]
    v_add_u32 v66, 0x10000, v66
    v_add_u32 v67, 0x10000, v67
    v_add_u32 v68, 0x10000, v68
    v_add_u32 v69, 0x10000, v69
    ds_read_b64_tr_b16 a[48:49], v66 offset:0
    v_mfma_f32_16x16x32_bf16 v[96:99], a[52:55], v[136:139], v[96:99]
    ds_read_b64_tr_b16 a[50:51], v66 offset:2048
    buffer_load_dwordx4 v[116:119], v5, s[44:47], s56 offen offset:2048 sc1
    s_waitcnt lgkmcnt(14)
    v_mfma_f32_16x16x32_bf16 v[84:87], a[56:59], v[132:135], v[84:87]
    ds_read_b64_tr_b16 a[52:53], v67 offset:0
    v_mfma_f32_16x16x32_bf16 v[100:103], a[56:59], v[136:139], v[100:103]
    ds_read_b64_tr_b16 a[54:55], v67 offset:2048
    buffer_load_dwordx4 v[120:123], v5, s[44:47], s57 offen offset:2048 sc1
    v_mfma_f32_16x16x32_bf16 v[88:91], a[60:63], v[132:135], v[88:91]
    ds_read_b64_tr_b16 a[56:57], v68 offset:0
    v_mfma_f32_16x16x32_bf16 v[104:107], a[60:63], v[136:139], v[104:107]
    ds_read_b64_tr_b16 a[58:59], v68 offset:2048
    s_waitcnt vmcnt(6) lgkmcnt(14)
    v_mfma_f32_16x16x32_bf16 v[76:79], a[64:67], v[140:143], v[76:79]
    ds_read_b64_tr_b16 a[60:61], v69 offset:0
    v_mfma_f32_16x16x32_bf16 v[92:95], a[64:67], v[144:147], v[92:95]
    ds_read_b64_tr_b16 a[62:63], v69 offset:2048
    v_mfma_f32_16x16x32_bf16 v[80:83], a[68:71], v[140:143], v[80:83]
    ds_read_b64_tr_b16 a[64:65], v66 offset:8192
    v_mfma_f32_16x16x32_bf16 v[96:99], a[68:71], v[144:147], v[96:99]
    ds_read_b64_tr_b16 a[66:67], v66 offset:10240
    s_add_u32 s56, s65, 16384
    buffer_load_dwordx4 v[124:127], v5, s[44:47], s56 offen offset:0 sc1
    s_waitcnt lgkmcnt(14)
    v_mfma_f32_16x16x32_bf16 v[84:87], a[72:75], v[140:143], v[84:87]
    ds_read_b64_tr_b16 a[68:69], v67 offset:8192
    v_mfma_f32_16x16x32_bf16 v[100:103], a[72:75], v[144:147], v[100:103]
    ds_read_b64_tr_b16 a[70:71], v67 offset:10240
    s_add_u32 s57, s66, 16384
    buffer_load_dwordx4 v[128:131], v5, s[44:47], s57 offen offset:0 sc1
    v_mfma_f32_16x16x32_bf16 v[88:91], a[76:79], v[140:143], v[88:91]
    ds_read_b64_tr_b16 a[72:73], v68 offset:8192
    v_mfma_f32_16x16x32_bf16 v[104:107], a[76:79], v[144:147], v[104:107]
    ds_read_b64_tr_b16 a[74:75], v68 offset:10240
    s_waitcnt vmcnt(6) lgkmcnt(14)
    ds_write_b32 v11, v1 offset:176
    v_mfma_f32_16x16x32_bf16 v[76:79], a[80:83], v[148:151], v[76:79]
    ds_read_b64_tr_b16 a[76:77], v69 offset:8192
    v_mfma_f32_16x16x32_bf16 v[92:95], a[80:83], v[152:155], v[92:95]
    ds_read_b64_tr_b16 a[78:79], v69 offset:10240
    v_mfma_f32_16x16x32_bf16 v[80:83], a[84:87], v[148:151], v[80:83]
    ds_read_b32 v64, v10 offset:608
    ds_read_b64_tr_b16 a[80:81], v66 offset:16384
    v_mfma_f32_16x16x32_bf16 v[96:99], a[84:87], v[152:155], v[96:99]
    ds_read_b64_tr_b16 a[82:83], v66 offset:18432
    buffer_load_dwordx4 v[132:135], v5, s[44:47], s56 offen offset:2048 sc1
    s_waitcnt lgkmcnt(14)
    v_mfma_f32_16x16x32_bf16 v[84:87], a[88:91], v[148:151], v[84:87]
    ds_read_b64_tr_b16 a[84:85], v67 offset:16384
    v_mfma_f32_16x16x32_bf16 v[100:103], a[88:91], v[152:155], v[100:103]
    ds_read_b64_tr_b16 a[86:87], v67 offset:18432
    buffer_load_dwordx4 v[136:139], v5, s[44:47], s57 offen offset:2048 sc1
    v_mfma_f32_16x16x32_bf16 v[88:91], a[92:95], v[148:151], v[88:91]
    ds_read_b64_tr_b16 a[88:89], v68 offset:16384
    v_mfma_f32_16x16x32_bf16 v[104:107], a[92:95], v[152:155], v[104:107]
    ds_read_b64_tr_b16 a[90:91], v68 offset:18432
    s_waitcnt vmcnt(6) lgkmcnt(14)
    v_mfma_f32_16x16x32_bf16 v[76:79], a[0:3], v[108:111], v[76:79]
    ds_read_b64_tr_b16 a[92:93], v69 offset:16384
    v_mfma_f32_16x16x32_bf16 v[92:95], a[0:3], v[112:115], v[92:95]
    ds_read_b64_tr_b16 a[94:95], v69 offset:18432
    v_mfma_f32_16x16x32_bf16 v[80:83], a[4:7], v[108:111], v[80:83]
    s_waitcnt lgkmcnt(8)
    v_cmp_ne_u32 vcc, 1, v64
    s_cbranch_vccnz gt_198
gt_198_r:
    ds_read_b64_tr_b16 a[0:1], v66 offset:24576
    v_mfma_f32_16x16x32_bf16 v[96:99], a[4:7], v[112:115], v[96:99]
    ds_read_b64_tr_b16 a[2:3], v66 offset:26624
    s_add_u32 s56, s65, 20480
    buffer_load_dwordx4 v[140:143], v5, s[44:47], s56 offen offset:0 sc1
    s_waitcnt lgkmcnt(14)
    v_mfma_f32_16x16x32_bf16 v[84:87], a[8:11], v[108:111], v[84:87]
    ds_read_b64_tr_b16 a[4:5], v67 offset:24576
    v_mfma_f32_16x16x32_bf16 v[100:103], a[8:11], v[112:115], v[100:103]
    ds_read_b64_tr_b16 a[6:7], v67 offset:26624
    s_add_u32 s57, s66, 20480
    buffer_load_dwordx4 v[144:147], v5, s[44:47], s57 offen offset:0 sc1
    v_mfma_f32_16x16x32_bf16 v[88:91], a[12:15], v[108:111], v[88:91]
    ds_read_b64_tr_b16 a[8:9], v68 offset:24576
    v_mfma_f32_16x16x32_bf16 v[104:107], a[12:15], v[112:115], v[104:107]
    ds_read_b64_tr_b16 a[10:11], v68 offset:26624
    s_waitcnt vmcnt(6) lgkmcnt(14)
    v_mfma_f32_16x16x32_bf16 v[76:79], a[16:19], v[116:119], v[76:79]
    ds_read_b64_tr_b16 a[12:13], v69 offset:24576
    v_mfma_f32_16x16x32_bf16 v[92:95], a[16:19], v[120:123], v[92:95]
    ds_read_b64_tr_b16 a[14:15], v69 offset:26624
    v_mfma_f32_16x16x32_bf16 v[80:83], a[20:23], v[116:119], v[80:83]
    ds_read_b64_tr_b16 a[16:17], v66 offset:32768
    v_mfma_f32_16x16x32_bf16 v[96:99], a[20:23], v[120:123], v[96:99]
    ds_read_b64_tr_b16 a[18:19], v66 offset:34816
    buffer_load_dwordx4 v[148:151], v5, s[44:47], s56 offen offset:2048 sc1
    s_waitcnt lgkmcnt(14)
    v_mfma_f32_16x16x32_bf16 v[84:87], a[24:27], v[116:119], v[84:87]
    ds_read_b64_tr_b16 a[20:21], v67 offset:32768
    v_mfma_f32_16x16x32_bf16 v[100:103], a[24:27], v[120:123], v[100:103]
    ds_read_b64_tr_b16 a[22:23], v67 offset:34816
    buffer_load_dwordx4 v[152:155], v5, s[44:47], s57 offen offset:2048 sc1
    v_mfma_f32_16x16x32_bf16 v[88:91], a[28:31], v[116:119], v[88:91]
    ds_read_b64_tr_b16 a[24:25], v68 offset:32768
    v_mfma_f32_16x16x32_bf16 v[104:107], a[28:31], v[120:123], v[104:107]
    ds_read_b64_tr_b16 a[26:27], v68 offset:34816
    s_waitcnt vmcnt(6) lgkmcnt(14)
    v_mfma_f32_16x16x32_bf16 v[76:79], a[32:35], v[124:127], v[76:79]
    ds_read_b64_tr_b16 a[28:29], v69 offset:32768
    v_mfma_f32_16x16x32_bf16 v[92:95], a[32:35], v[128:131], v[92:95]
    ds_read_b64_tr_b16 a[30:31], v69 offset:34816
    v_mfma_f32_16x16x32_bf16 v[80:83], a[36:39], v[124:127], v[80:83]
    ds_read_b64_tr_b16 a[32:33], v66 offset:40960
    v_mfma_f32_16x16x32_bf16 v[96:99], a[36:39], v[128:131], v[96:99]
    ds_read_b64_tr_b16 a[34:35], v66 offset:43008
    s_add_u32 s56, s65, 24576
    buffer_load_dwordx4 v[108:111], v5, s[44:47], s56 offen offset:0 sc1
    s_waitcnt lgkmcnt(14)
    v_mfma_f32_16x16x32_bf16 v[84:87], a[40:43], v[124:127], v[84:87]
    ds_read_b64_tr_b16 a[36:37], v67 offset:40960
    v_mfma_f32_16x16x32_bf16 v[100:103], a[40:43], v[128:131], v[100:103]
    ds_read_b64_tr_b16 a[38:39], v67 offset:43008
    s_add_u32 s57, s66, 24576
    buffer_load_dwordx4 v[112:115], v5, s[44:47], s57 offen offset:0 sc1
    v_mfma_f32_16x16x32_bf16 v[88:91], a[44:47], v[124:127], v[88:91]
    ds_read_b64_tr_b16 a[40:41], v68 offset:40960
    v_mfma_f32_16x16x32_bf16 v[104:107], a[44:47], v[128:131], v[104:107]
    ds_read_b64_tr_b16 a[42:43], v68 offset:43008
    s_waitcnt vmcnt(6) lgkmcnt(14)
    ds_write_b32 v11, v1 offset:192
    v_mfma_f32_16x16x32_bf16 v[76:79], a[48:51], v[132:135], v[76:79]
    ds_read_b64_tr_b16 a[44:45], v69 offset:40960
    v_mfma_f32_16x16x32_bf16 v[92:95], a[48:51], v[136:139], v[92:95]
    ds_read_b64_tr_b16 a[46:47], v69 offset:43008
    v_mfma_f32_16x16x32_bf16 v[80:83], a[52:55], v[132:135], v[80:83]
    ds_read_b64_tr_b16 a[48:49], v66 offset:49152
    v_mfma_f32_16x16x32_bf16 v[96:99], a[52:55], v[136:139], v[96:99]
    ds_read_b64_tr_b16 a[50:51], v66 offset:51200
    buffer_load_dwordx4 v[116:119], v5, s[44:47], s56 offen offset:2048 sc1
    s_waitcnt lgkmcnt(14)
    v_mfma_f32_16x16x32_bf16 v[84:87], a[56:59], v[132:135], v[84:87]
    ds_read_b64_tr_b16 a[52:53], v67 offset:49152
    v_mfma_f32_16x16x32_bf16 v[100:103], a[56:59], v[136:139], v[100:103]
    ds_read_b64_tr_b16 a[54:55], v67 offset:51200
    buffer_load_dwordx4 v[120:123], v5, s[44:47], s57 offen offset:2048 sc1
    v_mfma_f32_16x16x32_bf16 v[88:91], a[60:63], v[132:135], v[88:91]
    ds_read_b64_tr_b16 a[56:57], v68 offset:49152
    v_mfma_f32_16x16x32_bf16 v[104:107], a[60:63], v[136:139], v[104:107]
    ds_read_b64_tr_b16 a[58:59], v68 offset:51200
    s_waitcnt vmcnt(6) lgkmcnt(14)
    v_mfma_f32_16x16x32_bf16 v[76:79], a[64:67], v[140:143], v[76:79]
    ds_read_b64_tr_b16 a[60:61], v69 offset:49152
    v_mfma_f32_16x16x32_bf16 v[92:95], a[64:67], v[144:147], v[92:95]
    ds_read_b64_tr_b16 a[62:63], v69 offset:51200
    v_mfma_f32_16x16x32_bf16 v[80:83], a[68:71], v[140:143], v[80:83]
    v_add_u32 v66, 0x10000, v66
    v_add_u32 v67, 0x10000, v67
    v_add_u32 v68, 0x10000, v68
    v_add_u32 v69, 0x10000, v69
    ds_read_b64_tr_b16 a[64:65], v66 offset:0
    v_mfma_f32_16x16x32_bf16 v[96:99], a[68:71], v[144:147], v[96:99]
    ds_read_b64_tr_b16 a[66:67], v66 offset:2048
    s_add_u32 s56, s65, 28672
    buffer_load_dwordx4 v[124:127], v5, s[44:47], s56 offen offset:0 sc1
    s_waitcnt lgkmcnt(14)
    v_mfma_f32_16x16x32_bf16 v[84:87], a[72:75], v[140:143], v[84:87]
    ds_read_b64_tr_b16 a[68:69], v67 offset:0
    v_mfma_f32_16x16x32_bf16 v[100:103], a[72:75], v[144:147], v[100:103]
    ds_read_b64_tr_b16 a[70:71], v67 offset:2048
    s_add_u32 s57, s66, 28672
    buffer_load_dwordx4 v[128:131], v5, s[44:47], s57 offen offset:0 sc1
    v_mfma_f32_16x16x32_bf16 v[88:91], a[76:79], v[140:143], v[88:91]
    ds_read_b64_tr_b16 a[72:73], v68 offset:0
    v_mfma_f32_16x16x32_bf16 v[104:107], a[76:79], v[144:147], v[104:107]
    ds_read_b64_tr_b16 a[74:75], v68 offset:2048
    s_waitcnt vmcnt(6) lgkmcnt(14)
    v_mfma_f32_16x16x32_bf16 v[76:79], a[80:83], v[148:151], v[76:79]
    ds_read_b64_tr_b16 a[76:77], v69 offset:0
    v_mfma_f32_16x16x32_bf16 v[92:95], a[80:83], v[152:155], v[92:95]
    ds_read_b64_tr_b16 a[78:79], v69 offset:2048
    v_mfma_f32_16x16x32_bf16 v[80:83], a[84:87], v[148:151], v[80:83]
    ds_read_b64_tr_b16 a[80:81], v66 offset:8192
    v_mfma_f32_16x16x32_bf16 v[96:99], a[84:87], v[152:155], v[96:99]
    ds_read_b64_tr_b16 a[82:83], v66 offset:10240
    buffer_load_dwordx4 v[132:135], v5, s[44:47], s56 offen offset:2048 sc1
    s_waitcnt lgkmcnt(14)
    v_mfma_f32_16x16x32_bf16 v[84:87], a[88:91], v[148:151], v[84:87]
    ds_read_b64_tr_b16 a[84:85], v67 offset:8192
    v_mfma_f32_16x16x32_bf16 v[100:103], a[88:91], v[152:155], v[100:103]
    ds_read_b64_tr_b16 a[86:87], v67 offset:10240
    buffer_load_dwordx4 v[136:139], v5, s[44:47], s57 offen offset:2048 sc1
    v_mfma_f32_16x16x32_bf16 v[88:91], a[92:95], v[148:151], v[88:91]
    ds_read_b64_tr_b16 a[88:89], v68 offset:8192
    v_mfma_f32_16x16x32_bf16 v[104:107], a[92:95], v[152:155], v[104:107]
    ds_read_b64_tr_b16 a[90:91], v68 offset:10240
    s_waitcnt vmcnt(6) lgkmcnt(14)
    v_mfma_f32_16x16x32_bf16 v[76:79], a[0:3], v[108:111], v[76:79]
    ds_read_b64_tr_b16 a[92:93], v69 offset:8192
    v_mfma_f32_16x16x32_bf16 v[92:95], a[0:3], v[112:115], v[92:95]
    ds_read_b64_tr_b16 a[94:95], v69 offset:10240
    v_mfma_f32_16x16x32_bf16 v[80:83], a[4:7], v[108:111], v[80:83]
    ds_read_b32 v64, v10 offset:624
    ds_read_b64_tr_b16 a[0:1], v66 offset:16384
    v_mfma_f32_16x16x32_bf16 v[96:99], a[4:7], v[112:115], v[96:99]
    ds_read_b64_tr_b16 a[2:3], v66 offset:18432
    s_add_u32 s56, s65, 32768
    buffer_load_dwordx4 v[140:143], v5, s[44:47], s56 offen offset:0 sc1
    s_waitcnt lgkmcnt(14)
    v_mfma_f32_16x16x32_bf16 v[84:87], a[8:11], v[108:111], v[84:87]
    ds_read_b64_tr_b16 a[4:5], v67 offset:16384
    v_mfma_f32_16x16x32_bf16 v[100:103], a[8:11], v[112:115], v[100:103]
    ds_read_b64_tr_b16 a[6:7], v67 offset:18432
    s_add_u32 s57, s66, 32768
    buffer_load_dwordx4 v[144:147], v5, s[44:47], s57 offen offset:0 sc1
    v_mfma_f32_16x16x32_bf16 v[88:91], a[12:15], v[108:111], v[88:91]
    ds_read_b64_tr_b16 a[8:9], v68 offset:16384
    v_mfma_f32_16x16x32_bf16 v[104:107], a[12:15], v[112:115], v[104:107]
    ds_read_b64_tr_b16 a[10:11], v68 offset:18432
    s_waitcnt vmcnt(6) lgkmcnt(14)
    v_mfma_f32_16x16x32_bf16 v[76:79], a[16:19], v[116:119], v[76:79]
    ds_read_b64_tr_b16 a[12:13], v69 offset:16384
    v_mfma_f32_16x16x32_bf16 v[92:95], a[16:19], v[120:123], v[92:95]
    ds_read_b64_tr_b16 a[14:15], v69 offset:18432
    v_mfma_f32_16x16x32_bf16 v[80:83], a[20:23], v[116:119], v[80:83]
    s_waitcnt lgkmcnt(8)
    v_cmp_ne_u32 vcc, 1, v64
    s_cbranch_vccnz gt_199
gt_199_r:
    v_add_u32 v66, 0xfffe0000, v66
    v_add_u32 v67, 0xfffe0000, v67
    v_add_u32 v68, 0xfffe0000, v68
    v_add_u32 v69, 0xfffe0000, v69
    ds_read_b64_tr_b16 a[16:17], v66 offset:0
    v_mfma_f32_16x16x32_bf16 v[96:99], a[20:23], v[120:123], v[96:99]
    ds_read_b64_tr_b16 a[18:19], v66 offset:2048
    buffer_load_dwordx4 v[148:151], v5, s[44:47], s56 offen offset:2048 sc1
    s_waitcnt lgkmcnt(14)
    v_mfma_f32_16x16x32_bf16 v[84:87], a[24:27], v[116:119], v[84:87]
    ds_read_b64_tr_b16 a[20:21], v67 offset:0
    v_mfma_f32_16x16x32_bf16 v[100:103], a[24:27], v[120:123], v[100:103]
    ds_read_b64_tr_b16 a[22:23], v67 offset:2048
    buffer_load_dwordx4 v[152:155], v5, s[44:47], s57 offen offset:2048 sc1
    v_mfma_f32_16x16x32_bf16 v[88:91], a[28:31], v[116:119], v[88:91]
    ds_read_b64_tr_b16 a[24:25], v68 offset:0
    v_mfma_f32_16x16x32_bf16 v[104:107], a[28:31], v[120:123], v[104:107]
    ds_read_b64_tr_b16 a[26:27], v68 offset:2048
    s_waitcnt vmcnt(6) lgkmcnt(14)
    v_mfma_f32_16x16x32_bf16 v[76:79], a[32:35], v[124:127], v[76:79]
    ds_read_b64_tr_b16 a[28:29], v69 offset:0
    v_mfma_f32_16x16x32_bf16 v[92:95], a[32:35], v[128:131], v[92:95]
    ds_read_b64_tr_b16 a[30:31], v69 offset:2048
    v_mfma_f32_16x16x32_bf16 v[80:83], a[36:39], v[124:127], v[80:83]
    ds_read_b64_tr_b16 a[32:33], v66 offset:8192
    v_mfma_f32_16x16x32_bf16 v[96:99], a[36:39], v[128:131], v[96:99]
    ds_read_b64_tr_b16 a[34:35], v66 offset:10240
    s_add_u32 s56, s65, 36864
    buffer_load_dwordx4 v[108:111], v5, s[44:47], s56 offen offset:0 sc1
    s_waitcnt lgkmcnt(14)
    v_mfma_f32_16x16x32_bf16 v[84:87], a[40:43], v[124:127], v[84:87]
    ds_read_b64_tr_b16 a[36:37], v67 offset:8192
    v_mfma_f32_16x16x32_bf16 v[100:103], a[40:43], v[128:131], v[100:103]
    ds_read_b64_tr_b16 a[38:39], v67 offset:10240
    s_add_u32 s57, s66, 36864
    buffer_load_dwordx4 v[112:115], v5, s[44:47], s57 offen offset:0 sc1
    v_mfma_f32_16x16x32_bf16 v[88:91], a[44:47], v[124:127], v[88:91]
    ds_read_b64_tr_b16 a[40:41], v68 offset:8192
    v_mfma_f32_16x16x32_bf16 v[104:107], a[44:47], v[128:131], v[104:107]
    ds_read_b64_tr_b16 a[42:43], v68 offset:10240
    s_waitcnt vmcnt(6) lgkmcnt(14)
    v_mfma_f32_16x16x32_bf16 v[76:79], a[48:51], v[132:135], v[76:79]
    ds_read_b64_tr_b16 a[44:45], v69 offset:8192
    v_mfma_f32_16x16x32_bf16 v[92:95], a[48:51], v[136:139], v[92:95]
    ds_read_b64_tr_b16 a[46:47], v69 offset:10240
    v_mfma_f32_16x16x32_bf16 v[80:83], a[52:55], v[132:135], v[80:83]
    ds_read_b64_tr_b16 a[48:49], v66 offset:16384
    v_mfma_f32_16x16x32_bf16 v[96:99], a[52:55], v[136:139], v[96:99]
    ds_read_b64_tr_b16 a[50:51], v66 offset:18432
    buffer_load_dwordx4 v[116:119], v5, s[44:47], s56 offen offset:2048 sc1
    s_waitcnt lgkmcnt(14)
    v_mfma_f32_16x16x32_bf16 v[84:87], a[56:59], v[132:135], v[84:87]
    ds_read_b64_tr_b16 a[52:53], v67 offset:16384
    v_mfma_f32_16x16x32_bf16 v[100:103], a[56:59], v[136:139], v[100:103]
    ds_read_b64_tr_b16 a[54:55], v67 offset:18432
    buffer_load_dwordx4 v[120:123], v5, s[44:47], s57 offen offset:2048 sc1
    v_mfma_f32_16x16x32_bf16 v[88:91], a[60:63], v[132:135], v[88:91]
    ds_read_b64_tr_b16 a[56:57], v68 offset:16384
    v_mfma_f32_16x16x32_bf16 v[104:107], a[60:63], v[136:139], v[104:107]
    ds_read_b64_tr_b16 a[58:59], v68 offset:18432
    s_waitcnt vmcnt(6) lgkmcnt(14)
    v_mfma_f32_16x16x32_bf16 v[76:79], a[64:67], v[140:143], v[76:79]
    ds_read_b64_tr_b16 a[60:61], v69 offset:16384
    v_mfma_f32_16x16x32_bf16 v[92:95], a[64:67], v[144:147], v[92:95]
    ds_read_b64_tr_b16 a[62:63], v69 offset:18432
    v_mfma_f32_16x16x32_bf16 v[80:83], a[68:71], v[140:143], v[80:83]
    ds_read_b64_tr_b16 a[64:65], v66 offset:24576
    v_mfma_f32_16x16x32_bf16 v[96:99], a[68:71], v[144:147], v[96:99]
    ds_read_b64_tr_b16 a[66:67], v66 offset:26624
    s_add_u32 s56, s65, 40960
    buffer_load_dwordx4 v[124:127], v5, s[44:47], s56 offen offset:0 sc1
    s_waitcnt lgkmcnt(14)
    v_mfma_f32_16x16x32_bf16 v[84:87], a[72:75], v[140:143], v[84:87]
    ds_read_b64_tr_b16 a[68:69], v67 offset:24576
    v_mfma_f32_16x16x32_bf16 v[100:103], a[72:75], v[144:147], v[100:103]
    ds_read_b64_tr_b16 a[70:71], v67 offset:26624
    s_add_u32 s57, s66, 40960
    buffer_load_dwordx4 v[128:131], v5, s[44:47], s57 offen offset:0 sc1
    v_mfma_f32_16x16x32_bf16 v[88:91], a[76:79], v[140:143], v[88:91]
    ds_read_b64_tr_b16 a[72:73], v68 offset:24576
    v_mfma_f32_16x16x32_bf16 v[104:107], a[76:79], v[144:147], v[104:107]
    ds_read_b64_tr_b16 a[74:75], v68 offset:26624
    s_waitcnt vmcnt(6) lgkmcnt(14)
    v_mfma_f32_16x16x32_bf16 v[76:79], a[80:83], v[148:151], v[76:79]
    ds_read_b64_tr_b16 a[76:77], v69 offset:24576
    v_mfma_f32_16x16x32_bf16 v[92:95], a[80:83], v[152:155], v[92:95]
    ds_read_b64_tr_b16 a[78:79], v69 offset:26624
    v_mfma_f32_16x16x32_bf16 v[80:83], a[84:87], v[148:151], v[80:83]
    ds_read_b32 v64, v10 offset:640
    v_add_u32 v66, 0x10000, v66
    v_add_u32 v67, 0x10000, v67
    v_add_u32 v68, 0x10000, v68
    v_add_u32 v69, 0x10000, v69
    ds_read_b64_tr_b16 a[80:81], v66 offset:57344
    v_mfma_f32_16x16x32_bf16 v[96:99], a[84:87], v[152:155], v[96:99]
    ds_read_b64_tr_b16 a[82:83], v66 offset:59392
    buffer_load_dwordx4 v[132:135], v5, s[44:47], s56 offen offset:2048 sc1
    s_waitcnt lgkmcnt(14)
    v_mfma_f32_16x16x32_bf16 v[84:87], a[88:91], v[148:151], v[84:87]
    ds_read_b64_tr_b16 a[84:85], v67 offset:57344
    v_mfma_f32_16x16x32_bf16 v[100:103], a[88:91], v[152:155], v[100:103]
    ds_read_b64_tr_b16 a[86:87], v67 offset:59392
    buffer_load_dwordx4 v[136:139], v5, s[44:47], s57 offen offset:2048 sc1
    v_mfma_f32_16x16x32_bf16 v[88:91], a[92:95], v[148:151], v[88:91]
    ds_read_b64_tr_b16 a[88:89], v68 offset:57344
    v_mfma_f32_16x16x32_bf16 v[104:107], a[92:95], v[152:155], v[104:107]
    ds_read_b64_tr_b16 a[90:91], v68 offset:59392
    s_waitcnt vmcnt(6) lgkmcnt(14)
    v_mfma_f32_16x16x32_bf16 v[76:79], a[0:3], v[108:111], v[76:79]
    ds_read_b64_tr_b16 a[92:93], v69 offset:57344
    v_mfma_f32_16x16x32_bf16 v[92:95], a[0:3], v[112:115], v[92:95]
    ds_read_b64_tr_b16 a[94:95], v69 offset:59392
    v_mfma_f32_16x16x32_bf16 v[80:83], a[4:7], v[108:111], v[80:83]
    s_waitcnt lgkmcnt(8)
    v_cmp_ne_u32 vcc, 1, v64
    s_cbranch_vccnz gt_200
gt_200_r:
    v_add_u32 v66, 0xffff0000, v66
    v_add_u32 v67, 0xffff0000, v67
    v_add_u32 v68, 0xffff0000, v68
    v_add_u32 v69, 0xffff0000, v69
    ds_read_b64_tr_b16 a[0:1], v66 offset:32768
    v_mfma_f32_16x16x32_bf16 v[96:99], a[4:7], v[112:115], v[96:99]
    ds_read_b64_tr_b16 a[2:3], v66 offset:34816
    s_add_u32 s56, s65, 45056
    buffer_load_dwordx4 v[140:143], v5, s[44:47], s56 offen offset:0 sc1
    s_waitcnt lgkmcnt(14)
    v_mfma_f32_16x16x32_bf16 v[84:87], a[8:11], v[108:111], v[84:87]
    ds_read_b64_tr_b16 a[4:5], v67 offset:32768
    v_mfma_f32_16x16x32_bf16 v[100:103], a[8:11], v[112:115], v[100:103]
    ds_read_b64_tr_b16 a[6:7], v67 offset:34816
    s_add_u32 s57, s66, 45056
    buffer_load_dwordx4 v[144:147], v5, s[44:47], s57 offen offset:0 sc1
    v_mfma_f32_16x16x32_bf16 v[88:91], a[12:15], v[108:111], v[88:91]
    ds_read_b64_tr_b16 a[8:9], v68 offset:32768
    v_mfma_f32_16x16x32_bf16 v[104:107], a[12:15], v[112:115], v[104:107]
    ds_read_b64_tr_b16 a[10:11], v68 offset:34816
    s_waitcnt vmcnt(6) lgkmcnt(14)
    v_mfma_f32_16x16x32_bf16 v[76:79], a[16:19], v[116:119], v[76:79]
    ds_read_b64_tr_b16 a[12:13], v69 offset:32768
    v_mfma_f32_16x16x32_bf16 v[92:95], a[16:19], v[120:123], v[92:95]
    ds_read_b64_tr_b16 a[14:15], v69 offset:34816
    v_mfma_f32_16x16x32_bf16 v[80:83], a[20:23], v[116:119], v[80:83]
    ds_read_b64_tr_b16 a[16:17], v66 offset:40960
    v_mfma_f32_16x16x32_bf16 v[96:99], a[20:23], v[120:123], v[96:99]
    ds_read_b64_tr_b16 a[18:19], v66 offset:43008
    buffer_load_dwordx4 v[148:151], v5, s[44:47], s56 offen offset:2048 sc1
    s_waitcnt lgkmcnt(14)
    v_mfma_f32_16x16x32_bf16 v[84:87], a[24:27], v[116:119], v[84:87]
    ds_read_b64_tr_b16 a[20:21], v67 offset:40960
    v_mfma_f32_16x16x32_bf16 v[100:103], a[24:27], v[120:123], v[100:103]
    ds_read_b64_tr_b16 a[22:23], v67 offset:43008
    buffer_load_dwordx4 v[152:155], v5, s[44:47], s57 offen offset:2048 sc1
    v_mfma_f32_16x16x32_bf16 v[88:91], a[28:31], v[116:119], v[88:91]
    ds_read_b64_tr_b16 a[24:25], v68 offset:40960
    v_mfma_f32_16x16x32_bf16 v[104:107], a[28:31], v[120:123], v[104:107]
    ds_read_b64_tr_b16 a[26:27], v68 offset:43008
    s_waitcnt vmcnt(6) lgkmcnt(14)
    v_mfma_f32_16x16x32_bf16 v[76:79], a[32:35], v[124:127], v[76:79]
    ds_read_b64_tr_b16 a[28:29], v69 offset:40960
    v_mfma_f32_16x16x32_bf16 v[92:95], a[32:35], v[128:131], v[92:95]
    ds_read_b64_tr_b16 a[30:31], v69 offset:43008
    v_mfma_f32_16x16x32_bf16 v[80:83], a[36:39], v[124:127], v[80:83]
    ds_read_b64_tr_b16 a[32:33], v66 offset:49152
    v_mfma_f32_16x16x32_bf16 v[96:99], a[36:39], v[128:131], v[96:99]
    ds_read_b64_tr_b16 a[34:35], v66 offset:51200
    s_add_u32 s56, s65, 49152
    buffer_load_dwordx4 v[108:111], v5, s[44:47], s56 offen offset:0 sc1
    s_waitcnt lgkmcnt(14)
    v_mfma_f32_16x16x32_bf16 v[84:87], a[40:43], v[124:127], v[84:87]
    ds_read_b64_tr_b16 a[36:37], v67 offset:49152
    v_mfma_f32_16x16x32_bf16 v[100:103], a[40:43], v[128:131], v[100:103]
    ds_read_b64_tr_b16 a[38:39], v67 offset:51200
    s_add_u32 s57, s66, 49152
    buffer_load_dwordx4 v[112:115], v5, s[44:47], s57 offen offset:0 sc1
    v_mfma_f32_16x16x32_bf16 v[88:91], a[44:47], v[124:127], v[88:91]
    ds_read_b64_tr_b16 a[40:41], v68 offset:49152
    v_mfma_f32_16x16x32_bf16 v[104:107], a[44:47], v[128:131], v[104:107]
    ds_read_b64_tr_b16 a[42:43], v68 offset:51200
    s_waitcnt vmcnt(6) lgkmcnt(14)
    v_mfma_f32_16x16x32_bf16 v[76:79], a[48:51], v[132:135], v[76:79]
    ds_read_b64_tr_b16 a[44:45], v69 offset:49152
    v_mfma_f32_16x16x32_bf16 v[92:95], a[48:51], v[136:139], v[92:95]
    ds_read_b64_tr_b16 a[46:47], v69 offset:51200
    v_mfma_f32_16x16x32_bf16 v[80:83], a[52:55], v[132:135], v[80:83]
    ds_read_b64_tr_b16 a[48:49], v66 offset:57344
    v_mfma_f32_16x16x32_bf16 v[96:99], a[52:55], v[136:139], v[96:99]
    ds_read_b64_tr_b16 a[50:51], v66 offset:59392
    buffer_load_dwordx4 v[116:119], v5, s[44:47], s56 offen offset:2048 sc1
    s_waitcnt lgkmcnt(14)
    v_mfma_f32_16x16x32_bf16 v[84:87], a[56:59], v[132:135], v[84:87]
    ds_read_b64_tr_b16 a[52:53], v67 offset:57344
    v_mfma_f32_16x16x32_bf16 v[100:103], a[56:59], v[136:139], v[100:103]
    ds_read_b64_tr_b16 a[54:55], v67 offset:59392
    buffer_load_dwordx4 v[120:123], v5, s[44:47], s57 offen offset:2048 sc1
    v_mfma_f32_16x16x32_bf16 v[88:91], a[60:63], v[132:135], v[88:91]
    ds_read_b64_tr_b16 a[56:57], v68 offset:57344
    v_mfma_f32_16x16x32_bf16 v[104:107], a[60:63], v[136:139], v[104:107]
    ds_read_b64_tr_b16 a[58:59], v68 offset:59392
    s_waitcnt vmcnt(6) lgkmcnt(14)
    v_mfma_f32_16x16x32_bf16 v[76:79], a[64:67], v[140:143], v[76:79]
    ds_read_b64_tr_b16 a[60:61], v69 offset:57344
    v_mfma_f32_16x16x32_bf16 v[92:95], a[64:67], v[144:147], v[92:95]
    ds_read_b64_tr_b16 a[62:63], v69 offset:59392
    v_mfma_f32_16x16x32_bf16 v[80:83], a[68:71], v[140:143], v[80:83]
    v_mfma_f32_16x16x32_bf16 v[96:99], a[68:71], v[144:147], v[96:99]
    s_add_u32 s56, s65, 53248
    buffer_load_dwordx4 v[124:127], v5, s[44:47], s56 offen offset:0 sc1
    s_waitcnt lgkmcnt(14)
    v_mfma_f32_16x16x32_bf16 v[84:87], a[72:75], v[140:143], v[84:87]
    v_mfma_f32_16x16x32_bf16 v[100:103], a[72:75], v[144:147], v[100:103]
    s_add_u32 s57, s66, 53248
    buffer_load_dwordx4 v[128:131], v5, s[44:47], s57 offen offset:0 sc1
    v_mfma_f32_16x16x32_bf16 v[88:91], a[76:79], v[140:143], v[88:91]
    v_mfma_f32_16x16x32_bf16 v[104:107], a[76:79], v[144:147], v[104:107]
    s_waitcnt vmcnt(6) lgkmcnt(14)
    v_mfma_f32_16x16x32_bf16 v[76:79], a[80:83], v[148:151], v[76:79]
    v_mfma_f32_16x16x32_bf16 v[92:95], a[80:83], v[152:155], v[92:95]
    v_mfma_f32_16x16x32_bf16 v[80:83], a[84:87], v[148:151], v[80:83]
    v_mfma_f32_16x16x32_bf16 v[96:99], a[84:87], v[152:155], v[96:99]
    buffer_load_dwordx4 v[132:135], v5, s[44:47], s56 offen offset:2048 sc1
    s_waitcnt lgkmcnt(0)
    v_mfma_f32_16x16x32_bf16 v[84:87], a[88:91], v[148:151], v[84:87]
    v_mfma_f32_16x16x32_bf16 v[100:103], a[88:91], v[152:155], v[100:103]
    buffer_load_dwordx4 v[136:139], v5, s[44:47], s57 offen offset:2048 sc1
    v_mfma_f32_16x16x32_bf16 v[88:91], a[92:95], v[148:151], v[88:91]
    v_mfma_f32_16x16x32_bf16 v[104:107], a[92:95], v[152:155], v[104:107]
    s_waitcnt vmcnt(6)
    v_mfma_f32_16x16x32_bf16 v[76:79], a[0:3], v[108:111], v[76:79]
    v_mfma_f32_16x16x32_bf16 v[92:95], a[0:3], v[112:115], v[92:95]
    v_mfma_f32_16x16x32_bf16 v[80:83], a[4:7], v[108:111], v[80:83]
    v_mfma_f32_16x16x32_bf16 v[96:99], a[4:7], v[112:115], v[96:99]
    v_mfma_f32_16x16x32_bf16 v[84:87], a[8:11], v[108:111], v[84:87]
    v_mfma_f32_16x16x32_bf16 v[100:103], a[8:11], v[112:115], v[100:103]
    v_mfma_f32_16x16x32_bf16 v[88:91], a[12:15], v[108:111], v[88:91]
    v_mfma_f32_16x16x32_bf16 v[104:107], a[12:15], v[112:115], v[104:107]
    s_waitcnt vmcnt(4)
    v_mfma_f32_16x16x32_bf16 v[76:79], a[16:19], v[116:119], v[76:79]
    v_mfma_f32_16x16x32_bf16 v[92:95], a[16:19], v[120:123], v[92:95]
    v_mfma_f32_16x16x32_bf16 v[80:83], a[20:23], v[116:119], v[80:83]
    v_mfma_f32_16x16x32_bf16 v[96:99], a[20:23], v[120:123], v[96:99]
    v_mfma_f32_16x16x32_bf16 v[84:87], a[24:27], v[116:119], v[84:87]
    v_mfma_f32_16x16x32_bf16 v[100:103], a[24:27], v[120:123], v[100:103]
    v_mfma_f32_16x16x32_bf16 v[88:91], a[28:31], v[116:119], v[88:91]
    v_mfma_f32_16x16x32_bf16 v[104:107], a[28:31], v[120:123], v[104:107]
    s_waitcnt vmcnt(2)
    v_mfma_f32_16x16x32_bf16 v[76:79], a[32:35], v[124:127], v[76:79]
    v_mfma_f32_16x16x32_bf16 v[92:95], a[32:35], v[128:131], v[92:95]
    v_mfma_f32_16x16x32_bf16 v[80:83], a[36:39], v[124:127], v[80:83]
    v_mfma_f32_16x16x32_bf16 v[96:99], a[36:39], v[128:131], v[96:99]
    v_mfma_f32_16x16x32_bf16 v[84:87], a[40:43], v[124:127], v[84:87]
    v_mfma_f32_16x16x32_bf16 v[100:103], a[40:43], v[128:131], v[100:103]
    v_mfma_f32_16x16x32_bf16 v[88:91], a[44:47], v[124:127], v[88:91]
    v_mfma_f32_16x16x32_bf16 v[104:107], a[44:47], v[128:131], v[104:107]
    s_waitcnt vmcnt(0)
    v_mfma_f32_16x16x32_bf16 v[76:79], a[48:51], v[132:135], v[76:79]
    v_mfma_f32_16x16x32_bf16 v[92:95], a[48:51], v[136:139], v[92:95]
    v_mfma_f32_16x16x32_bf16 v[80:83], a[52:55], v[132:135], v[80:83]
    v_mfma_f32_16x16x32_bf16 v[96:99], a[52:55], v[136:139], v[96:99]
    v_mfma_f32_16x16x32_bf16 v[84:87], a[56:59], v[132:135], v[84:87]
    v_mfma_f32_16x16x32_bf16 v[100:103], a[56:59], v[136:139], v[100:103]
    v_mfma_f32_16x16x32_bf16 v[88:91], a[60:63], v[132:135], v[88:91]
    v_mfma_f32_16x16x32_bf16 v[104:107], a[60:63], v[136:139], v[104:107]
    s_nop 1
    ds_write_b128 v70, v[92:95] offset:0
    s_nop 0
    ds_write_b128 v70, v[96:99] offset:1024
    s_nop 0
    ds_write_b128 v70, v[100:103] offset:2048
    s_nop 0
    ds_write_b128 v70, v[104:107] offset:3072
    v_pk_fma_f32 v[12:13], v[76:77], v[28:29], v[12:13]
    v_pk_fma_f32 v[14:15], v[78:79], v[30:31], v[14:15]
    v_pk_fma_f32 v[16:17], v[80:81], v[32:33], v[16:17]
    v_pk_fma_f32 v[18:19], v[82:83], v[34:35], v[18:19]
    v_pk_fma_f32 v[20:21], v[84:85], v[36:37], v[20:21]
    v_pk_fma_f32 v[22:23], v[86:87], v[38:39], v[22:23]
    v_pk_fma_f32 v[24:25], v[88:89], v[40:41], v[24:25]
    v_pk_fma_f32 v[26:27], v[90:91], v[42:43], v[26:27]
    s_waitcnt lgkmcnt(0)
    ds_write_b32 v11, v1 offset:336
    s_mov_b32 s15, 0
sp_201:
    ds_read_b32 v64, v72 offset:336
    s_add_u32 s15, s15, 1
    s_cmp_gt_u32 s15, 4000000
    s_cbranch_scc1 sp_201_x
    s_waitcnt lgkmcnt(0)
    v_cmp_ne_u32 vcc, 1, v64
    s_cbranch_vccnz sp_201
sp_201_x:
    s_waitcnt lgkmcnt(0)
    ds_read_b128 v[116:119], v71 offset:0
    ds_read_b128 v[120:123], v71 offset:1024
    ds_read_b128 v[124:127], v71 offset:2048
    ds_read_b128 v[128:131], v71 offset:3072
    v_and_b32 v9, 1, v3
    v_lshlrev_b32 v65, 10, v4
    v_lshl_add_u32 v65, v9, 5, v65
    v_lshrrev_b32 v9, 1, v3
    v_lshl_add_u32 v65, v9, 4, v65
    s_waitcnt lgkmcnt(2)
    v_pk_fma_f32 v[12:13], v[116:117], v[28:29], v[12:13]
    v_pk_fma_f32 v[14:15], v[118:119], v[30:31], v[14:15]
    v_pk_fma_f32 v[16:17], v[120:121], v[32:33], v[16:17]
    v_pk_fma_f32 v[18:19], v[122:123], v[34:35], v[18:19]
    v_cvt_pk_bf16_f32 v108, v12, v13
    v_cvt_pk_bf16_f32 v109, v14, v15
    v_cvt_pk_bf16_f32 v110, v16, v17
    v_cvt_pk_bf16_f32 v111, v18, v19
    s_nop 0
    v_permlane16_swap_b32 v108, v110
    v_permlane16_swap_b32 v109, v111
    buffer_store_dwordx4 v[108:111], v65, s[48:51], s60 offen offset:0
    s_waitcnt lgkmcnt(0)
    v_pk_fma_f32 v[20:21], v[124:125], v[36:37], v[20:21]
    v_pk_fma_f32 v[22:23], v[126:127], v[38:39], v[22:23]
    v_pk_fma_f32 v[24:25], v[128:129], v[40:41], v[24:25]
    v_pk_fma_f32 v[26:27], v[130:131], v[42:43], v[26:27]
    v_cvt_pk_bf16_f32 v112, v20, v21
    v_cvt_pk_bf16_f32 v113, v22, v23
    v_cvt_pk_bf16_f32 v114, v24, v25
    v_cvt_pk_bf16_f32 v115, v26, v27
    s_nop 0
    v_permlane16_swap_b32 v112, v114
    v_permlane16_swap_b32 v113, v115
    buffer_store_dwordx4 v[112:115], v65, s[48:51], s60 offen offset:64
    s_endpgm
fm_109:
    s_mov_b32 s15, 0
sp_202:
    s_sleep 8
    s_mov_b32 s10, s55
    buffer_load_dwordx2 v[18:19], v13, s[72:75], s10 offen sc1
    s_add_u32 s10, s10, 4096
    buffer_load_dwordx2 v[20:21], v13, s[72:75], s10 offen sc1
    s_add_u32 s10, s10, 4096
    buffer_load_dwordx2 v[22:23], v13, s[72:75], s10 offen sc1
    s_add_u32 s10, s10, 4096
    buffer_load_dwordx2 v[24:25], v13, s[72:75], s10 offen sc1
    s_add_u32 s10, s10, 4096
    buffer_load_dwordx2 v[26:27], v13, s[72:75], s10 offen sc1
    s_add_u32 s10, s10, 4096
    buffer_load_dwordx2 v[28:29], v13, s[72:75], s10 offen sc1
    s_add_u32 s10, s10, 4096
    buffer_load_dwordx2 v[30:31], v13, s[72:75], s10 offen sc1
    s_add_u32 s10, s10, 4096
    buffer_load_dwordx2 v[32:33], v13, s[72:75], s10 offen sc1
    s_add_u32 s10, s10, 4096
    buffer_load_dwordx2 v[34:35], v13, s[72:75], s10 offen sc1
    s_add_u32 s10, s10, 4096
    buffer_load_dwordx2 v[36:37], v13, s[72:75], s10 offen sc1
    s_add_u32 s10, s10, 4096
    buffer_load_dwordx2 v[38:39], v13, s[72:75], s10 offen sc1
    s_add_u32 s10, s10, 4096
    buffer_load_dwordx2 v[40:41], v13, s[72:75], s10 offen sc1
    s_add_u32 s10, s10, 4096
    buffer_load_dwordx2 v[42:43], v13, s[72:75], s10 offen sc1
    s_add_u32 s10, s10, 4096
    buffer_load_dwordx2 v[44:45], v13, s[72:75], s10 offen sc1
    s_add_u32 s10, s10, 4096
    buffer_load_dwordx2 v[46:47], v13, s[72:75], s10 offen sc1
    s_add_u32 s10, s10, 4096
    buffer_load_dwordx2 v[48:49], v13, s[72:75], s10 offen sc1
    s_add_u32 s10, s10, 4096
    buffer_load_dwordx2 v[50:51], v13, s[72:75], s10 offen sc1
    s_add_u32 s10, s10, 4096
    buffer_load_dwordx2 v[52:53], v13, s[72:75], s10 offen sc1
    s_add_u32 s10, s10, 4096
    buffer_load_dwordx2 v[54:55], v13, s[72:75], s10 offen sc1
    s_add_u32 s10, s10, 4096
    buffer_load_dwordx2 v[56:57], v13, s[72:75], s10 offen sc1
    s_add_u32 s10, s10, 4096
    buffer_load_dwordx2 v[58:59], v13, s[72:75], s10 offen sc1
    s_add_u32 s10, s10, 4096
    buffer_load_dwordx2 v[60:61], v13, s[72:75], s10 offen sc1
    s_add_u32 s10, s10, 4096
    buffer_load_dwordx2 v[62:63], v13, s[72:75], s10 offen sc1
    s_add_u32 s10, s10, 4096
    buffer_load_dwordx2 v[64:65], v13, s[72:75], s10 offen sc1
    s_add_u32 s10, s10, 4096
    buffer_load_dwordx2 v[66:67], v13, s[72:75], s10 offen sc1
    s_add_u32 s10, s10, 4096
    buffer_load_dwordx2 v[68:69], v13, s[72:75], s10 offen sc1
    s_add_u32 s10, s10, 4096
    buffer_load_dwordx2 v[70:71], v13, s[72:75], s10 offen sc1
    s_add_u32 s10, s10, 4096
    buffer_load_dwordx2 v[72:73], v13, s[72:75], s10 offen sc1
    s_add_u32 s10, s10, 4096
    buffer_load_dwordx2 v[74:75], v13, s[72:75], s10 offen sc1
    s_add_u32 s10, s10, 4096
    buffer_load_dwordx2 v[76:77], v13, s[72:75], s10 offen sc1
    s_add_u32 s10, s10, 4096
    buffer_load_dwordx2 v[78:79], v13, s[72:75], s10 offen sc1
    s_add_u32 s10, s10, 4096
    buffer_load_dwordx2 v[80:81], v13, s[72:75], s10 offen sc1
    s_add_u32 s10, s10, 4096
    s_add_u32 s15, s15, 1
    s_cmp_gt_u32 s15, 100000
    s_cbranch_scc1 sp_202_x
    s_waitcnt vmcnt(0)
    v_xor_b32 v9, v8, v19
    v_xor_b32 v12, v8, v21
    v_or_b32 v9, v9, v12
    v_xor_b32 v12, v8, v23
    v_or_b32 v9, v9, v12
    v_xor_b32 v12, v8, v25
    v_or_b32 v9, v9, v12
    v_xor_b32 v12, v8, v27
    v_or_b32 v9, v9, v12
    v_xor_b32 v12, v8, v29
    v_or_b32 v9, v9, v12
    v_xor_b32 v12, v8, v31
    v_or_b32 v9, v9, v12
    v_xor_b32 v12, v8, v33
    v_or_b32 v9, v9, v12
    v_xor_b32 v12, v8, v35
    v_or_b32 v9, v9, v12
    v_xor_b32 v12, v8, v37
    v_or_b32 v9, v9, v12
    v_xor_b32 v12, v8, v39
    v_or_b32 v9, v9, v12
    v_xor_b32 v12, v8, v41
    v_or_b32 v9, v9, v12
    v_xor_b32 v12, v8, v43
    v_or_b32 v9, v9, v12
    v_xor_b32 v12, v8, v45
    v_or_b32 v9, v9, v12
    v_xor_b32 v12, v8, v47
    v_or_b32 v9, v9, v12
    v_xor_b32 v12, v8, v49
    v_or_b32 v9, v9, v12
    v_xor_b32 v12, v8, v51
    v_or_b32 v9, v9, v12
    v_xor_b32 v12, v8, v53
    v_or_b32 v9, v9, v12
    v_xor_b32 v12, v8, v55
    v_or_b32 v9, v9, v12
    v_xor_b32 v12, v8, v57
    v_or_b32 v9, v9, v12
    v_xor_b32 v12, v8, v59
    v_or_b32 v9, v9, v12
    v_xor_b32 v12, v8, v61
    v_or_b32 v9, v9, v12
    v_xor_b32 v12, v8, v63
    v_or_b32 v9, v9, v12
    v_xor_b32 v12, v8, v65
    v_or_b32 v9, v9, v12
    v_xor_b32 v12, v8, v67
    v_or_b32 v9, v9, v12
    v_xor_b32 v12, v8, v69
    v_or_b32 v9, v9, v12
    v_xor_b32 v12, v8, v71
    v_or_b32 v9, v9, v12
    v_xor_b32 v12, v8, v73
    v_or_b32 v9, v9, v12
    v_xor_b32 v12, v8, v75
    v_or_b32 v9, v9, v12
    v_xor_b32 v12, v8, v77
    v_or_b32 v9, v9, v12
    v_xor_b32 v12, v8, v79
    v_or_b32 v9, v9, v12
    v_xor_b32 v12, v8, v81
    v_or_b32 v9, v9, v12
    v_cmp_ne_u32 vcc, 0, v9
    s_cbranch_vccnz sp_202
sp_202_x:
    s_waitcnt vmcnt(0)
    s_branch fm_109_r
ps_110:
    s_cmp_eq_u32 s37, 1
    s_cbranch_scc1 cm_203
    v_and_b32 v9, 7, v2
    v_lshlrev_b32 v9, 2, v9
    global_load_dword v9, v9, s[42:43] sc1
    s_waitcnt vmcnt(0)
    v_cmp_ne_u32 vcc, s38, v9
    s_nop 0
    s_cmp_eq_u64 vcc, 0
    s_cselect_b32 s37, 1, 0
cm_203:
    s_cmp_eq_u32 s37, 1
    s_cbranch_scc1 pd_111_f
    buffer_store_dwordx2 v[86:87], v13, s[44:47], s53 offen sc1
    s_branch pd_111
ps_122:
    buffer_store_dwordx4 v[44:47], v146, s[44:47], s57 offen sc1
    s_branch pd_123
ps_130:
    s_cmp_eq_u32 s37, 1
    s_cbranch_scc1 cm_204
    v_and_b32 v9, 7, v2
    v_lshlrev_b32 v9, 2, v9
    global_load_dword v9, v9, s[42:43] sc1
    s_waitcnt vmcnt(0)
    v_cmp_ne_u32 vcc, s38, v9
    s_nop 0
    s_cmp_eq_u64 vcc, 0
    s_cselect_b32 s37, 1, 0
cm_204:
    s_cmp_eq_u32 s37, 1
    s_cbranch_scc1 pd_131_f
    buffer_store_dwordx4 v[92:95], v5, s[44:47], s55 offen sc1
    buffer_store_dwordx4 v[96:99], v5, s[44:47], s24 offen sc1
    buffer_store_dwordx4 v[100:103], v5, s[44:47], s25 offen sc1
    buffer_store_dwordx4 v[104:107], v5, s[44:47], s26 offen sc1
    buffer_store_dwordx4 v[108:111], v5, s[44:47], s59 offen sc1
    s_branch pd_131
ps_132:
    buffer_store_dword v8, v6, s[44:47], s56 offen sc1
    s_branch pd_133
fb_116:
    s_waitcnt lgkmcnt(0)
    s_mul_i32 s36, s36, 1664525
    s_add_u32 s36, s36, 1013904221
    s_or_b32 s36, s36, 1
    v_mov_b32 v8, s36
    s_sub_u32 s9, s5, 18
    s_and_b32 s10, s9, 0xfffffff9
    s_cmp_lg_u32 s10, 0
    s_cbranch_scc1 fb_116_n
    s_lshl_b32 s52, s9, 1
    s_add_u32 s52, s52, s3
    s_mov_b32 s56, s64
    s_mov_b32 s57, s65
    s_mov_b32 s58, 0x400
    s_mov_b32 s59, 0x20000
    v_lshlrev_b32 v142, 1, v2
    s_lshl_b32 s9, s4, 7
    buffer_load_ushort v140, v142, s[56:59], s9 offen
    s_mov_b32 s56, s66
    s_mov_b32 s57, s67
    s_mov_b32 s58, 0x300000
    s_mov_b32 s59, 0x20000
    v_lshrrev_b32 v141, 3, v2
    v_mul_u32_u24 v141, 6144, v141
    v_and_b32 v142, 7, v2
    v_lshl_add_u32 v141, v142, 4, v141
    s_mul_i32 s55, s4, 393216
    s_lshl_b32 s9, s52, 8
    s_add_u32 s55, s55, s9
    s_add_u32 s55, s55, 0x800
    s_mov_b32 s15, 0
sp_205:
    s_sleep 2
    ds_read_b32 v9, v10 offset:720
    s_add_u32 s15, s15, 1
    s_cmp_gt_u32 s15, 4000000
    s_cbranch_scc1 sp_205_x
    s_waitcnt lgkmcnt(0)
    v_cmp_ne_u32 vcc, 1, v9
    s_cbranch_vccnz sp_205
sp_205_x:
    s_waitcnt lgkmcnt(0)
    buffer_load_dwordx4 v[76:79], v141, s[56:59], s55 offen offset:0
    buffer_load_dwordx4 v[80:83], v141, s[56:59], s55 offen offset:128
    s_add_u32 s55, s55, 49152
    buffer_load_dwordx4 v[84:87], v141, s[56:59], s55 offen offset:0
    buffer_load_dwordx4 v[88:91], v141, s[56:59], s55 offen offset:128
    s_add_u32 s55, s55, 49152
    buffer_load_dwordx4 v[92:95], v141, s[56:59], s55 offen offset:0
    buffer_load_dwordx4 v[96:99], v141, s[56:59], s55 offen offset:128
    s_add_u32 s55, s55, 49152
    buffer_load_dwordx4 v[100:103], v141, s[56:59], s55 offen offset:0
    buffer_load_dwordx4 v[104:107], v141, s[56:59], s55 offen offset:128
    s_add_u32 s55, s55, 49152
    buffer_load_dwordx4 v[108:111], v141, s[56:59], s55 offen offset:0
    buffer_load_dwordx4 v[112:115], v141, s[56:59], s55 offen offset:128
    s_add_u32 s55, s55, 49152
    buffer_load_dwordx4 v[116:119], v141, s[56:59], s55 offen offset:0
    buffer_load_dwordx4 v[120:123], v141, s[56:59], s55 offen offset:128
    s_add_u32 s55, s55, 49152
    buffer_load_dwordx4 v[124:127], v141, s[56:59], s55 offen offset:0
    buffer_load_dwordx4 v[128:131], v141, s[56:59], s55 offen offset:128
    s_add_u32 s55, s55, 49152
    buffer_load_dwordx4 v[132:135], v141, s[56:59], s55 offen offset:0
    buffer_load_dwordx4 v[136:139], v141, s[56:59], s55 offen offset:128
    s_add_u32 s55, s55, 49152
    s_waitcnt vmcnt(16)
    v_lshlrev_b32 v140, 16, v140
    v_mul_f32 v142, 0xbfb8aa3b, v140
    v_exp_f32 v142, v142
    s_nop 0
    v_add_f32 v142, 1.0, v142
    v_rcp_f32 v142, v142
    s_nop 0
    v_mul_f32 v140, v140, v142
    v_cvt_pk_bf16_f32 v140, v140, v140
    v_and_b32 v140, 0xffff0000, v140
    v_lshrrev_b32 v142, 3, v2
    v_lshlrev_b32 v142, 2, v142
    ds_bpermute_b32 v12, v142, v140 offset:0
    ds_bpermute_b32 v13, v142, v140 offset:32
    ds_bpermute_b32 v14, v142, v140 offset:64
    ds_bpermute_b32 v15, v142, v140 offset:96
    ds_bpermute_b32 v16, v142, v140 offset:128
    ds_bpermute_b32 v17, v142, v140 offset:160
    ds_bpermute_b32 v18, v142, v140 offset:192
    ds_bpermute_b32 v19, v142, v140 offset:224
    s_waitcnt lgkmcnt(0)
    s_waitcnt vmcnt(15)
    v_lshlrev_b32 v36, 16, v76
    v_and_b32 v37, 0xffff0000, v76
    v_lshlrev_b32 v38, 16, v77
    v_and_b32 v39, 0xffff0000, v77
    v_lshlrev_b32 v40, 16, v78
    v_and_b32 v41, 0xffff0000, v78
    v_lshlrev_b32 v42, 16, v79
    v_and_b32 v43, 0xffff0000, v79
    v_pk_mul_f32 v[20:21], v[36:37], v[12:13] op_sel_hi:[1,0]
    v_pk_mul_f32 v[22:23], v[38:39], v[12:13] op_sel_hi:[1,0]
    v_pk_mul_f32 v[24:25], v[40:41], v[12:13] op_sel_hi:[1,0]
    v_pk_mul_f32 v[26:27], v[42:43], v[12:13] op_sel_hi:[1,0]
    s_waitcnt vmcnt(14)
    v_lshlrev_b32 v36, 16, v80
    v_and_b32 v37, 0xffff0000, v80
    v_lshlrev_b32 v38, 16, v81
    v_and_b32 v39, 0xffff0000, v81
    v_lshlrev_b32 v40, 16, v82
    v_and_b32 v41, 0xffff0000, v82
    v_lshlrev_b32 v42, 16, v83
    v_and_b32 v43, 0xffff0000, v83
    v_pk_mul_f32 v[28:29], v[36:37], v[12:13] op_sel_hi:[1,0]
    v_pk_mul_f32 v[30:31], v[38:39], v[12:13] op_sel_hi:[1,0]
    v_pk_mul_f32 v[32:33], v[40:41], v[12:13] op_sel_hi:[1,0]
    v_pk_mul_f32 v[34:35], v[42:43], v[12:13] op_sel_hi:[1,0]
    s_waitcnt vmcnt(13)
    v_lshlrev_b32 v36, 16, v84
    v_and_b32 v37, 0xffff0000, v84
    v_lshlrev_b32 v38, 16, v85
    v_and_b32 v39, 0xffff0000, v85
    v_lshlrev_b32 v40, 16, v86
    v_and_b32 v41, 0xffff0000, v86
    v_lshlrev_b32 v42, 16, v87
    v_and_b32 v43, 0xffff0000, v87
    v_pk_fma_f32 v[20:21], v[36:37], v[12:13], v[20:21] op_sel:[0,1,0] op_sel_hi:[1,1,1]
    v_pk_fma_f32 v[22:23], v[38:39], v[12:13], v[22:23] op_sel:[0,1,0] op_sel_hi:[1,1,1]
    v_pk_fma_f32 v[24:25], v[40:41], v[12:13], v[24:25] op_sel:[0,1,0] op_sel_hi:[1,1,1]
    v_pk_fma_f32 v[26:27], v[42:43], v[12:13], v[26:27] op_sel:[0,1,0] op_sel_hi:[1,1,1]
    s_waitcnt vmcnt(12)
    v_lshlrev_b32 v36, 16, v88
    v_and_b32 v37, 0xffff0000, v88
    v_lshlrev_b32 v38, 16, v89
    v_and_b32 v39, 0xffff0000, v89
    v_lshlrev_b32 v40, 16, v90
    v_and_b32 v41, 0xffff0000, v90
    v_lshlrev_b32 v42, 16, v91
    v_and_b32 v43, 0xffff0000, v91
    v_pk_fma_f32 v[28:29], v[36:37], v[12:13], v[28:29] op_sel:[0,1,0] op_sel_hi:[1,1,1]
    v_pk_fma_f32 v[30:31], v[38:39], v[12:13], v[30:31] op_sel:[0,1,0] op_sel_hi:[1,1,1]
    v_pk_fma_f32 v[32:33], v[40:41], v[12:13], v[32:33] op_sel:[0,1,0] op_sel_hi:[1,1,1]
    v_pk_fma_f32 v[34:35], v[42:43], v[12:13], v[34:35] op_sel:[0,1,0] op_sel_hi:[1,1,1]
    s_waitcnt vmcnt(11)
    v_lshlrev_b32 v36, 16, v92
    v_and_b32 v37, 0xffff0000, v92
    v_lshlrev_b32 v38, 16, v93
    v_and_b32 v39, 0xffff0000, v93
    v_lshlrev_b32 v40, 16, v94
    v_and_b32 v41, 0xffff0000, v94
    v_lshlrev_b32 v42, 16, v95
    v_and_b32 v43, 0xffff0000, v95
    v_pk_fma_f32 v[20:21], v[36:37], v[14:15], v[20:21] op_sel_hi:[1,0,1]
    v_pk_fma_f32 v[22:23], v[38:39], v[14:15], v[22:23] op_sel_hi:[1,0,1]
    v_pk_fma_f32 v[24:25], v[40:41], v[14:15], v[24:25] op_sel_hi:[1,0,1]
    v_pk_fma_f32 v[26:27], v[42:43], v[14:15], v[26:27] op_sel_hi:[1,0,1]
    s_waitcnt vmcnt(10)
    v_lshlrev_b32 v36, 16, v96
    v_and_b32 v37, 0xffff0000, v96
    v_lshlrev_b32 v38, 16, v97
    v_and_b32 v39, 0xffff0000, v97
    v_lshlrev_b32 v40, 16, v98
    v_and_b32 v41, 0xffff0000, v98
    v_lshlrev_b32 v42, 16, v99
    v_and_b32 v43, 0xffff0000, v99
    v_pk_fma_f32 v[28:29], v[36:37], v[14:15], v[28:29] op_sel_hi:[1,0,1]
    v_pk_fma_f32 v[30:31], v[38:39], v[14:15], v[30:31] op_sel_hi:[1,0,1]
    v_pk_fma_f32 v[32:33], v[40:41], v[14:15], v[32:33] op_sel_hi:[1,0,1]
    v_pk_fma_f32 v[34:35], v[42:43], v[14:15], v[34:35] op_sel_hi:[1,0,1]
    s_waitcnt vmcnt(9)
    v_lshlrev_b32 v36, 16, v100
    v_and_b32 v37, 0xffff0000, v100
    v_lshlrev_b32 v38, 16, v101
    v_and_b32 v39, 0xffff0000, v101
    v_lshlrev_b32 v40, 16, v102
    v_and_b32 v41, 0xffff0000, v102
    v_lshlrev_b32 v42, 16, v103
    v_and_b32 v43, 0xffff0000, v103
    v_pk_fma_f32 v[20:21], v[36:37], v[14:15], v[20:21] op_sel:[0,1,0] op_sel_hi:[1,1,1]
    v_pk_fma_f32 v[22:23], v[38:39], v[14:15], v[22:23] op_sel:[0,1,0] op_sel_hi:[1,1,1]
    v_pk_fma_f32 v[24:25], v[40:41], v[14:15], v[24:25] op_sel:[0,1,0] op_sel_hi:[1,1,1]
    v_pk_fma_f32 v[26:27], v[42:43], v[14:15], v[26:27] op_sel:[0,1,0] op_sel_hi:[1,1,1]
    s_waitcnt vmcnt(8)
    v_lshlrev_b32 v36, 16, v104
    v_and_b32 v37, 0xffff0000, v104
    v_lshlrev_b32 v38, 16, v105
    v_and_b32 v39, 0xffff0000, v105
    v_lshlrev_b32 v40, 16, v106
    v_and_b32 v41, 0xffff0000, v106
    v_lshlrev_b32 v42, 16, v107
    v_and_b32 v43, 0xffff0000, v107
    v_pk_fma_f32 v[28:29], v[36:37], v[14:15], v[28:29] op_sel:[0,1,0] op_sel_hi:[1,1,1]
    v_pk_fma_f32 v[30:31], v[38:39], v[14:15], v[30:31] op_sel:[0,1,0] op_sel_hi:[1,1,1]
    v_pk_fma_f32 v[32:33], v[40:41], v[14:15], v[32:33] op_sel:[0,1,0] op_sel_hi:[1,1,1]
    v_pk_fma_f32 v[34:35], v[42:43], v[14:15], v[34:35] op_sel:[0,1,0] op_sel_hi:[1,1,1]
    s_waitcnt vmcnt(7)
    v_lshlrev_b32 v36, 16, v108
    v_and_b32 v37, 0xffff0000, v108
    v_lshlrev_b32 v38, 16, v109
    v_and_b32 v39, 0xffff0000, v109
    v_lshlrev_b32 v40, 16, v110
    v_and_b32 v41, 0xffff0000, v110
    v_lshlrev_b32 v42, 16, v111
    v_and_b32 v43, 0xffff0000, v111
    v_pk_fma_f32 v[20:21], v[36:37], v[16:17], v[20:21] op_sel_hi:[1,0,1]
    v_pk_fma_f32 v[22:23], v[38:39], v[16:17], v[22:23] op_sel_hi:[1,0,1]
    v_pk_fma_f32 v[24:25], v[40:41], v[16:17], v[24:25] op_sel_hi:[1,0,1]
    v_pk_fma_f32 v[26:27], v[42:43], v[16:17], v[26:27] op_sel_hi:[1,0,1]
    s_waitcnt vmcnt(6)
    v_lshlrev_b32 v36, 16, v112
    v_and_b32 v37, 0xffff0000, v112
    v_lshlrev_b32 v38, 16, v113
    v_and_b32 v39, 0xffff0000, v113
    v_lshlrev_b32 v40, 16, v114
    v_and_b32 v41, 0xffff0000, v114
    v_lshlrev_b32 v42, 16, v115
    v_and_b32 v43, 0xffff0000, v115
    v_pk_fma_f32 v[28:29], v[36:37], v[16:17], v[28:29] op_sel_hi:[1,0,1]
    v_pk_fma_f32 v[30:31], v[38:39], v[16:17], v[30:31] op_sel_hi:[1,0,1]
    v_pk_fma_f32 v[32:33], v[40:41], v[16:17], v[32:33] op_sel_hi:[1,0,1]
    v_pk_fma_f32 v[34:35], v[42:43], v[16:17], v[34:35] op_sel_hi:[1,0,1]
    s_waitcnt vmcnt(5)
    v_lshlrev_b32 v36, 16, v116
    v_and_b32 v37, 0xffff0000, v116
    v_lshlrev_b32 v38, 16, v117
    v_and_b32 v39, 0xffff0000, v117
    v_lshlrev_b32 v40, 16, v118
    v_and_b32 v41, 0xffff0000, v118
    v_lshlrev_b32 v42, 16, v119
    v_and_b32 v43, 0xffff0000, v119
    v_pk_fma_f32 v[20:21], v[36:37], v[16:17], v[20:21] op_sel:[0,1,0] op_sel_hi:[1,1,1]
    v_pk_fma_f32 v[22:23], v[38:39], v[16:17], v[22:23] op_sel:[0,1,0] op_sel_hi:[1,1,1]
    v_pk_fma_f32 v[24:25], v[40:41], v[16:17], v[24:25] op_sel:[0,1,0] op_sel_hi:[1,1,1]
    v_pk_fma_f32 v[26:27], v[42:43], v[16:17], v[26:27] op_sel:[0,1,0] op_sel_hi:[1,1,1]
    s_waitcnt vmcnt(4)
    v_lshlrev_b32 v36, 16, v120
    v_and_b32 v37, 0xffff0000, v120
    v_lshlrev_b32 v38, 16, v121
    v_and_b32 v39, 0xffff0000, v121
    v_lshlrev_b32 v40, 16, v122
    v_and_b32 v41, 0xffff0000, v122
    v_lshlrev_b32 v42, 16, v123
    v_and_b32 v43, 0xffff0000, v123
    v_pk_fma_f32 v[28:29], v[36:37], v[16:17], v[28:29] op_sel:[0,1,0] op_sel_hi:[1,1,1]
    v_pk_fma_f32 v[30:31], v[38:39], v[16:17], v[30:31] op_sel:[0,1,0] op_sel_hi:[1,1,1]
    v_pk_fma_f32 v[32:33], v[40:41], v[16:17], v[32:33] op_sel:[0,1,0] op_sel_hi:[1,1,1]
    v_pk_fma_f32 v[34:35], v[42:43], v[16:17], v[34:35] op_sel:[0,1,0] op_sel_hi:[1,1,1]
    s_waitcnt vmcnt(3)
    v_lshlrev_b32 v36, 16, v124
    v_and_b32 v37, 0xffff0000, v124
    v_lshlrev_b32 v38, 16, v125
    v_and_b32 v39, 0xffff0000, v125
    v_lshlrev_b32 v40, 16, v126
    v_and_b32 v41, 0xffff0000, v126
    v_lshlrev_b32 v42, 16, v127
    v_and_b32 v43, 0xffff0000, v127
    v_pk_fma_f32 v[20:21], v[36:37], v[18:19], v[20:21] op_sel_hi:[1,0,1]
    v_pk_fma_f32 v[22:23], v[38:39], v[18:19], v[22:23] op_sel_hi:[1,0,1]
    v_pk_fma_f32 v[24:25], v[40:41], v[18:19], v[24:25] op_sel_hi:[1,0,1]
    v_pk_fma_f32 v[26:27], v[42:43], v[18:19], v[26:27] op_sel_hi:[1,0,1]
    s_waitcnt vmcnt(2)
    v_lshlrev_b32 v36, 16, v128
    v_and_b32 v37, 0xffff0000, v128
    v_lshlrev_b32 v38, 16, v129
    v_and_b32 v39, 0xffff0000, v129
    v_lshlrev_b32 v40, 16, v130
    v_and_b32 v41, 0xffff0000, v130
    v_lshlrev_b32 v42, 16, v131
    v_and_b32 v43, 0xffff0000, v131
    v_pk_fma_f32 v[28:29], v[36:37], v[18:19], v[28:29] op_sel_hi:[1,0,1]
    v_pk_fma_f32 v[30:31], v[38:39], v[18:19], v[30:31] op_sel_hi:[1,0,1]
    v_pk_fma_f32 v[32:33], v[40:41], v[18:19], v[32:33] op_sel_hi:[1,0,1]
    v_pk_fma_f32 v[34:35], v[42:43], v[18:19], v[34:35] op_sel_hi:[1,0,1]
    s_waitcnt vmcnt(1)
    v_lshlrev_b32 v36, 16, v132
    v_and_b32 v37, 0xffff0000, v132
    v_lshlrev_b32 v38, 16, v133
    v_and_b32 v39, 0xffff0000, v133
    v_lshlrev_b32 v40, 16, v134
    v_and_b32 v41, 0xffff0000, v134
    v_lshlrev_b32 v42, 16, v135
    v_and_b32 v43, 0xffff0000, v135
    v_pk_fma_f32 v[20:21], v[36:37], v[18:19], v[20:21] op_sel:[0,1,0] op_sel_hi:[1,1,1]
    v_pk_fma_f32 v[22:23], v[38:39], v[18:19], v[22:23] op_sel:[0,1,0] op_sel_hi:[1,1,1]
    v_pk_fma_f32 v[24:25], v[40:41], v[18:19], v[24:25] op_sel:[0,1,0] op_sel_hi:[1,1,1]
    v_pk_fma_f32 v[26:27], v[42:43], v[18:19], v[26:27] op_sel:[0,1,0] op_sel_hi:[1,1,1]
    s_waitcnt vmcnt(0)
    v_lshlrev_b32 v36, 16, v136
    v_and_b32 v37, 0xffff0000, v136
    v_lshlrev_b32 v38, 16, v137
    v_and_b32 v39, 0xffff0000, v137
    v_lshlrev_b32 v40, 16, v138
    v_and_b32 v41, 0xffff0000, v138
    v_lshlrev_b32 v42, 16, v139
    v_and_b32 v43, 0xffff0000, v139
    v_pk_fma_f32 v[28:29], v[36:37], v[18:19], v[28:29] op_sel:[0,1,0] op_sel_hi:[1,1,1]
    v_pk_fma_f32 v[30:31], v[38:39], v[18:19], v[30:31] op_sel:[0,1,0] op_sel_hi:[1,1,1]
    v_pk_fma_f32 v[32:33], v[40:41], v[18:19], v[32:33] op_sel:[0,1,0] op_sel_hi:[1,1,1]
    v_pk_fma_f32 v[34:35], v[42:43], v[18:19], v[34:35] op_sel:[0,1,0] op_sel_hi:[1,1,1]
    v_add_f32_dpp v20, v20, v20 row_ror:8 row_mask:0xf bank_mask:0xf
    v_add_f32_dpp v21, v21, v21 row_ror:8 row_mask:0xf bank_mask:0xf
    v_add_f32_dpp v22, v22, v22 row_ror:8 row_mask:0xf bank_mask:0xf
    v_add_f32_dpp v23, v23, v23 row_ror:8 row_mask:0xf bank_mask:0xf
    v_add_f32_dpp v24, v24, v24 row_ror:8 row_mask:0xf bank_mask:0xf
    v_add_f32_dpp v25, v25, v25 row_ror:8 row_mask:0xf bank_mask:0xf
    v_add_f32_dpp v26, v26, v26 row_ror:8 row_mask:0xf bank_mask:0xf
    v_add_f32_dpp v27, v27, v27 row_ror:8 row_mask:0xf bank_mask:0xf
    v_add_f32_dpp v28, v28, v28 row_ror:8 row_mask:0xf bank_mask:0xf
    v_add_f32_dpp v29, v29, v29 row_ror:8 row_mask:0xf bank_mask:0xf
    v_add_f32_dpp v30, v30, v30 row_ror:8 row_mask:0xf bank_mask:0xf
    v_add_f32_dpp v31, v31, v31 row_ror:8 row_mask:0xf bank_mask:0xf
    v_add_f32_dpp v32, v32, v32 row_ror:8 row_mask:0xf bank_mask:0xf
    v_add_f32_dpp v33, v33, v33 row_ror:8 row_mask:0xf bank_mask:0xf
    v_add_f32_dpp v34, v34, v34 row_ror:8 row_mask:0xf bank_mask:0xf
    v_add_f32_dpp v35, v35, v35 row_ror:8 row_mask:0xf bank_mask:0xf
    v_permlane32_swap_b32 v20, v24
    v_permlane32_swap_b32 v21, v25
    v_permlane32_swap_b32 v22, v26
    v_permlane32_swap_b32 v23, v27
    v_permlane32_swap_b32 v28, v32
    v_permlane32_swap_b32 v29, v33
    v_permlane32_swap_b32 v30, v34
    v_permlane32_swap_b32 v31, v35
    v_pk_add_f32 v[20:21], v[20:21], v[24:25]
    v_pk_add_f32 v[22:23], v[22:23], v[26:27]
    v_pk_add_f32 v[28:29], v[28:29], v[32:33]
    v_pk_add_f32 v[30:31], v[30:31], v[34:35]
    v_permlane16_swap_b32 v20, v22
    v_permlane16_swap_b32 v21, v23
    v_permlane16_swap_b32 v28, v30
    v_permlane16_swap_b32 v29, v31
    v_pk_add_f32 v[20:21], v[20:21], v[22:23]
    v_pk_add_f32 v[28:29], v[28:29], v[30:31]
    v_and_b32 v141, 7, v2
    v_lshlrev_b32 v141, 6, v141
    v_lshrrev_b32 v142, 5, v2
    v_lshl_add_u32 v141, v142, 5, v141
    v_bfe_u32 v142, v2, 4, 1
    v_lshl_add_u32 v141, v142, 4, v141
    s_lshl_b32 s53, s4, 14
    s_lshl_b32 s9, s52, 10
    s_add_u32 s53, s53, s9
    s_add_u32 s53, s53, 0x40000
    v_mov_b32 v22, v21
    v_mov_b32 v21, v8
    v_mov_b32 v23, v8
    v_mov_b32 v30, v29
    v_mov_b32 v29, v8
    v_mov_b32 v31, v8
    buffer_store_dwordx4 v[20:23], v141, s[72:75], s53 offen offset:0 sc1
    buffer_store_dwordx4 v[28:31], v141, s[72:75], s53 offen offset:512 sc1
    s_branch fj_117
fb_116_n:
    s_sleep 60
    s_cmp_eq_u32 s37, 1
    s_cbranch_scc1 cm_206
    v_and_b32 v9, 7, v2
    v_lshlrev_b32 v9, 2, v9
    global_load_dword v9, v9, s[42:43] sc1
    s_waitcnt vmcnt(0)
    v_cmp_ne_u32 vcc, s38, v9
    s_nop 0
    s_cmp_eq_u64 vcc, 0
    s_cselect_b32 s37, 1, 0
cm_206:
    s_branch fj_117
gt_136:
    s_mov_b32 s15, 0
sp_207:
    ds_read_b32 v64, v10 offset:368
    s_add_u32 s15, s15, 1
    s_cmp_gt_u32 s15, 4000000
    s_cbranch_scc1 sp_207_x
    s_waitcnt lgkmcnt(0)
    v_cmp_ne_u32 vcc, 1, v64
    s_cbranch_vccnz sp_207
sp_207_x:
    s_waitcnt lgkmcnt(0)
    s_branch gt_136_r
gt_137:
    s_mov_b32 s15, 0
sp_208:
    ds_read_b32 v64, v10 offset:384
    s_add_u32 s15, s15, 1
    s_cmp_gt_u32 s15, 4000000
    s_cbranch_scc1 sp_208_x
    s_waitcnt lgkmcnt(0)
    v_cmp_ne_u32 vcc, 1, v64
    s_cbranch_vccnz sp_208
sp_208_x:
    s_waitcnt lgkmcnt(0)
    s_branch gt_137_r
gt_138:
    s_mov_b32 s15, 0
sp_209:
    ds_read_b32 v64, v10 offset:400
    s_add_u32 s15, s15, 1
    s_cmp_gt_u32 s15, 4000000
    s_cbranch_scc1 sp_209_x
    s_waitcnt lgkmcnt(0)
    v_cmp_ne_u32 vcc, 1, v64
    s_cbranch_vccnz sp_209
sp_209_x:
    s_waitcnt lgkmcnt(0)
    s_branch gt_138_r
ps_140:
    s_cmp_eq_u32 s37, 1
    s_cbranch_scc1 cm_210
    v_and_b32 v9, 7, v2
    v_lshlrev_b32 v9, 2, v9
    global_load_dword v9, v9, s[42:43] sc1
    s_waitcnt vmcnt(0)
    v_cmp_ne_u32 vcc, s38, v9
    s_nop 0
    s_cmp_eq_u64 vcc, 0
    s_cselect_b32 s37, 1, 0
cm_210:
    s_cmp_eq_u32 s37, 1
    s_cbranch_scc1 pd_141_f
    buffer_store_dwordx4 v[28:31], v5, s[44:47], s52 offen sc1
    buffer_store_dwordx4 v[32:35], v5, s[44:47], s53 offen sc1
    s_branch pd_141
ps_142:
    buffer_store_dword v8, v6, s[44:47], s54 offen sc1
    s_branch pd_143
gt_147:
    s_mov_b32 s15, 0
sp_211:
    ds_read_b32 v64, v10 offset:464
    s_add_u32 s15, s15, 1
    s_cmp_gt_u32 s15, 4000000
    s_cbranch_scc1 sp_211_x
    s_waitcnt lgkmcnt(0)
    v_cmp_ne_u32 vcc, 1, v64
    s_cbranch_vccnz sp_211
sp_211_x:
    s_waitcnt lgkmcnt(0)
    s_branch gt_147_r
ps_148:
    s_cmp_eq_u32 s37, 1
    s_cbranch_scc1 cm_212
    v_and_b32 v9, 7, v2
    v_lshlrev_b32 v9, 2, v9
    global_load_dword v9, v9, s[42:43] sc1
    s_waitcnt vmcnt(0)
    v_cmp_ne_u32 vcc, s38, v9
    s_nop 0
    s_cmp_eq_u64 vcc, 0
    s_cselect_b32 s37, 1, 0
cm_212:
    s_cmp_eq_u32 s37, 1
    s_cbranch_scc1 pd_149_f
    buffer_store_dwordx4 v[96:99], v5, s[44:47], s85 offen offset:0 sc1
    buffer_store_dwordx4 v[100:103], v5, s[44:47], s85 offen offset:1024 sc1
    s_branch pd_149
ps_150:
    buffer_store_dword v104, v62, s[44:47], s81 offen sc1
    s_branch pd_151
ps_153:
    buffer_store_dword v8, v6, s[44:47], s87 offen sc1
    s_branch pd_154
ps_156:
    buffer_store_dwordx2 v[152:153], v65, s[44:47], s86 offen sc1
    s_branch pd_157
rc_158:
    s_mov_b32 s15, 0
sp_213:
    ds_read_b32 v44, v10 offset:656
    s_add_u32 s15, s15, 1
    s_cmp_gt_u32 s15, 4000000
    s_cbranch_scc1 sp_213_x
    s_waitcnt lgkmcnt(0)
    v_cmp_ne_u32 vcc, 1, v44
    s_cbranch_vccnz sp_213
sp_213_x:
    s_waitcnt lgkmcnt(0)
    s_branch rc_158_r
hs_159:
    s_mov_b32 s15, 0
sp_214:
    buffer_load_dwordx4 v[28:31], v45, s[44:47], s89 offen offset:0 sc1
    buffer_load_dwordx4 v[32:35], v45, s[44:47], s89 offen offset:16 sc1
    buffer_load_dwordx4 v[36:39], v45, s[44:47], s89 offen offset:32 sc1
    buffer_load_dwordx4 v[40:43], v45, s[44:47], s89 offen offset:48 sc1
    s_add_u32 s15, s15, 1
    s_cmp_gt_u32 s15, 100000
    s_cbranch_scc1 sp_214_x
    s_waitcnt vmcnt(0)
    v_xor_b32 v9, v8, v29
    v_xor_b32 v65, v8, v31
    v_xor_b32 v44, v8, v33
    v_or3_b32 v9, v9, v65, v44
    v_xor_b32 v65, v8, v35
    v_xor_b32 v44, v8, v37
    v_or3_b32 v9, v9, v65, v44
    v_xor_b32 v65, v8, v39
    v_xor_b32 v44, v8, v41
    v_or3_b32 v9, v9, v65, v44
    v_xor_b32 v65, v8, v43
    v_or_b32 v9, v9, v65
    v_cmp_ne_u32 vcc, 0, v9
    s_cbranch_vccnz sp_214
sp_214_x:
    s_waitcnt vmcnt(0)
    s_branch hs_159_r
ps_160:
    s_cmp_eq_u32 s37, 1
    s_cbranch_scc1 cm_215
    v_and_b32 v9, 7, v2
    v_lshlrev_b32 v9, 2, v9
    global_load_dword v9, v9, s[42:43] sc1
    s_waitcnt vmcnt(0)
    v_cmp_ne_u32 vcc, s38, v9
    s_nop 0
    s_cmp_eq_u64 vcc, 0
    s_cselect_b32 s37, 1, 0
cm_215:
    s_cmp_eq_u32 s37, 1
    s_cbranch_scc1 pd_161_f
    buffer_store_dwordx4 v[152:155], v5, s[44:47], s90 offen offset:0 sc1
    buffer_store_dwordx4 v[156:159], v5, s[44:47], s90 offen offset:1024 sc1
    s_branch pd_161
ps_164:
    buffer_store_dword v8, v6, s[44:47], s91 offen sc1
    s_branch pd_165
h1h_162:
    s_mov_b32 exec_lo, s64
    s_mov_b32 exec_hi, s64
    buffer_store_dwordx4 v[152:155], v5, s[72:75], s65 offen offset:0 sc1
    buffer_store_dwordx4 v[156:159], v5, s[72:75], s65 offen offset:1024 sc1
    s_mov_b64 exec, -1
    s_branch h1h_162_r
h1h_162_f:
    s_waitcnt vmcnt(2)
    s_mov_b64 exec, 1
    s_cmp_lg_u32 s37, 1
    s_cbranch_scc1 ps_216
pd_217_f:
    buffer_store_dword v8, v6, s[44:47], s91 offen
pd_217:
    s_waitcnt vmcnt(1)
    buffer_store_dword v8, v6, s[72:75], s66 offen sc1
    s_mov_b64 exec, -1
    s_branch h1h_162_fr
ps_167:
    s_cmp_eq_u32 s37, 1
    s_cbranch_scc1 cm_218
    v_and_b32 v9, 7, v2
    v_lshlrev_b32 v9, 2, v9
    global_load_dword v9, v9, s[42:43] sc1
    s_waitcnt vmcnt(0)
    v_cmp_ne_u32 vcc, s38, v9
    s_nop 0
    s_cmp_eq_u64 vcc, 0
    s_cselect_b32 s37, 1, 0
cm_218:
    s_cmp_eq_u32 s37, 1
    s_cbranch_scc1 pd_168_f
    buffer_store_dwordx4 v[148:151], v5, s[44:47], s85 offen offset:0 sc1
    buffer_store_dwordx4 v[152:155], v5, s[44:47], s85 offen offset:1024 sc1
    s_branch pd_168
ps_169:
    buffer_store_dword v156, v62, s[44:47], s93 offen sc1
    s_branch pd_170
ps_171:
    buffer_store_dword v8, v6, s[44:47], s94 offen sc1
    s_branch pd_172
gt_175:
    s_mov_b32 s15, 0
sp_219:
    ds_read_b32 v64, v10 offset:544
    s_add_u32 s15, s15, 1
    s_cmp_gt_u32 s15, 4000000
    s_cbranch_scc1 sp_219_x
    s_waitcnt lgkmcnt(0)
    v_cmp_ne_u32 vcc, 1, v64
    s_cbranch_vccnz sp_219
sp_219_x:
    s_waitcnt lgkmcnt(0)
    s_branch gt_175_r
gt_176:
    s_mov_b32 s15, 0
sp_220:
    ds_read_b32 v64, v10 offset:560
    s_add_u32 s15, s15, 1
    s_cmp_gt_u32 s15, 4000000
    s_cbranch_scc1 sp_220_x
    s_waitcnt lgkmcnt(0)
    v_cmp_ne_u32 vcc, 1, v64
    s_cbranch_vccnz sp_220
sp_220_x:
    s_waitcnt lgkmcnt(0)
    s_branch gt_176_r
ps_183:
    s_cmp_eq_u32 s37, 1
    s_cbranch_scc1 cm_221
    v_and_b32 v9, 7, v2
    v_lshlrev_b32 v9, 2, v9
    global_load_dword v9, v9, s[42:43] sc1
    s_waitcnt vmcnt(0)
    v_cmp_ne_u32 vcc, s38, v9
    s_nop 0
    s_cmp_eq_u64 vcc, 0
    s_cselect_b32 s37, 1, 0
cm_221:
    s_cmp_eq_u32 s37, 1
    s_cbranch_scc1 pd_184_f
    buffer_store_dwordx4 v[76:79], v5, s[44:47], s58 offen offset:0 sc1
    buffer_store_dwordx4 v[80:83], v5, s[44:47], s58 offen offset:1024 sc1
    buffer_store_dwordx4 v[84:87], v5, s[44:47], s58 offen offset:2048 sc1
    buffer_store_dwordx2 v[88:89], v5, s[44:47], s58 offen offset:3072 sc1
    s_branch pd_184
ps_185:
    s_cmp_eq_u32 s37, 1
    s_cbranch_scc1 cm_222
    v_and_b32 v9, 7, v2
    v_lshlrev_b32 v9, 2, v9
    global_load_dword v9, v9, s[42:43] sc1
    s_waitcnt vmcnt(0)
    v_cmp_ne_u32 vcc, s38, v9
    s_nop 0
    s_cmp_eq_u64 vcc, 0
    s_cselect_b32 s37, 1, 0
cm_222:
    s_cmp_eq_u32 s37, 1
    s_cbranch_scc1 pd_186_f
    buffer_store_dwordx2 v[76:77], v5, s[44:47], s58 offen offset:8 sc1
    buffer_store_dwordx4 v[78:81], v5, s[44:47], s58 offen offset:1024 sc1
    buffer_store_dwordx4 v[82:85], v5, s[44:47], s58 offen offset:2048 sc1
    buffer_store_dwordx4 v[86:89], v5, s[44:47], s58 offen offset:3072 sc1
    s_branch pd_186
ps_190:
    s_cmp_eq_u32 s37, 1
    s_cbranch_scc1 cm_223
    v_and_b32 v9, 7, v2
    v_lshlrev_b32 v9, 2, v9
    global_load_dword v9, v9, s[42:43] sc1
    s_waitcnt vmcnt(0)
    v_cmp_ne_u32 vcc, s38, v9
    s_nop 0
    s_cmp_eq_u64 vcc, 0
    s_cselect_b32 s37, 1, 0
cm_223:
    s_cmp_eq_u32 s37, 1
    s_cbranch_scc1 pd_191_f
    buffer_store_dwordx4 v[104:107], v5, s[44:47], s59 offen offset:0 sc1
    buffer_store_dwordx4 v[108:111], v5, s[44:47], s59 offen offset:1024 sc1
    buffer_store_dwordx4 v[112:115], v5, s[44:47], s59 offen offset:2048 sc1
    buffer_store_dwordx2 v[116:117], v5, s[44:47], s59 offen offset:3072 sc1
    s_branch pd_191
ps_192:
    s_cmp_eq_u32 s37, 1
    s_cbranch_scc1 cm_224
    v_and_b32 v9, 7, v2
    v_lshlrev_b32 v9, 2, v9
    global_load_dword v9, v9, s[42:43] sc1
    s_waitcnt vmcnt(0)
    v_cmp_ne_u32 vcc, s38, v9
    s_nop 0
    s_cmp_eq_u64 vcc, 0
    s_cselect_b32 s37, 1, 0
cm_224:
    s_cmp_eq_u32 s37, 1
    s_cbranch_scc1 pd_193_f
    buffer_store_dwordx2 v[104:105], v5, s[44:47], s59 offen offset:8 sc1
    buffer_store_dwordx4 v[106:109], v5, s[44:47], s59 offen offset:1024 sc1
    buffer_store_dwordx4 v[110:113], v5, s[44:47], s59 offen offset:2048 sc1
    buffer_store_dwordx4 v[114:117], v5, s[44:47], s59 offen offset:3072 sc1
    s_branch pd_193
ps_194:
    buffer_store_dword v8, v6, s[44:47], s79 offen sc1
    s_branch pd_195
gt_198:
    s_mov_b32 s15, 0
sp_225:
    ds_read_b32 v64, v10 offset:608
    s_add_u32 s15, s15, 1
    s_cmp_gt_u32 s15, 4000000
    s_cbranch_scc1 sp_225_x
    s_waitcnt lgkmcnt(0)
    v_cmp_ne_u32 vcc, 1, v64
    s_cbranch_vccnz sp_225
sp_225_x:
    s_waitcnt lgkmcnt(0)
    s_branch gt_198_r
gt_199:
    s_mov_b32 s15, 0
sp_226:
    ds_read_b32 v64, v10 offset:624
    s_add_u32 s15, s15, 1
    s_cmp_gt_u32 s15, 4000000
    s_cbranch_scc1 sp_226_x
    s_waitcnt lgkmcnt(0)
    v_cmp_ne_u32 vcc, 1, v64
    s_cbranch_vccnz sp_226
sp_226_x:
    s_waitcnt lgkmcnt(0)
    s_branch gt_199_r
gt_200:
    s_mov_b32 s15, 0
sp_227:
    ds_read_b32 v64, v10 offset:640
    s_add_u32 s15, s15, 1
    s_cmp_gt_u32 s15, 4000000
    s_cbranch_scc1 sp_227_x
    s_waitcnt lgkmcnt(0)
    v_cmp_ne_u32 vcc, 1, v64
    s_cbranch_vccnz sp_227
sp_227_x:
    s_waitcnt lgkmcnt(0)
    s_branch gt_200_r
ps_216:
    buffer_store_dword v8, v6, s[44:47], s91 offen sc1
    s_branch pd_217
kp_end:
    s_endpgm
kp_code_end:
.section .rodata,"a"
.p2align 6
.amdhsa_kernel adaLN_cond__sliding_local_dilated__mixer_s_mlp__prompt_kernel
  .amdhsa_next_free_vgpr 256
  .amdhsa_next_free_sgpr 100
  .amdhsa_accum_offset 160
  .amdhsa_group_segment_fixed_size 0
  .amdhsa_kernarg_size 104
  .amdhsa_user_sgpr_count 2
  .amdhsa_user_sgpr_kernarg_segment_ptr 1
  .amdhsa_system_sgpr_workgroup_id_x 1
  .amdhsa_float_denorm_mode_32 3
.end_amdhsa_kernel
```
